```python
import torch

def _softmax(x, axis=-1):
    return torch.softmax(x, dim=axis)
def _gelu(x):
    return torch.nn.functional.gelu(x, approximate="tanh")
def _silu(x):
    return torch.nn.functional.silu(x)
def _sigmoid(x):
    return torch.sigmoid(x)
def _layernorm(x, axis=-1, eps=1e-5):
    m = x.mean(dim=axis, keepdim=True)
    v = x.var(dim=axis, keepdim=True, unbiased=False)
    return (x - m) / torch.sqrt(v + eps)
def _scatter_add(tgt, idx, src, axis=0):
    return tgt.clone().index_add_(axis, idx, src)
def _segment_sum(src, seg, n):
    out = torch.zeros((n,) + src.shape[1:], dtype=src.dtype)
    return out.index_add_(0, seg, src)
def _pad(x, pw):
    flat = tuple(v for pair in reversed(pw) for v in pair)
    return torch.nn.functional.pad(x, flat)

kernel_name = 'recurrent_scan__sliding_local_dilated__swiglu_ffn__prompt'

def setup_inputs():

    _w = (lambda a: (lambda t: t.to(torch.bfloat16) if t.is_floating_point() else t)(torch.as_tensor(a)))
    def _A_setup():
        B, S, D = 1, 2048, 512
        return {
            "x": _w((lambda *s: torch.randn(*s, dtype=torch.bfloat16) * 0.05)(B, S, D)),
            "wqkv": _w((lambda *s: torch.randn(*s, dtype=torch.bfloat16) * 0.05)(D, 3 * D)),
            "wo": _w((lambda *s: torch.randn(*s, dtype=torch.bfloat16) * 0.05)(D, D)),
        }
    _A_in = _A_setup()

    def _B_setup():
        B, S, D, F = 1, 2048, 512, 1792
        return {
            "x": _w((lambda *s: torch.randn(*s, dtype=torch.bfloat16) * 0.05)(B, S, D)),
            "w_gate": _w((lambda *s: torch.randn(*s, dtype=torch.bfloat16) * 0.05)(D, F)),
            "w_up": _w((lambda *s: torch.randn(*s, dtype=torch.bfloat16) * 0.05)(D, F)),
            "w_down": _w((lambda *s: torch.randn(*s, dtype=torch.bfloat16) * 0.05)(F, D)),
        }
    _B_in = _B_setup()

    return {
        "A_x": _A_in["x"],
        "A_wqkv": _A_in["wqkv"],
        "A_wo": _A_in["wo"],
        "B_x": _B_in["x"],
        "B_w_gate": _B_in["w_gate"],
        "B_w_up": _B_in["w_up"],
        "B_w_down": _B_in["w_down"],
    }

def reference(A_x, A_wqkv, A_wo, B_x, B_w_gate, B_w_up, B_w_down):
    def _A_ref(x, wqkv, wo):
        B, S, D = x.shape
        H = 32; Dh = D // H
        W, dil = 8, 2
        qkv = (lambda x, *d: x.permute(*d))((x @ wqkv).reshape(B, S, 3, H, Dh), 2, 0, 3, 1, 4)
        q, k, v = qkv[0], qkv[1], qkv[2]
        scale = Dh ** -0.5
        pos = torch.arange(S)
        off = torch.arange(W) * dil
        idx = pos[:, None] - off[None, :]
        mask = idx >= 0
        idx_c = torch.where(mask, idx, 0).reshape(-1)
        kg = k[:, :, idx_c, :].reshape(B, H, S, W, Dh)
        vg = v[:, :, idx_c, :].reshape(B, H, S, W, Dh)
        logits = torch.einsum("bhsd,bhswd->bhsw", q, kg) * scale
        logits = torch.where(mask[None, None, :, :], logits, -1e9)
        attn = _softmax(logits, axis=-1)
        o = torch.einsum("bhsw,bhswd->bhsd", attn, vg)
        return (lambda x, *d: x.permute(*d))(o, 0, 2, 1, 3).reshape(B, S, D) @ wo

    def _B_ref(x, w_gate, w_up, w_down):
        g = _silu(x @ w_gate)
        u = x @ w_up
        return (g * u) @ w_down

    x = A_x
    xn = _layernorm(x, axis=-1)
    s = _A_ref(xn, A_wqkv, A_wo)
    g = _silu(_B_ref(xn, B_w_gate, B_w_up, B_w_down))
    return x + s * g
```

```asm
; @launch grid=(256,1,1) block=(256,1,1) lds=163840
.amdgcn_target "amdgcn-amd-amdhsa--gfx950"
.text
.globl recurrent_scan__sliding_local_dilated__swiglu_ffn__prompt_kernel
.p2align 8
.type recurrent_scan__sliding_local_dilated__swiglu_ffn__prompt_kernel,@function
recurrent_scan__sliding_local_dilated__swiglu_ffn__prompt_kernel:
    s_cmp_ge_u32 s2, 256
    s_cbranch_scc0 L_go
    s_endpgm
L_go:
    s_load_dwordx2 s[24:25], s[0:1], 0
    s_load_dwordx16 s[4:19], s[0:1], 0
    s_load_dwordx4 s[20:23], s[0:1], 64
    v_lshrrev_b32 v1, 6, v0
    s_getpc_b64 s[28:29]
    v_readfirstlane_b32 s56, v1
    s_bfe_u32 s26, s2, 0x30003
    s_lshl_b32 s26, s26, 13
    v_lshrrev_b32 v2, 2, v0
    v_lshl_add_u32 v2, v2, 7, s26
    v_min_u32 v2, L_end-L_go-256, v2
    global_load_dword v3, v2, s[28:29]
    v_and_b32 v255, 63, v0
    v_lshrrev_b32 v96, 3, v255
    v_and_b32 v97, 7, v0
    s_lshl_b32 s62, s56, 12
    s_cmp_ge_u32 s2, 128
    s_cbranch_scc1 L_typeC
L_typeB:
    s_and_b32 s64, s2, 63
    s_lshl_b32 s64, s64, 15
    s_lshr_b32 s63, s2, 6
    s_lshl2_add_u32 s63, s63, s56
    s_lshl_b32 s63, s63, 8
    s_add_u32 s63, s63, s64
    v_xor_b32 v98, v96, v97
    v_lshlrev_b32 v98, 4, v98
    v_lshl_add_u32 v100, v96, 11, v98
    s_add_u32 s71, s63, 15360
    s_mov_b32 s26, 2097152
    s_mov_b32 s27, 0x20000
    s_add_u32 m0, s62, 131072
    s_waitcnt lgkmcnt(0)
    buffer_load_dwordx4 v100, s[24:27], s63 offen lds
    buffer_load_dwordx4 v100, s[24:27], s71 offen offset:1024 lds
    s_add_u32 m0, s62, 132992
    s_mov_b32 s48, s22
    buffer_load_dwordx4 v100, s[24:27], s63 offen offset:128 lds
    buffer_load_dwordx4 v100, s[24:27], s71 offen offset:1152 lds
    s_mov_b32 s49, s23
    s_mov_b32 s50, 15728640
    s_mov_b32 s51, 0x20000
    s_lshr_b32 s63, s2, 3
    s_and_b32 s64, s2, 1
    s_lshl1_add_u32 s63, s63, s64
    s_and_b32 s65, s2, 0xe6
    s_lshl_b32 s64, s63, 11
    s_add_u32 s64, s64, 9633792
    s_lshl_b32 s63, s63, 2
    s_or_b32 s65, s65, s56
    s_cselect_b32 s64, 1073741824, s64
    s_cselect_b32 s63, 1073741824, s63
    s_lshl_b32 s65, s2, 10
    s_add_u32 s65, s65, 9502720
    s_cmp_eq_u32 s56, 1
    s_cselect_b32 s64, s65, s64
    s_cselect_b32 s65, 6, 7
    v_lshrrev_b32 v98, 2, v255
    v_and_b32 v99, 3, v255
    v_lshlrev_b32 v99, 4, v99
    v_lshl_add_u32 v98, v98, s65, v99
    v_add_u32 v102, s64, v98
    v_mov_b32 v108, s63
    v_mov_b32 v144, 0
    v_mov_b32 v145, 0
    v_mov_b32 v146, 0
    v_mov_b32 v147, 0
    buffer_store_dwordx4 v[144:147], v102, s[48:51], 0 offen sc1
    s_lshr_b32 s3, s2, 3
    s_and_b32 s63, s2, 7
    s_and_b32 s57, s2, 1
    s_lshl_b32 s57, s57, 3
    s_and_b32 s64, s3, 7
    s_add_u32 s57, s57, s64
    s_lshr_b32 s58, s63, 1
    s_lshr_b32 s59, s3, 3
    s_lshl_b32 s60, s63, 2
    s_and_b32 s64, s3, 3
    s_add_u32 s60, s60, s64
    s_lshr_b32 s61, s3, 2
    s_mov_b32 s52, s20
    s_mov_b32 s53, s21
    s_mov_b32 s54, 256
    s_mov_b32 s55, 0x20000
    s_mov_b32 s28, s6
    s_mov_b32 s29, s7
    s_mov_b32 s30, 1572864
    s_mov_b32 s31, 0x20000
    s_mov_b32 s44, s18
    s_mov_b32 s45, s19
    s_mov_b32 s46, 2097152
    s_mov_b32 s47, 0x20000
    s_lshl1_add_u32 s3, s57, s59
    s_lshl2_add_u32 s63, s3, s56
    s_mul_i32 s63, s63, 12288
    s_lshl_b32 s64, s58, 8
    s_add_u32 s63, s63, s64
    v_min_u32 v98, 5, v97
    v_and_b32 v99, 1, v98
    v_lshrrev_b32 v98, 1, v98
    v_lshl_add_u32 v98, v98, 3, v99
    v_and_b32 v99, 3, v96
    v_mul_u32_u24 v99, 3072, v99
    v_lshl_add_u32 v98, v98, 7, v99
    v_add_u32 v98, s63, v98
    buffer_load_dword a168, v98, s[28:31], 0 offen
    s_cmp_lt_u32 s56, 2
    s_cselect_b32 s32, s12, s14
    s_cselect_b32 s33, s13, s15
    s_mov_b32 s34, 1835008
    s_mov_b32 s35, 0x20000
    s_lshl2_add_u32 s63, s57, s56
    s_lshl_b32 s64, s63, 13
    s_lshl1_add_u32 s65, s58, s59
    s_mov_b32 s36, s8
    s_mov_b32 s37, s9
    s_mov_b32 s38, 524288
    s_mov_b32 s39, 0x20000
    s_lshl_b32 s79, s65, 7
    s_add_u32 s64, s64, s79
    v_lshrrev_b32 v98, 2, v255
    v_and_b32 v98, 4, v98
    v_xor_b32 v98, v98, v97
    v_lshlrev_b32 v98, 4, v98
    v_lshl_add_u32 v98, v96, 10, v98
    v_add_u32 v110, s64, v98
    s_mul_i32 s64, s65, 294912
    s_lshl_b32 s63, s63, 10
    s_add_u32 s64, s64, s63
    s_add_u32 s64, s64, 12816384
    s_lshl4_add_u32 s63, s65, s57
    s_and_b32 s65, s63, 7
    s_lshr_b32 s63, s63, 3
    s_lshl_b32 s63, s63, 7
    s_lshl2_add_u32 s63, s65, s63
    s_add_u32 s63, s63, 9644032
    s_cmp_eq_u32 s56, 0
    s_cselect_b32 s63, s63, 1073741824
    v_lshl_add_u32 v111, v255, 4, s64
    v_mov_b32 v232, 1073741824
    v_writelane_b32 v232, s63, 0
    s_lshr_b32 s63, s62, 2
    s_add_u32 m0, s63, 114688
    s_nop 0
    buffer_load_dwordx4 v110, s[36:39], 0 offen lds
    v_mov_b32 v241, 1
    s_mov_b32 s11, 23552
    s_mov_b32 s14, 27648
    s_mov_b32 s12, 47104
    s_mov_b32 s15, 55296
    s_mov_b32 s13, 70656
    s_mov_b32 s16, 82944
    v_lshrrev_b32 v224, 4, v255
    v_and_b32 v225, 7, v255
    v_xor_b32 v225, v224, v225
    v_lshrrev_b32 v224, 3, v255
    v_mul_u32_u24 v224, 3072, v224
    v_lshl_add_u32 v224, v225, 4, v224
    s_lshl_b32 s63, s58, 1
    s_add_u32 s63, s63, s59
    s_lshl_b32 s63, s63, 7
    s_lshr_b32 s64, s56, 1
    s_add_u32 s64, s64, 1
    s_lshl_b32 s64, s64, 10
    s_add_u32 s63, s63, s64
    s_and_b32 s64, s56, 1
    s_mul_i32 s64, s64, 98304
    s_add_u32 s63, s63, s64
    v_add_u32 v252, s63, v224
    s_lshr_b32 s3, s2, 1
    s_and_b32 s65, s2, 1
    s_lshl_b32 s63, s3, 15
    s_lshl_b32 s64, s56, 13
    s_add_u32 s63, s63, s64
    s_lshl_b32 s64, s65, 10
    s_add_u32 s63, s63, s64
    s_add_u32 s63, s63, 9666560
    v_lshrrev_b32 v98, 4, v255
    v_and_b32 v99, 2, v98
    v_xor_b32 v99, v99, v97
    v_lshlrev_b32 v99, 4, v99
    v_and_b32 v103, 15, v255
    v_lshl_add_u32 v99, v103, 7, v99
    v_and_b32 v98, 1, v98
    v_lshl_add_u32 v99, v98, 3, v99
    s_add_u32 s64, s62, 131072
    v_add_u32 v109, s64, v99
    v_xor_b32 v100, 64, v109
    v_xor_b32 v165, 16, v109
    v_xor_b32 v166, 16, v100
    v_lshl_add_u32 v101, v255, 4, s63
    v_lshlrev_b32 v103, 5, v103
    v_add_u32 v103, 151952, v103
    s_lshl_b32 s64, s56, 2
    v_lshrrev_b32 v99, 5, v255
    v_lshl_add_u32 v99, v99, 4, s64
    v_add_u32 v102, v99, v103
    s_lshl_b32 s63, s3, 7
    s_lshl_b32 s64, s65, 2
    s_add_u32 s63, s63, s64
    s_add_u32 s63, s63, 9633792
    s_cmp_eq_u32 s56, 0
    s_cselect_b32 s63, s63, 1073741824
    v_mov_b32 v98, 1073741824
    v_mov_b32 v99, s63
    v_cmp_eq_u32 vcc, 0, v255
    s_nop 1
    v_cndmask_b32 v104, v98, v99, vcc
    v_mov_b32 v158, 0x3f803f80
    v_mov_b32 v156, 0
    v_mov_b32 v157, 0
    s_mov_b32 s71, 4096
    s_lshl_b32 s63, s57, 2
    s_add_u32 s63, s63, s56
    s_lshl_b32 s64, s63, 7
    s_add_u32 s64, s64, 9633792
    v_and_b32 v244, 1, v255
    v_lshlrev_b32 v244, 2, v244
    v_add_u32 v105, s64, v244
    s_lshl_b32 s63, s63, 15
    s_add_u32 s63, s63, 9666560
    v_lshl_add_u32 v216, v255, 4, s63
    s_cmp_eq_u32 s56, 0
    s_cselect_b32 s63, 0, 1073741824
    s_cselect_b32 s65, 1, 0
    v_lshl_add_u32 v106, v97, 2, s63
    v_mov_b32 v107, s65
    v_lshrrev_b32 v224, 4, v255
    v_and_b32 v225, 7, v255
    v_xor_b32 v225, v224, v225
    v_lshrrev_b32 v224, 3, v255
    v_mul_u32_u24 v224, 3072, v224
    v_lshl_add_u32 v224, v225, 4, v224
    s_lshl_b32 s63, s58, 1
    s_add_u32 s63, s63, s59
    s_lshl_b32 s63, s63, 7
    s_mul_i32 s64, s56, 98304
    s_add_u32 s63, s63, s64
    v_add_u32 v239, s63, v224
    v_lshrrev_b32 v224, 4, v255
    v_and_b32 v225, 7, v255
    v_xor_b32 v225, v224, v225
    v_lshrrev_b32 v224, 3, v255
    v_mul_u32_u24 v224, 3584, v224
    v_lshl_add_u32 v224, v225, 4, v224
    s_lshl_b32 s64, s59, 7
    s_add_u32 s64, s64, 256
    s_mul_i32 s63, s58, 896
    s_add_u32 s63, s63, s64
    s_and_b32 s64, s56, 1
    s_mul_i32 s64, s64, 114688
    s_add_u32 s63, s63, s64
    v_add_u32 v238, s63, v224
    s_mov_b32 s17, 0xbfb8aa3b
    s_mul_i32 s9, s56, 28672
    s_lshl_b32 s10, s56, 13
    s_add_u32 s10, s10, 114688
    s_lshl_b32 s40, s9, 1
    s_lshl_b32 s41, s10, 1
    s_waitcnt vmcnt(3)
    ds_read_b64 v[112:113], v109
    ds_read_b64 v[114:115], v165
    ds_read_b64 v[116:117], v100
    ds_read_b64 v[118:119], v166
    ds_read_b64 v[120:121], v109 offset:2048
    ds_read_b64 v[122:123], v165 offset:2048
    ds_read_b64 v[124:125], v100 offset:2048
    ds_read_b64 v[126:127], v166 offset:2048
    s_waitcnt lgkmcnt(7)
    v_dot2c_f32_bf16 v156, v112, v158
    v_dot2c_f32_bf16 v157, v112, v112
    v_dot2c_f32_bf16 v156, v113, v158
    v_dot2c_f32_bf16 v157, v113, v113
    s_waitcnt lgkmcnt(6)
    v_dot2c_f32_bf16 v156, v114, v158
    v_dot2c_f32_bf16 v157, v114, v114
    v_dot2c_f32_bf16 v156, v115, v158
    v_dot2c_f32_bf16 v157, v115, v115
    s_waitcnt lgkmcnt(5)
    v_dot2c_f32_bf16 v156, v116, v158
    v_dot2c_f32_bf16 v157, v116, v116
    v_dot2c_f32_bf16 v156, v117, v158
    v_dot2c_f32_bf16 v157, v117, v117
    s_waitcnt lgkmcnt(4)
    v_dot2c_f32_bf16 v156, v118, v158
    v_dot2c_f32_bf16 v157, v118, v118
    v_dot2c_f32_bf16 v156, v119, v158
    v_dot2c_f32_bf16 v157, v119, v119
    s_waitcnt lgkmcnt(3)
    v_dot2c_f32_bf16 v156, v120, v158
    v_dot2c_f32_bf16 v157, v120, v120
    v_dot2c_f32_bf16 v156, v121, v158
    v_dot2c_f32_bf16 v157, v121, v121
    s_waitcnt lgkmcnt(2)
    v_dot2c_f32_bf16 v156, v122, v158
    v_dot2c_f32_bf16 v157, v122, v122
    v_dot2c_f32_bf16 v156, v123, v158
    v_dot2c_f32_bf16 v157, v123, v123
    s_waitcnt lgkmcnt(1)
    v_dot2c_f32_bf16 v156, v124, v158
    v_dot2c_f32_bf16 v157, v124, v124
    v_dot2c_f32_bf16 v156, v125, v158
    v_dot2c_f32_bf16 v157, v125, v125
    s_waitcnt lgkmcnt(0)
    v_dot2c_f32_bf16 v156, v126, v158
    v_dot2c_f32_bf16 v157, v126, v126
    v_dot2c_f32_bf16 v156, v127, v158
    v_dot2c_f32_bf16 v157, v127, v127
    v_lshlrev_b32 v128, 16, v112
    v_lshlrev_b32 v129, 16, v113
    v_lshlrev_b32 v130, 16, v114
    v_permlane32_swap_b32 v156, v157
    v_add_f32 v156, v156, v157
    v_mov_b32 v157, v156
    v_lshlrev_b32 v131, 16, v115
    v_lshlrev_b32 v132, 16, v116
    v_permlane16_swap_b32 v156, v157
    v_add_f32 v156, v156, v157
    ds_write_b32 v102, v156
    s_waitcnt vmcnt(2)
    buffer_store_dword v241, v108, s[52:55], 0 offen sc1
    v_lshlrev_b32 v133, 16, v117
    v_lshlrev_b32 v134, 16, v118
    v_lshlrev_b32 v135, 16, v119
    v_lshlrev_b32 v136, 16, v120
    v_lshlrev_b32 v137, 16, v121
    v_lshlrev_b32 v138, 16, v122
    v_lshlrev_b32 v139, 16, v123
    v_lshlrev_b32 v140, 16, v124
    v_lshlrev_b32 v141, 16, v125
    v_lshlrev_b32 v142, 16, v126
    v_lshlrev_b32 v143, 16, v127
    s_waitcnt lgkmcnt(0)
    s_barrier
    ds_read_b128 v[148:151], v103
    ds_read_b128 v[152:155], v103 offset:16
    v_and_b32 v112, 0xffff0000, v112
    v_and_b32 v113, 0xffff0000, v113
    v_and_b32 v114, 0xffff0000, v114
    v_and_b32 v115, 0xffff0000, v115
    v_and_b32 v116, 0xffff0000, v116
    v_and_b32 v117, 0xffff0000, v117
    v_and_b32 v118, 0xffff0000, v118
    v_and_b32 v119, 0xffff0000, v119
    v_and_b32 v120, 0xffff0000, v120
    v_and_b32 v121, 0xffff0000, v121
    v_and_b32 v122, 0xffff0000, v122
    v_and_b32 v123, 0xffff0000, v123
    v_and_b32 v124, 0xffff0000, v124
    v_and_b32 v125, 0xffff0000, v125
    v_and_b32 v126, 0xffff0000, v126
    v_and_b32 v127, 0xffff0000, v127
    s_waitcnt lgkmcnt(1)
    v_pk_add_f32 v[148:149], v[148:149], v[150:151]
    s_waitcnt lgkmcnt(0)
    v_pk_add_f32 v[152:153], v[152:153], v[154:155]
    v_add_f32 v156, v148, v149
    v_add_f32 v157, v152, v153
    v_mul_f32 v156, 0x3b000000, v156
    v_mul_f32 v157, 0x3b000000, v157
    v_fma_f32 v157, -v156, v156, v157
    v_max_f32 v157, 0, v157
    v_cvt_pk_bf16_f32 v157, v157, v156
    v_and_b32 v156, 0xffff0000, v157
    v_lshlrev_b32 v157, 16, v157
    v_add_f32 v157, 0x3727c5ac, v157
    v_cvt_pk_bf16_f32 v157, v157, v157
    v_lshlrev_b32 v157, 16, v157
    v_sqrt_f32 v157, v157
    s_nop 0
    v_cvt_pk_bf16_f32 v157, v157, v157
    v_lshlrev_b32 v157, 16, v157
    v_rcp_f32 v161, v157
    s_nop 0
    v_mul_f32 v160, -v156, v161
    v_pk_fma_f32 v[128:129], v[128:129], v[160:161], v[160:161] op_sel:[0,1,0] op_sel_hi:[1,1,0]
    v_pk_fma_f32 v[130:131], v[130:131], v[160:161], v[160:161] op_sel:[0,1,0] op_sel_hi:[1,1,0]
    v_pk_fma_f32 v[112:113], v[112:113], v[160:161], v[160:161] op_sel:[0,1,0] op_sel_hi:[1,1,0]
    v_pk_fma_f32 v[114:115], v[114:115], v[160:161], v[160:161] op_sel:[0,1,0] op_sel_hi:[1,1,0]
    v_cvt_pk_bf16_f32 v112, v128, v112
    v_cvt_pk_bf16_f32 v113, v129, v113
    v_cvt_pk_bf16_f32 v114, v130, v114
    v_cvt_pk_bf16_f32 v115, v131, v115
    buffer_store_dwordx4 v[112:115], v101, s[48:51], 0 offen sc1
    v_pk_fma_f32 v[132:133], v[132:133], v[160:161], v[160:161] op_sel:[0,1,0] op_sel_hi:[1,1,0]
    v_pk_fma_f32 v[134:135], v[134:135], v[160:161], v[160:161] op_sel:[0,1,0] op_sel_hi:[1,1,0]
    v_pk_fma_f32 v[116:117], v[116:117], v[160:161], v[160:161] op_sel:[0,1,0] op_sel_hi:[1,1,0]
    v_pk_fma_f32 v[118:119], v[118:119], v[160:161], v[160:161] op_sel:[0,1,0] op_sel_hi:[1,1,0]
    v_cvt_pk_bf16_f32 v116, v132, v116
    v_cvt_pk_bf16_f32 v117, v133, v117
    v_cvt_pk_bf16_f32 v118, v134, v118
    v_cvt_pk_bf16_f32 v119, v135, v119
    buffer_store_dwordx4 v[116:119], v101, s[48:51], 0 offen offset:2048 sc1
    v_pk_fma_f32 v[136:137], v[136:137], v[160:161], v[160:161] op_sel:[0,1,0] op_sel_hi:[1,1,0]
    v_pk_fma_f32 v[138:139], v[138:139], v[160:161], v[160:161] op_sel:[0,1,0] op_sel_hi:[1,1,0]
    v_pk_fma_f32 v[120:121], v[120:121], v[160:161], v[160:161] op_sel:[0,1,0] op_sel_hi:[1,1,0]
    v_pk_fma_f32 v[122:123], v[122:123], v[160:161], v[160:161] op_sel:[0,1,0] op_sel_hi:[1,1,0]
    v_cvt_pk_bf16_f32 v120, v136, v120
    v_cvt_pk_bf16_f32 v121, v137, v121
    v_cvt_pk_bf16_f32 v122, v138, v122
    v_cvt_pk_bf16_f32 v123, v139, v123
    buffer_store_dwordx4 v[120:123], v101, s[48:51], s71 offen sc1
    v_pk_fma_f32 v[140:141], v[140:141], v[160:161], v[160:161] op_sel:[0,1,0] op_sel_hi:[1,1,0]
    v_pk_fma_f32 v[142:143], v[142:143], v[160:161], v[160:161] op_sel:[0,1,0] op_sel_hi:[1,1,0]
    v_pk_fma_f32 v[124:125], v[124:125], v[160:161], v[160:161] op_sel:[0,1,0] op_sel_hi:[1,1,0]
    v_pk_fma_f32 v[126:127], v[126:127], v[160:161], v[160:161] op_sel:[0,1,0] op_sel_hi:[1,1,0]
    v_cvt_pk_bf16_f32 v124, v140, v124
    v_cvt_pk_bf16_f32 v125, v141, v125
    v_cvt_pk_bf16_f32 v126, v142, v126
    v_cvt_pk_bf16_f32 v127, v143, v127
    buffer_store_dwordx4 v[124:127], v101, s[48:51], s71 offen offset:2048 sc1
    v_bfe_u32 v224, v255, 2, 3
    v_and_b32 v225, 32, v255
    v_lshrrev_b32 v225, 1, v225
    v_add_u32 v225, v225, v224
    v_and_b32 v226, 1, v255
    v_lshlrev_b32 v226, 3, v226
    v_and_b32 v227, 2, v255
    v_lshl_add_u32 v254, v225, 7, v226
    v_lshl_add_u32 v254, v227, 5, v254
    v_lshrrev_b32 v224, 1, v224
    v_lshl_add_u32 v254, v224, 4, v254
    v_xor_b32 v253, 16, v254
    v_xor_b32 v230, 32, v254
    v_xor_b32 v231, 48, v254
    s_lshl_b32 s63, s58, 1
    s_add_u32 s63, s63, s59
    s_lshl_b32 s63, s63, 12
    s_add_u32 s5, s63, 114688
    s_mul_i32 s6, s58, 28672
    s_lshl_b32 s63, s59, 12
    s_add_u32 s63, s63, 8192
    s_add_u32 s6, s6, s63
    v_and_b32 v224, 15, v255
    v_mul_u32_u24 v224, 272, v224
    v_and_b32 v225, 48, v255
    v_lshlrev_b32 v225, 1, v225
    s_mul_i32 s3, s56, 8704
    s_add_u32 s3, s3, 114688
    v_add3_u32 v250, s3, v224, v225
    v_and_b32 v224, 3, v255
    v_bfe_u32 v249, v255, 2, 2
    v_lshl_add_u32 v224, v224, 2, v249
    v_mul_u32_u24 v224, 272, v224
    v_add3_u32 v249, s3, v224, v225
    s_mov_b32 s3, 149632
    v_lshl_add_u32 v236, v255, 4, s3
    s_lshl_b32 s63, s57, 3
    s_lshl_b32 s64, s58, 1
    s_add_u32 s63, s63, s64
    s_add_u32 s63, s63, s59
    s_lshl_b32 s8, s63, 11
    s_add_u32 s8, s8, 11763712
    s_cmp_eq_u32 s56, 3
    s_cselect_b32 s63, s8, 1073741824
    s_cselect_b32 s18, 0, 1073741824
    v_lshl_add_u32 v245, v255, 4, s63
    s_and_b32 s63, s57, 7
    s_or_b32 s64, s63, s56
    s_cselect_b32 s66, 0, 0xf000f
    s_cselect_b32 s68, 0, 0xff00ff
    s_mov_b32 s67, s66
    s_mov_b32 s69, s68
    s_mov_b32 s70, 151952
    s_cmp_eq_u32 s56, 0
    s_cselect_b32 s70, 114816, s70
    s_cselect_b32 s63, s63, 0
    s_cmp_lg_u32 s63, 0
    s_cselect_b32 s78, 1, 0
    s_sub_u32 s64, s8, 16384
    s_cmp_lg_u32 s78, 0
    s_cselect_b32 s64, s64, 1073741824
    v_lshl_add_u32 v247, v255, 4, s64
    s_lshl_b32 s63, s57, 3
    s_add_u32 s63, s63, s58
    s_lshl_b32 s63, s63, 10
    s_lshl_b32 s64, s59, 3
    s_add_u32 s63, s63, s64
    s_add_u32 s63, s63, 9498628
    s_cmp_lg_u32 s78, 0
    s_cselect_b32 s63, s63, 1073741824
    v_mov_b32 v246, s63
    s_mov_b32 s7, 0x3eb8aa3b
    v_and_b32 v224, 3, v255
    v_mov_b32 v225, 0xffff
    v_cmp_le_u32 s[72:73], 1, v224
    v_cmp_le_u32 s[74:75], 2, v224
    v_cmp_le_u32 s[76:77], 3, v224
    v_cndmask_b32 v234, v225, -1, s[72:73]
    v_cndmask_b32 v233, 0, v225, s[74:75]
    v_cndmask_b32 v233, v233, -1, s[76:77]
    s_lshl_b32 s63, s57, 2
    s_add_u32 s63, s63, s56
    s_mul_i32 s64, s63, 148480
    v_and_b32 v224, 16, v255
    v_lshlrev_b32 v224, 1, v224
    v_and_or_b32 v224, v255, 15, v224
    v_lshl_add_u32 v224, v224, 4, s64
    v_and_b32 v225, 32, v255
    v_lshl_add_u32 v251, v225, 6, v224
    s_lshr_b32 s63, s63, 1
    s_lshl_b32 s63, s63, 2
    s_add_u32 s63, s63, s58
    s_lshl_b32 s63, s63, 10
    s_and_b32 s64, s56, 1
    s_lshl_b32 s65, s59, 1
    s_add_u32 s64, s64, s65
    s_lshl_b32 s64, s64, 2
    s_add_u32 s63, s63, s64
    s_add_u32 s63, s63, 9502720
    v_mov_b32 v224, 1073741824
    v_mov_b32 v225, s63
    v_cmp_eq_u32 vcc, 0, v255
    s_nop 1
    v_cndmask_b32 v248, v224, v225, vcc
    v_add_u32 v223, s18, v248
    s_lshl_b32 s63, s60, 1
    s_lshr_b32 s64, s56, 1
    s_add_u32 s63, s63, s64
    s_mul_i32 s20, s63, 148480
    s_xor_b32 s64, s63, 1
    s_mul_i32 s23, s64, 148480
    s_lshl_b32 s63, s63, 5
    s_and_b32 s64, s63, 1023
    s_lshl_b32 s64, s64, 11
    s_lshr_b32 s63, s63, 10
    s_lshl_b32 s63, s63, 10
    s_add_u32 s63, s63, s64
    s_lshl_b32 s64, s61, 7
    s_add_u32 s63, s63, s64
    s_and_b32 s64, s56, 1
    s_lshl_b32 s64, s64, 6
    s_add_u32 s22, s63, s64
    s_lshl_b32 s63, s60, 2
    s_add_u32 s63, s63, s56
    s_lshl_b32 s63, s63, 10
    s_add_u32 s21, s63, 9502720
    s_mul_i32 s63, s61, 294912
    s_add_u32 s63, s63, 12587008
    s_lshl_b32 s64, s64, 4
    s_add_u32 s65, s63, s64
    v_lshl_add_u32 v243, v255, 4, s65
    s_sub_u32 s65, s63, s64
    v_lshl_add_u32 v240, v255, 4, s65
    v_lshl_add_u32 v237, v255, 4, s62
    s_lshl_b32 s63, s61, 8
    s_add_u32 s63, s63, 9646080
    s_lshl_b32 s64, s58, 9
    s_add_u32 s64, s64, 9644032
    s_lshr_b32 s65, s61, 1
    s_xor_b32 s65, s65, 1
    s_lshl_b32 s65, s65, 9
    s_add_u32 s65, s65, 9644032
    s_cmp_eq_u32 s56, 0
    s_cselect_b32 s63, s63, 1073741824
    s_cselect_b32 s64, s64, 1073741824
    s_cselect_b32 s65, s65, 1073741824
    s_cselect_b32 s43, 1, 0
    v_and_b32 v224, 24, v255
    v_lshlrev_b32 v224, 2, v224
    v_and_or_b32 v224, v255, 7, v224
    v_and_b32 v225, 63, v224
    v_lshl_add_u32 v225, v225, 2, s63
    v_lshl_add_u32 v235, v224, 2, s65
    v_cmp_lt_u32 vcc, 31, v255
    s_nop 1
    v_cndmask_b32 v235, v235, v225, vcc
    buffer_load_dword v242, v106, s[52:55], 0 offen sc1
    v_bfe_u32 v98, v255, 2, 2
    v_lshrrev_b32 v99, 5, v255
    v_lshl_add_u32 v163, v99, 4, v98
    v_lshlrev_b32 v163, 7, v163
    v_lshrrev_b32 v98, 1, v98
    v_lshl_add_u32 v163, v98, 6, v163
    v_and_b32 v98, 1, v255
    v_lshl_add_u32 v163, v98, 5, v163
    v_and_or_b32 v163, v255, 16, v163
    v_and_b32 v98, 2, v255
    v_lshl_add_u32 v163, v98, 2, v163
    s_and_b32 s63, s56, 1
    s_lshl_b32 s63, s63, 6
    v_xor_b32 v163, s63, v163
    s_lshr_b32 s63, s56, 1
    s_lshl_b32 s63, s63, 10
    s_add_u32 s63, s63, 114688
    v_add_u32 v163, s63, v163
    s_waitcnt vmcnt(0)
    v_cmp_gt_u32 vcc, v107, v242
    s_cbranch_vccnz L_B_p1_slow
L_B_p1_ok:
    s_barrier
    buffer_store_dword v241, v104, s[48:51], 0 offen sc1
    s_add_u32 m0, s62, 0
    s_nop 0
    buffer_load_dwordx4 v252, s[28:31], 0 offen lds
    buffer_load_dwordx4 v252, s[28:31], s11 offen offset:1024 lds
    buffer_load_dwordx4 v252, s[28:31], s12 offen offset:2048 lds
    buffer_load_dwordx4 v252, s[28:31], s13 offen offset:3072 lds
    s_add_u32 m0, s62, 16384
    v_add_u32 v252, 196608, v252
    buffer_load_dwordx4 v252, s[28:31], 0 offen lds
    buffer_load_dwordx4 v252, s[28:31], s11 offen offset:1024 lds
    buffer_load_dwordx4 v252, s[28:31], s12 offen offset:2048 lds
    buffer_load_dwordx4 v252, s[28:31], s13 offen offset:3072 lds
    v_mov_b32 v242, 15
    s_bfm_b64 exec, 2, 0
    v_mov_b32 v242, 0
    buffer_atomic_add v242, v105, s[48:51], 0 offen offset:0 sc0 sc1
    s_mov_b64 exec, -1
    s_add_u32 m0, s62, 32768
    v_add_u32 v252, 196608, v252
    buffer_load_dwordx4 v252, s[28:31], 0 offen lds
    buffer_load_dwordx4 v252, s[28:31], s11 offen offset:1024 lds
    buffer_load_dwordx4 v252, s[28:31], s12 offen offset:2048 lds
    buffer_load_dwordx4 v252, s[28:31], s13 offen offset:3072 lds
    s_add_u32 m0, s62, 49152
    v_add_u32 v252, 196608, v252
    buffer_load_dwordx4 v252, s[28:31], 0 offen lds
    buffer_load_dwordx4 v252, s[28:31], s11 offen offset:1024 lds
    buffer_load_dwordx4 v252, s[28:31], s12 offen offset:2048 lds
    buffer_load_dwordx4 v252, s[28:31], s13 offen offset:3072 lds
    s_waitcnt vmcnt(8)
    v_cmp_gt_u32 vcc, 1, v242
    s_cbranch_vccnz L_B_p2_slow
L_B_p2_ok:
    s_mov_b32 s71, 0
    buffer_load_dwordx4 a[0:3], v216, s[48:51], s71 offen sc1
    buffer_load_dwordx4 a[4:7], v216, s[48:51], s71 offen offset:1024 sc1
    buffer_load_dwordx4 a[8:11], v216, s[48:51], s71 offen offset:2048 sc1
    buffer_load_dwordx4 a[12:15], v216, s[48:51], s71 offen offset:3072 sc1
    s_barrier
    ds_read_b64_tr_b16 v[168:169], v163
    ds_read_b64_tr_b16 v[170:171], v163 offset:512
    ds_read_b64_tr_b16 a[128:129], v254
    ds_read_b64_tr_b16 a[130:131], v254 offset:1024
    ds_read_b64_tr_b16 a[132:133], v254 offset:4096
    ds_read_b64_tr_b16 a[134:135], v254 offset:5120
    s_mov_b32 s71, 4096
    buffer_load_dwordx4 a[16:19], v216, s[48:51], s71 offen sc1
    ds_read_b64_tr_b16 a[136:137], v254 offset:8192
    ds_read_b64_tr_b16 a[138:139], v254 offset:9216
    ds_read_b64_tr_b16 a[140:141], v254 offset:12288
    ds_read_b64_tr_b16 a[142:143], v254 offset:13312
    buffer_load_dwordx4 a[20:23], v216, s[48:51], s71 offen offset:1024 sc1
    ds_read_b64_tr_b16 a[144:145], v253
    ds_read_b64_tr_b16 a[146:147], v253 offset:1024
    ds_read_b64_tr_b16 a[148:149], v253 offset:4096
    ds_read_b64_tr_b16 a[150:151], v253 offset:5120
    buffer_load_dwordx4 a[24:27], v216, s[48:51], s71 offen offset:2048 sc1
    ds_read_b64_tr_b16 a[152:153], v253 offset:8192
    ds_read_b64_tr_b16 a[154:155], v253 offset:9216
    ds_read_b64_tr_b16 a[156:157], v253 offset:12288
    ds_read_b64_tr_b16 a[158:159], v253 offset:13312
    buffer_load_dwordx4 a[28:31], v216, s[48:51], s71 offen offset:3072 sc1
    s_waitcnt lgkmcnt(8)
    s_waitcnt vmcnt(7)
    v_mfma_f32_16x16x32_bf16 v[0:3], a[128:131], a[0:3], 0
    buffer_store_dwordx4 v[168:171], v111, s[48:51], 0 offen sc1
    s_waitcnt vmcnt(6)
    v_mfma_f32_16x16x32_bf16 v[0:3], a[132:135], a[8:11], v[0:3]
    ds_read_b64_tr_b16 a[160:161], v230
    ds_read_b64_tr_b16 a[162:163], v230 offset:1024
    s_waitcnt vmcnt(5)
    v_mfma_f32_16x16x32_bf16 v[32:35], a[132:135], a[12:15], 0
    ds_read_b64_tr_b16 a[164:165], v230 offset:4096
    s_add_u32 m0, s62, 65536
    v_mfma_f32_16x16x32_bf16 v[32:35], a[128:131], a[4:7], v[32:35]
    ds_read_b64_tr_b16 a[166:167], v230 offset:5120
    v_add_u32 v252, 196608, v252
    v_mfma_f32_16x16x32_bf16 v[16:19], a[136:139], a[0:3], 0
    ds_read_b64_tr_b16 a[128:129], v230 offset:8192
    ds_read_b64_tr_b16 a[130:131], v230 offset:9216
    s_mov_b32 s71, 8192
    v_mfma_f32_16x16x32_bf16 v[16:19], a[140:143], a[8:11], v[16:19]
    buffer_load_dwordx4 a[32:35], v216, s[48:51], s71 offen sc1
    v_mfma_f32_16x16x32_bf16 v[48:51], a[140:143], a[12:15], 0
    buffer_load_dwordx4 v252, s[28:31], 0 offen lds
    v_mfma_f32_16x16x32_bf16 v[48:51], a[136:139], a[4:7], v[48:51]
    ds_read_b64_tr_b16 a[132:133], v230 offset:12288
    ds_read_b64_tr_b16 a[134:135], v230 offset:13312
    s_waitcnt lgkmcnt(8)
    v_mfma_f32_16x16x32_bf16 v[4:7], a[144:147], a[0:3], 0
    buffer_load_dwordx4 a[36:39], v216, s[48:51], s71 offen offset:1024 sc1
    v_mfma_f32_16x16x32_bf16 v[4:7], a[148:151], a[8:11], v[4:7]
    ds_read_b64_tr_b16 a[136:137], v231
    ds_read_b64_tr_b16 a[138:139], v231 offset:1024
    v_mfma_f32_16x16x32_bf16 v[36:39], a[148:151], a[12:15], 0
    ds_read_b64_tr_b16 a[140:141], v231 offset:4096
    buffer_load_dwordx4 v252, s[28:31], s11 offen offset:1024 lds
    v_mfma_f32_16x16x32_bf16 v[36:39], a[144:147], a[4:7], v[36:39]
    ds_read_b64_tr_b16 a[142:143], v231 offset:5120
    buffer_load_dwordx4 v252, s[28:31], s12 offen offset:2048 lds
    v_mfma_f32_16x16x32_bf16 v[20:23], a[152:155], a[0:3], 0
    buffer_load_dwordx4 v252, s[28:31], s13 offen offset:3072 lds
    v_mfma_f32_16x16x32_bf16 v[20:23], a[156:159], a[8:11], v[20:23]
    ds_read_b64_tr_b16 a[144:145], v231 offset:8192
    ds_read_b64_tr_b16 a[146:147], v231 offset:9216
    v_mfma_f32_16x16x32_bf16 v[52:55], a[156:159], a[12:15], 0
    ds_read_b64_tr_b16 a[148:149], v231 offset:12288
    v_mfma_f32_16x16x32_bf16 v[52:55], a[152:155], a[4:7], v[52:55]
    ds_read_b64_tr_b16 a[150:151], v231 offset:13312
    s_barrier
    s_waitcnt lgkmcnt(8)
    v_mfma_f32_16x16x32_bf16 v[8:11], a[160:163], a[0:3], 0
    ds_read_b64_tr_b16 a[152:153], v254 offset:16384
    s_add_u32 m0, s62, 81920
    v_mfma_f32_16x16x32_bf16 v[8:11], a[164:167], a[8:11], v[8:11]
    ds_read_b64_tr_b16 a[154:155], v254 offset:17408
    v_add_u32 v252, 196608, v252
    v_mfma_f32_16x16x32_bf16 v[40:43], a[164:167], a[12:15], 0
    buffer_load_dwordx4 a[40:43], v216, s[48:51], s71 offen offset:2048 sc1
    v_mfma_f32_16x16x32_bf16 v[40:43], a[160:163], a[4:7], v[40:43]
    ds_read_b64_tr_b16 a[156:157], v254 offset:20480
    ds_read_b64_tr_b16 a[158:159], v254 offset:21504
    v_mfma_f32_16x16x32_bf16 v[24:27], a[128:131], a[0:3], 0
    ds_read_b64_tr_b16 a[160:161], v254 offset:24576
    v_mfma_f32_16x16x32_bf16 v[24:27], a[132:135], a[8:11], v[24:27]
    ds_read_b64_tr_b16 a[162:163], v254 offset:25600
    v_mfma_f32_16x16x32_bf16 v[56:59], a[132:135], a[12:15], 0
    buffer_load_dwordx4 v252, s[28:31], 0 offen lds
    v_mfma_f32_16x16x32_bf16 v[56:59], a[128:131], a[4:7], v[56:59]
    ds_read_b64_tr_b16 a[164:165], v254 offset:28672
    ds_read_b64_tr_b16 a[166:167], v254 offset:29696
    s_waitcnt lgkmcnt(8)
    v_mfma_f32_16x16x32_bf16 v[12:15], a[136:139], a[0:3], 0
    ds_read_b64_tr_b16 a[128:129], v253 offset:16384
    v_mfma_f32_16x16x32_bf16 v[12:15], a[140:143], a[8:11], v[12:15]
    ds_read_b64_tr_b16 a[130:131], v253 offset:17408
    v_mfma_f32_16x16x32_bf16 v[44:47], a[140:143], a[12:15], 0
    buffer_load_dwordx4 a[44:47], v216, s[48:51], s71 offen offset:3072 sc1
    v_mfma_f32_16x16x32_bf16 v[44:47], a[136:139], a[4:7], v[44:47]
    ds_read_b64_tr_b16 a[132:133], v253 offset:20480
    ds_read_b64_tr_b16 a[134:135], v253 offset:21504
    v_mfma_f32_16x16x32_bf16 v[28:31], a[144:147], a[0:3], 0
    buffer_load_dwordx4 v252, s[28:31], s11 offen offset:1024 lds
    v_mfma_f32_16x16x32_bf16 v[28:31], a[148:151], a[8:11], v[28:31]
    ds_read_b64_tr_b16 a[136:137], v253 offset:24576
    ds_read_b64_tr_b16 a[138:139], v253 offset:25600
    v_mfma_f32_16x16x32_bf16 v[60:63], a[148:151], a[12:15], 0
    ds_read_b64_tr_b16 a[140:141], v253 offset:28672
    s_mov_b32 s71, 12288
    v_mfma_f32_16x16x32_bf16 v[60:63], a[144:147], a[4:7], v[60:63]
    ds_read_b64_tr_b16 a[142:143], v253 offset:29696
    s_waitcnt lgkmcnt(8)
    s_waitcnt vmcnt(14)
    v_mfma_f32_16x16x32_bf16 v[0:3], a[152:155], a[16:19], v[0:3]
    ds_read_b64_tr_b16 a[144:145], v230 offset:16384
    s_waitcnt vmcnt(12)
    v_mfma_f32_16x16x32_bf16 v[0:3], a[156:159], a[24:27], v[0:3]
    ds_read_b64_tr_b16 a[146:147], v230 offset:17408
    s_waitcnt vmcnt(11)
    v_mfma_f32_16x16x32_bf16 v[32:35], a[156:159], a[28:31], v[32:35]
    buffer_load_dwordx4 a[48:51], v216, s[48:51], s71 offen sc1
    v_mfma_f32_16x16x32_bf16 v[32:35], a[152:155], a[20:23], v[32:35]
    ds_read_b64_tr_b16 a[148:149], v230 offset:20480
    ds_read_b64_tr_b16 a[150:151], v230 offset:21504
    v_mfma_f32_16x16x32_bf16 v[16:19], a[160:163], a[16:19], v[16:19]
    buffer_load_dwordx4 v252, s[28:31], s12 offen offset:2048 lds
    v_mfma_f32_16x16x32_bf16 v[16:19], a[164:167], a[24:27], v[16:19]
    ds_read_b64_tr_b16 a[152:153], v230 offset:24576
    ds_read_b64_tr_b16 a[154:155], v230 offset:25600
    v_mfma_f32_16x16x32_bf16 v[48:51], a[164:167], a[28:31], v[48:51]
    ds_read_b64_tr_b16 a[156:157], v230 offset:28672
    v_mfma_f32_16x16x32_bf16 v[48:51], a[160:163], a[20:23], v[48:51]
    ds_read_b64_tr_b16 a[158:159], v230 offset:29696
    s_waitcnt lgkmcnt(8)
    v_mfma_f32_16x16x32_bf16 v[4:7], a[128:131], a[16:19], v[4:7]
    buffer_load_dwordx4 a[52:55], v216, s[48:51], s71 offen offset:1024 sc1
    v_mfma_f32_16x16x32_bf16 v[4:7], a[132:135], a[24:27], v[4:7]
    ds_read_b64_tr_b16 a[160:161], v231 offset:16384
    ds_read_b64_tr_b16 a[162:163], v231 offset:17408
    v_mfma_f32_16x16x32_bf16 v[36:39], a[132:135], a[28:31], v[36:39]
    ds_read_b64_tr_b16 a[164:165], v231 offset:20480
    v_mfma_f32_16x16x32_bf16 v[36:39], a[128:131], a[20:23], v[36:39]
    ds_read_b64_tr_b16 a[166:167], v231 offset:21504
    v_mfma_f32_16x16x32_bf16 v[20:23], a[136:139], a[16:19], v[20:23]
    buffer_load_dwordx4 v252, s[28:31], s13 offen offset:3072 lds
    v_mfma_f32_16x16x32_bf16 v[20:23], a[140:143], a[24:27], v[20:23]
    ds_read_b64_tr_b16 a[128:129], v231 offset:24576
    ds_read_b64_tr_b16 a[130:131], v231 offset:25600
    v_mfma_f32_16x16x32_bf16 v[52:55], a[140:143], a[28:31], v[52:55]
    ds_read_b64_tr_b16 a[132:133], v231 offset:28672
    v_mfma_f32_16x16x32_bf16 v[52:55], a[136:139], a[20:23], v[52:55]
    ds_read_b64_tr_b16 a[134:135], v231 offset:29696
    s_waitcnt vmcnt(14)
    s_barrier
    s_waitcnt lgkmcnt(8)
    v_mfma_f32_16x16x32_bf16 v[8:11], a[144:147], a[16:19], v[8:11]
    buffer_store_dword v241, v232, s[48:51], 0 offen offset:2048 sc1
    v_mfma_f32_16x16x32_bf16 v[8:11], a[148:151], a[24:27], v[8:11]
    ds_read_b64_tr_b16 a[136:137], v254 offset:32768
    ds_read_b64_tr_b16 a[138:139], v254 offset:33792
    v_mfma_f32_16x16x32_bf16 v[40:43], a[148:151], a[28:31], v[40:43]
    ds_read_b64_tr_b16 a[140:141], v254 offset:36864
    s_add_u32 m0, s62, 98304
    v_mfma_f32_16x16x32_bf16 v[40:43], a[144:147], a[20:23], v[40:43]
    ds_read_b64_tr_b16 a[142:143], v254 offset:37888
    v_add_u32 v252, 196608, v252
    v_mfma_f32_16x16x32_bf16 v[24:27], a[152:155], a[16:19], v[24:27]
    buffer_load_dwordx4 a[56:59], v216, s[48:51], s71 offen offset:2048 sc1
    v_mfma_f32_16x16x32_bf16 v[24:27], a[156:159], a[24:27], v[24:27]
    ds_read_b64_tr_b16 a[144:145], v254 offset:40960
    ds_read_b64_tr_b16 a[146:147], v254 offset:41984
    v_mfma_f32_16x16x32_bf16 v[56:59], a[156:159], a[28:31], v[56:59]
    buffer_load_dwordx4 v252, s[28:31], 0 offen lds
    v_mfma_f32_16x16x32_bf16 v[56:59], a[152:155], a[20:23], v[56:59]
    ds_read_b64_tr_b16 a[148:149], v254 offset:45056
    ds_read_b64_tr_b16 a[150:151], v254 offset:46080
    s_waitcnt lgkmcnt(8)
    v_mfma_f32_16x16x32_bf16 v[12:15], a[160:163], a[16:19], v[12:15]
    buffer_load_dwordx4 a[60:63], v216, s[48:51], s71 offen offset:3072 sc1
    v_mfma_f32_16x16x32_bf16 v[12:15], a[164:167], a[24:27], v[12:15]
    ds_read_b64_tr_b16 a[152:153], v253 offset:32768
    ds_read_b64_tr_b16 a[154:155], v253 offset:33792
    v_mfma_f32_16x16x32_bf16 v[44:47], a[164:167], a[28:31], v[44:47]
    ds_read_b64_tr_b16 a[156:157], v253 offset:36864
    v_mfma_f32_16x16x32_bf16 v[44:47], a[160:163], a[20:23], v[44:47]
    ds_read_b64_tr_b16 a[158:159], v253 offset:37888
    v_mfma_f32_16x16x32_bf16 v[28:31], a[128:131], a[16:19], v[28:31]
    buffer_load_dwordx4 v252, s[28:31], s11 offen offset:1024 lds
    v_mfma_f32_16x16x32_bf16 v[28:31], a[132:135], a[24:27], v[28:31]
    ds_read_b64_tr_b16 a[160:161], v253 offset:40960
    ds_read_b64_tr_b16 a[162:163], v253 offset:41984
    v_mfma_f32_16x16x32_bf16 v[60:63], a[132:135], a[28:31], v[60:63]
    ds_read_b64_tr_b16 a[164:165], v253 offset:45056
    ds_read_b64_tr_b16 a[166:167], v253 offset:46080
    s_mov_b32 s71, 16384
    v_mfma_f32_16x16x32_bf16 v[60:63], a[128:131], a[20:23], v[60:63]
    buffer_load_dwordx4 a[64:67], v216, s[48:51], s71 offen sc1
    s_waitcnt lgkmcnt(8)
    s_waitcnt vmcnt(19)
    v_mfma_f32_16x16x32_bf16 v[0:3], a[136:139], a[32:35], v[0:3]
    ds_read_b64_tr_b16 a[128:129], v230 offset:32768
    s_waitcnt vmcnt(13)
    v_mfma_f32_16x16x32_bf16 v[0:3], a[140:143], a[40:43], v[0:3]
    ds_read_b64_tr_b16 a[130:131], v230 offset:33792
    s_waitcnt vmcnt(11)
    v_mfma_f32_16x16x32_bf16 v[32:35], a[140:143], a[44:47], v[32:35]
    buffer_load_dwordx4 v252, s[28:31], s12 offen offset:2048 lds
    v_mfma_f32_16x16x32_bf16 v[32:35], a[136:139], a[36:39], v[32:35]
    ds_read_b64_tr_b16 a[132:133], v230 offset:36864
    ds_read_b64_tr_b16 a[134:135], v230 offset:37888
    v_mfma_f32_16x16x32_bf16 v[16:19], a[144:147], a[32:35], v[16:19]
    buffer_load_dwordx4 a[68:71], v216, s[48:51], s71 offen offset:1024 sc1
    v_mfma_f32_16x16x32_bf16 v[16:19], a[148:151], a[40:43], v[16:19]
    ds_read_b64_tr_b16 a[136:137], v230 offset:40960
    ds_read_b64_tr_b16 a[138:139], v230 offset:41984
    v_mfma_f32_16x16x32_bf16 v[48:51], a[148:151], a[44:47], v[48:51]
    buffer_load_dwordx4 v252, s[28:31], s13 offen offset:3072 lds
    v_mfma_f32_16x16x32_bf16 v[48:51], a[144:147], a[36:39], v[48:51]
    ds_read_b64_tr_b16 a[140:141], v230 offset:45056
    ds_read_b64_tr_b16 a[142:143], v230 offset:46080
    s_waitcnt lgkmcnt(8)
    v_mfma_f32_16x16x32_bf16 v[4:7], a[152:155], a[32:35], v[4:7]
    ds_read_b64_tr_b16 a[144:145], v231 offset:32768
    v_mfma_f32_16x16x32_bf16 v[4:7], a[156:159], a[40:43], v[4:7]
    ds_read_b64_tr_b16 a[146:147], v231 offset:33792
    v_mfma_f32_16x16x32_bf16 v[36:39], a[156:159], a[44:47], v[36:39]
    buffer_load_dwordx4 a[72:75], v216, s[48:51], s71 offen offset:2048 sc1
    v_mfma_f32_16x16x32_bf16 v[36:39], a[152:155], a[36:39], v[36:39]
    ds_read_b64_tr_b16 a[148:149], v231 offset:36864
    ds_read_b64_tr_b16 a[150:151], v231 offset:37888
    v_mfma_f32_16x16x32_bf16 v[20:23], a[160:163], a[32:35], v[20:23]
    buffer_load_dwordx4 a[76:79], v216, s[48:51], s71 offen offset:3072 sc1
    v_mfma_f32_16x16x32_bf16 v[20:23], a[164:167], a[40:43], v[20:23]
    ds_read_b64_tr_b16 a[152:153], v231 offset:40960
    ds_read_b64_tr_b16 a[154:155], v231 offset:41984
    v_mfma_f32_16x16x32_bf16 v[52:55], a[164:167], a[44:47], v[52:55]
    ds_read_b64_tr_b16 a[156:157], v231 offset:45056
    v_mfma_f32_16x16x32_bf16 v[52:55], a[160:163], a[36:39], v[52:55]
    ds_read_b64_tr_b16 a[158:159], v231 offset:46080
    s_barrier
    s_waitcnt lgkmcnt(8)
    v_mfma_f32_16x16x32_bf16 v[8:11], a[128:131], a[32:35], v[8:11]
    ds_read_b64_tr_b16 a[160:161], v254 offset:49152
    s_add_u32 m0, s62, 0
    v_add_u32 v252, 196608, v252
    v_mfma_f32_16x16x32_bf16 v[8:11], a[132:135], a[40:43], v[8:11]
    ds_read_b64_tr_b16 a[162:163], v254 offset:50176
    s_mov_b32 s71, 20480
    v_mfma_f32_16x16x32_bf16 v[40:43], a[132:135], a[44:47], v[40:43]
    buffer_load_dwordx4 a[80:83], v216, s[48:51], s71 offen sc1
    v_mfma_f32_16x16x32_bf16 v[40:43], a[128:131], a[36:39], v[40:43]
    ds_read_b64_tr_b16 a[164:165], v254 offset:53248
    ds_read_b64_tr_b16 a[166:167], v254 offset:54272
    v_mfma_f32_16x16x32_bf16 v[24:27], a[136:139], a[32:35], v[24:27]
    ds_read_b64_tr_b16 a[128:129], v254 offset:57344
    buffer_load_dwordx4 v252, s[28:31], 0 offen lds
    v_mfma_f32_16x16x32_bf16 v[24:27], a[140:143], a[40:43], v[24:27]
    ds_read_b64_tr_b16 a[130:131], v254 offset:58368
    buffer_load_dwordx4 a[84:87], v216, s[48:51], s71 offen offset:1024 sc1
    v_mfma_f32_16x16x32_bf16 v[56:59], a[140:143], a[44:47], v[56:59]
    buffer_load_dwordx4 v252, s[28:31], s11 offen offset:1024 lds
    v_mfma_f32_16x16x32_bf16 v[56:59], a[136:139], a[36:39], v[56:59]
    ds_read_b64_tr_b16 a[132:133], v254 offset:61440
    ds_read_b64_tr_b16 a[134:135], v254 offset:62464
    s_waitcnt lgkmcnt(8)
    v_mfma_f32_16x16x32_bf16 v[12:15], a[144:147], a[32:35], v[12:15]
    buffer_load_dwordx4 a[88:91], v216, s[48:51], s71 offen offset:2048 sc1
    v_mfma_f32_16x16x32_bf16 v[12:15], a[148:151], a[40:43], v[12:15]
    ds_read_b64_tr_b16 a[136:137], v253 offset:49152
    ds_read_b64_tr_b16 a[138:139], v253 offset:50176
    v_mfma_f32_16x16x32_bf16 v[44:47], a[148:151], a[44:47], v[44:47]
    buffer_load_dwordx4 v252, s[28:31], s12 offen offset:2048 lds
    v_mfma_f32_16x16x32_bf16 v[44:47], a[144:147], a[36:39], v[44:47]
    ds_read_b64_tr_b16 a[140:141], v253 offset:53248
    ds_read_b64_tr_b16 a[142:143], v253 offset:54272
    v_mfma_f32_16x16x32_bf16 v[28:31], a[152:155], a[32:35], v[28:31]
    buffer_load_dwordx4 a[92:95], v216, s[48:51], s71 offen offset:3072 sc1
    v_mfma_f32_16x16x32_bf16 v[28:31], a[156:159], a[40:43], v[28:31]
    ds_read_b64_tr_b16 a[144:145], v253 offset:57344
    ds_read_b64_tr_b16 a[146:147], v253 offset:58368
    v_mfma_f32_16x16x32_bf16 v[60:63], a[156:159], a[44:47], v[60:63]
    buffer_load_dwordx4 v252, s[28:31], s13 offen offset:3072 lds
    v_mfma_f32_16x16x32_bf16 v[60:63], a[152:155], a[36:39], v[60:63]
    ds_read_b64_tr_b16 a[148:149], v253 offset:61440
    ds_read_b64_tr_b16 a[150:151], v253 offset:62464
    s_mov_b32 s71, 24576
    s_waitcnt lgkmcnt(8)
    s_waitcnt vmcnt(22)
    v_mfma_f32_16x16x32_bf16 v[0:3], a[160:163], a[48:51], v[0:3]
    buffer_load_dwordx4 a[96:99], v216, s[48:51], s71 offen sc1
    s_waitcnt vmcnt(18)
    v_mfma_f32_16x16x32_bf16 v[0:3], a[164:167], a[56:59], v[0:3]
    ds_read_b64_tr_b16 a[152:153], v230 offset:49152
    ds_read_b64_tr_b16 a[154:155], v230 offset:50176
    s_waitcnt vmcnt(16)
    v_mfma_f32_16x16x32_bf16 v[32:35], a[164:167], a[60:63], v[32:35]
    buffer_load_dwordx4 a[100:103], v216, s[48:51], s71 offen offset:1024 sc1
    v_mfma_f32_16x16x32_bf16 v[32:35], a[160:163], a[52:55], v[32:35]
    ds_read_b64_tr_b16 a[156:157], v230 offset:53248
    ds_read_b64_tr_b16 a[158:159], v230 offset:54272
    v_mfma_f32_16x16x32_bf16 v[16:19], a[128:131], a[48:51], v[16:19]
    ds_read_b64_tr_b16 a[160:161], v230 offset:57344
    buffer_load_dwordx4 a[104:107], v216, s[48:51], s71 offen offset:2048 sc1
    v_mfma_f32_16x16x32_bf16 v[16:19], a[132:135], a[56:59], v[16:19]
    ds_read_b64_tr_b16 a[162:163], v230 offset:58368
    buffer_load_dwordx4 a[108:111], v216, s[48:51], s71 offen offset:3072 sc1
    v_mfma_f32_16x16x32_bf16 v[48:51], a[132:135], a[60:63], v[48:51]
    ds_read_b64_tr_b16 a[164:165], v230 offset:61440
    ds_read_b64_tr_b16 a[166:167], v230 offset:62464
    s_mov_b32 s71, 28672
    v_mfma_f32_16x16x32_bf16 v[48:51], a[128:131], a[52:55], v[48:51]
    buffer_load_dwordx4 a[112:115], v216, s[48:51], s71 offen sc1
    s_waitcnt lgkmcnt(8)
    v_mfma_f32_16x16x32_bf16 v[4:7], a[136:139], a[48:51], v[4:7]
    buffer_load_dwordx4 a[116:119], v216, s[48:51], s71 offen offset:1024 sc1
    v_mfma_f32_16x16x32_bf16 v[4:7], a[140:143], a[56:59], v[4:7]
    ds_read_b64_tr_b16 a[128:129], v231 offset:49152
    ds_read_b64_tr_b16 a[130:131], v231 offset:50176
    v_mfma_f32_16x16x32_bf16 v[36:39], a[140:143], a[60:63], v[36:39]
    buffer_load_dwordx4 a[120:123], v216, s[48:51], s71 offen offset:2048 sc1
    v_mfma_f32_16x16x32_bf16 v[36:39], a[136:139], a[52:55], v[36:39]
    ds_read_b64_tr_b16 a[132:133], v231 offset:53248
    ds_read_b64_tr_b16 a[134:135], v231 offset:54272
    v_mfma_f32_16x16x32_bf16 v[20:23], a[144:147], a[48:51], v[20:23]
    buffer_load_dwordx4 a[124:127], v216, s[48:51], s71 offen offset:3072 sc1
    v_mfma_f32_16x16x32_bf16 v[20:23], a[148:151], a[56:59], v[20:23]
    ds_read_b64_tr_b16 a[136:137], v231 offset:57344
    ds_read_b64_tr_b16 a[138:139], v231 offset:58368
    v_mfma_f32_16x16x32_bf16 v[52:55], a[148:151], a[60:63], v[52:55]
    ds_read_b64_tr_b16 a[140:141], v231 offset:61440
    v_mfma_f32_16x16x32_bf16 v[52:55], a[144:147], a[52:55], v[52:55]
    ds_read_b64_tr_b16 a[142:143], v231 offset:62464
    s_barrier
    s_waitcnt lgkmcnt(8)
    v_mfma_f32_16x16x32_bf16 v[8:11], a[152:155], a[48:51], v[8:11]
    v_add_u32 v254, 65536, v254
    ds_read_b64_tr_b16 a[144:145], v254
    s_add_u32 m0, s62, 16384
    v_mfma_f32_16x16x32_bf16 v[8:11], a[156:159], a[56:59], v[8:11]
    ds_read_b64_tr_b16 a[146:147], v254 offset:1024
    v_mfma_f32_16x16x32_bf16 v[40:43], a[156:159], a[60:63], v[40:43]
    ds_read_b64_tr_b16 a[148:149], v254 offset:4096
    v_mfma_f32_16x16x32_bf16 v[40:43], a[152:155], a[52:55], v[40:43]
    ds_read_b64_tr_b16 a[150:151], v254 offset:5120
    v_mfma_f32_16x16x32_bf16 v[24:27], a[160:163], a[48:51], v[24:27]
    buffer_load_dwordx4 v239, s[28:31], 0 offen lds
    v_mfma_f32_16x16x32_bf16 v[24:27], a[164:167], a[56:59], v[24:27]
    ds_read_b64_tr_b16 a[152:153], v254 offset:8192
    ds_read_b64_tr_b16 a[154:155], v254 offset:9216
    v_mfma_f32_16x16x32_bf16 v[56:59], a[164:167], a[60:63], v[56:59]
    ds_read_b64_tr_b16 a[156:157], v254 offset:12288
    v_mfma_f32_16x16x32_bf16 v[56:59], a[160:163], a[52:55], v[56:59]
    ds_read_b64_tr_b16 a[158:159], v254 offset:13312
    s_waitcnt lgkmcnt(8)
    v_mfma_f32_16x16x32_bf16 v[12:15], a[128:131], a[48:51], v[12:15]
    v_add_u32 v253, 65536, v253
    ds_read_b64_tr_b16 a[160:161], v253
    v_mfma_f32_16x16x32_bf16 v[12:15], a[132:135], a[56:59], v[12:15]
    ds_read_b64_tr_b16 a[162:163], v253 offset:1024
    v_mfma_f32_16x16x32_bf16 v[44:47], a[132:135], a[60:63], v[44:47]
    ds_read_b64_tr_b16 a[164:165], v253 offset:4096
    v_mfma_f32_16x16x32_bf16 v[44:47], a[128:131], a[52:55], v[44:47]
    ds_read_b64_tr_b16 a[166:167], v253 offset:5120
    v_mfma_f32_16x16x32_bf16 v[28:31], a[136:139], a[48:51], v[28:31]
    buffer_load_dwordx4 v239, s[28:31], s11 offen offset:1024 lds
    v_mfma_f32_16x16x32_bf16 v[28:31], a[140:143], a[56:59], v[28:31]
    ds_read_b64_tr_b16 a[128:129], v253 offset:8192
    ds_read_b64_tr_b16 a[130:131], v253 offset:9216
    v_mfma_f32_16x16x32_bf16 v[60:63], a[140:143], a[60:63], v[60:63]
    ds_read_b64_tr_b16 a[132:133], v253 offset:12288
    v_mfma_f32_16x16x32_bf16 v[60:63], a[136:139], a[52:55], v[60:63]
    ds_read_b64_tr_b16 a[134:135], v253 offset:13312
    s_waitcnt lgkmcnt(8)
    s_waitcnt vmcnt(23)
    v_mfma_f32_16x16x32_bf16 v[0:3], a[144:147], a[64:67], v[0:3]
    v_add_u32 v230, 65536, v230
    ds_read_b64_tr_b16 a[136:137], v230
    s_waitcnt vmcnt(19)
    v_mfma_f32_16x16x32_bf16 v[0:3], a[148:151], a[72:75], v[0:3]
    ds_read_b64_tr_b16 a[138:139], v230 offset:1024
    s_waitcnt vmcnt(18)
    v_mfma_f32_16x16x32_bf16 v[32:35], a[148:151], a[76:79], v[32:35]
    buffer_load_dwordx4 v239, s[28:31], s12 offen offset:2048 lds
    v_mfma_f32_16x16x32_bf16 v[32:35], a[144:147], a[68:71], v[32:35]
    ds_read_b64_tr_b16 a[140:141], v230 offset:4096
    ds_read_b64_tr_b16 a[142:143], v230 offset:5120
    v_mfma_f32_16x16x32_bf16 v[16:19], a[152:155], a[64:67], v[16:19]
    ds_read_b64_tr_b16 a[144:145], v230 offset:8192
    v_mfma_f32_16x16x32_bf16 v[16:19], a[156:159], a[72:75], v[16:19]
    ds_read_b64_tr_b16 a[146:147], v230 offset:9216
    v_mfma_f32_16x16x32_bf16 v[48:51], a[156:159], a[76:79], v[48:51]
    ds_read_b64_tr_b16 a[148:149], v230 offset:12288
    v_mfma_f32_16x16x32_bf16 v[48:51], a[152:155], a[68:71], v[48:51]
    ds_read_b64_tr_b16 a[150:151], v230 offset:13312
    s_waitcnt lgkmcnt(8)
    v_mfma_f32_16x16x32_bf16 v[4:7], a[160:163], a[64:67], v[4:7]
    v_add_u32 v231, 65536, v231
    ds_read_b64_tr_b16 a[152:153], v231
    v_mfma_f32_16x16x32_bf16 v[4:7], a[164:167], a[72:75], v[4:7]
    ds_read_b64_tr_b16 a[154:155], v231 offset:1024
    v_mfma_f32_16x16x32_bf16 v[36:39], a[164:167], a[76:79], v[36:39]
    buffer_load_dwordx4 v239, s[28:31], s13 offen offset:3072 lds
    v_mfma_f32_16x16x32_bf16 v[36:39], a[160:163], a[68:71], v[36:39]
    ds_read_b64_tr_b16 a[156:157], v231 offset:4096
    ds_read_b64_tr_b16 a[158:159], v231 offset:5120
    v_mfma_f32_16x16x32_bf16 v[20:23], a[128:131], a[64:67], v[20:23]
    ds_read_b64_tr_b16 a[160:161], v231 offset:8192
    v_mfma_f32_16x16x32_bf16 v[20:23], a[132:135], a[72:75], v[20:23]
    ds_read_b64_tr_b16 a[162:163], v231 offset:9216
    v_mfma_f32_16x16x32_bf16 v[52:55], a[132:135], a[76:79], v[52:55]
    ds_read_b64_tr_b16 a[164:165], v231 offset:12288
    v_mfma_f32_16x16x32_bf16 v[52:55], a[128:131], a[68:71], v[52:55]
    ds_read_b64_tr_b16 a[166:167], v231 offset:13312
    s_barrier
    s_waitcnt lgkmcnt(8)
    v_mfma_f32_16x16x32_bf16 v[8:11], a[136:139], a[64:67], v[8:11]
    buffer_load_dword v242, v235, s[48:51], 0 offen sc1
    v_mfma_f32_16x16x32_bf16 v[8:11], a[140:143], a[72:75], v[8:11]
    ds_read_b64_tr_b16 a[128:129], v254 offset:16384
    ds_read_b64_tr_b16 a[130:131], v254 offset:17408
    v_mfma_f32_16x16x32_bf16 v[40:43], a[140:143], a[76:79], v[40:43]
    ds_read_b64_tr_b16 a[132:133], v254 offset:20480
    s_add_u32 m0, s62, 32768
    v_mfma_f32_16x16x32_bf16 v[40:43], a[136:139], a[68:71], v[40:43]
    ds_read_b64_tr_b16 a[134:135], v254 offset:21504
    v_mfma_f32_16x16x32_bf16 v[24:27], a[144:147], a[64:67], v[24:27]
    ds_read_b64_tr_b16 a[136:137], v254 offset:24576
    v_add_u32 v239, 393216, v239
    v_mfma_f32_16x16x32_bf16 v[24:27], a[148:151], a[72:75], v[24:27]
    ds_read_b64_tr_b16 a[138:139], v254 offset:25600
    v_mfma_f32_16x16x32_bf16 v[56:59], a[148:151], a[76:79], v[56:59]
    ds_read_b64_tr_b16 a[140:141], v254 offset:28672
    v_mfma_f32_16x16x32_bf16 v[56:59], a[144:147], a[68:71], v[56:59]
    ds_read_b64_tr_b16 a[142:143], v254 offset:29696
    s_waitcnt lgkmcnt(8)
    v_mfma_f32_16x16x32_bf16 v[12:15], a[152:155], a[64:67], v[12:15]
    buffer_load_dwordx4 v239, s[28:31], 0 offen lds
    v_mfma_f32_16x16x32_bf16 v[12:15], a[156:159], a[72:75], v[12:15]
    ds_read_b64_tr_b16 a[144:145], v253 offset:16384
    ds_read_b64_tr_b16 a[146:147], v253 offset:17408
    v_mfma_f32_16x16x32_bf16 v[44:47], a[156:159], a[76:79], v[44:47]
    ds_read_b64_tr_b16 a[148:149], v253 offset:20480
    v_mfma_f32_16x16x32_bf16 v[44:47], a[152:155], a[68:71], v[44:47]
    ds_read_b64_tr_b16 a[150:151], v253 offset:21504
    v_mfma_f32_16x16x32_bf16 v[28:31], a[160:163], a[64:67], v[28:31]
    buffer_load_dwordx4 v239, s[28:31], s11 offen offset:1024 lds
    v_mfma_f32_16x16x32_bf16 v[28:31], a[164:167], a[72:75], v[28:31]
    ds_read_b64_tr_b16 a[152:153], v253 offset:24576
    ds_read_b64_tr_b16 a[154:155], v253 offset:25600
    v_mfma_f32_16x16x32_bf16 v[60:63], a[164:167], a[76:79], v[60:63]
    ds_read_b64_tr_b16 a[156:157], v253 offset:28672
    v_mfma_f32_16x16x32_bf16 v[60:63], a[160:163], a[68:71], v[60:63]
    ds_read_b64_tr_b16 a[158:159], v253 offset:29696
    s_waitcnt lgkmcnt(8)
    s_waitcnt vmcnt(22)
    v_mfma_f32_16x16x32_bf16 v[0:3], a[128:131], a[80:83], v[0:3]
    ds_read_b64_tr_b16 a[160:161], v230 offset:16384
    s_waitcnt vmcnt(18)
    v_mfma_f32_16x16x32_bf16 v[0:3], a[132:135], a[88:91], v[0:3]
    ds_read_b64_tr_b16 a[162:163], v230 offset:17408
    s_waitcnt vmcnt(16)
    v_mfma_f32_16x16x32_bf16 v[32:35], a[132:135], a[92:95], v[32:35]
    buffer_load_dwordx4 v239, s[28:31], s12 offen offset:2048 lds
    v_mfma_f32_16x16x32_bf16 v[32:35], a[128:131], a[84:87], v[32:35]
    ds_read_b64_tr_b16 a[164:165], v230 offset:20480
    ds_read_b64_tr_b16 a[166:167], v230 offset:21504
    v_mfma_f32_16x16x32_bf16 v[16:19], a[136:139], a[80:83], v[16:19]
    ds_read_b64_tr_b16 a[128:129], v230 offset:24576
    v_mfma_f32_16x16x32_bf16 v[16:19], a[140:143], a[88:91], v[16:19]
    ds_read_b64_tr_b16 a[130:131], v230 offset:25600
    v_mfma_f32_16x16x32_bf16 v[48:51], a[140:143], a[92:95], v[48:51]
    ds_read_b64_tr_b16 a[132:133], v230 offset:28672
    v_mfma_f32_16x16x32_bf16 v[48:51], a[136:139], a[84:87], v[48:51]
    ds_read_b64_tr_b16 a[134:135], v230 offset:29696
    s_waitcnt lgkmcnt(8)
    v_mfma_f32_16x16x32_bf16 v[4:7], a[144:147], a[80:83], v[4:7]
    buffer_load_dwordx4 v239, s[28:31], s13 offen offset:3072 lds
    v_mfma_f32_16x16x32_bf16 v[4:7], a[148:151], a[88:91], v[4:7]
    ds_read_b64_tr_b16 a[136:137], v231 offset:16384
    ds_read_b64_tr_b16 a[138:139], v231 offset:17408
    v_mfma_f32_16x16x32_bf16 v[36:39], a[148:151], a[92:95], v[36:39]
    ds_read_b64_tr_b16 a[140:141], v231 offset:20480
    v_mfma_f32_16x16x32_bf16 v[36:39], a[144:147], a[84:87], v[36:39]
    ds_read_b64_tr_b16 a[142:143], v231 offset:21504
    v_mfma_f32_16x16x32_bf16 v[20:23], a[152:155], a[80:83], v[20:23]
    s_waitcnt vmcnt(4)
    v_cmp_gt_u32 vcc, s43, v242
    s_cbranch_vccnz L_B_p3_slow
L_B_p3_ok:
    v_mfma_f32_16x16x32_bf16 v[20:23], a[156:159], a[88:91], v[20:23]
    ds_read_b64_tr_b16 a[144:145], v231 offset:24576
    ds_read_b64_tr_b16 a[146:147], v231 offset:25600
    v_mfma_f32_16x16x32_bf16 v[52:55], a[156:159], a[92:95], v[52:55]
    ds_read_b64_tr_b16 a[148:149], v231 offset:28672
    v_mfma_f32_16x16x32_bf16 v[52:55], a[152:155], a[84:87], v[52:55]
    ds_read_b64_tr_b16 a[150:151], v231 offset:29696
    s_barrier
    s_waitcnt lgkmcnt(8)
    v_mfma_f32_16x16x32_bf16 v[8:11], a[160:163], a[80:83], v[8:11]
    ds_read_b64_tr_b16 a[152:153], v254 offset:32768
    s_add_u32 m0, s62, 49152
    v_mfma_f32_16x16x32_bf16 v[8:11], a[164:167], a[88:91], v[8:11]
    ds_read_b64_tr_b16 a[154:155], v254 offset:33792
    v_add_u32 v239, 393216, v239
    v_mfma_f32_16x16x32_bf16 v[40:43], a[164:167], a[92:95], v[40:43]
    buffer_load_dwordx4 v239, s[28:31], 0 offen lds
    v_mfma_f32_16x16x32_bf16 v[40:43], a[160:163], a[84:87], v[40:43]
    ds_read_b64_tr_b16 a[156:157], v254 offset:36864
    ds_read_b64_tr_b16 a[158:159], v254 offset:37888
    v_mfma_f32_16x16x32_bf16 v[24:27], a[128:131], a[80:83], v[24:27]
    ds_read_b64_tr_b16 a[160:161], v254 offset:40960
    v_mfma_f32_16x16x32_bf16 v[24:27], a[132:135], a[88:91], v[24:27]
    ds_read_b64_tr_b16 a[162:163], v254 offset:41984
    v_mfma_f32_16x16x32_bf16 v[56:59], a[132:135], a[92:95], v[56:59]
    buffer_load_dwordx4 v239, s[28:31], s11 offen offset:1024 lds
    v_mfma_f32_16x16x32_bf16 v[56:59], a[128:131], a[84:87], v[56:59]
    ds_read_b64_tr_b16 a[164:165], v254 offset:45056
    ds_read_b64_tr_b16 a[166:167], v254 offset:46080
    s_waitcnt lgkmcnt(8)
    v_mfma_f32_16x16x32_bf16 v[12:15], a[136:139], a[80:83], v[12:15]
    ds_read_b64_tr_b16 a[128:129], v253 offset:32768
    v_mfma_f32_16x16x32_bf16 v[12:15], a[140:143], a[88:91], v[12:15]
    ds_read_b64_tr_b16 a[130:131], v253 offset:33792
    v_mfma_f32_16x16x32_bf16 v[44:47], a[140:143], a[92:95], v[44:47]
    buffer_load_dwordx4 v239, s[28:31], s12 offen offset:2048 lds
    v_mfma_f32_16x16x32_bf16 v[44:47], a[136:139], a[84:87], v[44:47]
    ds_read_b64_tr_b16 a[132:133], v253 offset:36864
    ds_read_b64_tr_b16 a[134:135], v253 offset:37888
    v_mfma_f32_16x16x32_bf16 v[28:31], a[144:147], a[80:83], v[28:31]
    buffer_load_dwordx4 v239, s[28:31], s13 offen offset:3072 lds
    v_mfma_f32_16x16x32_bf16 v[28:31], a[148:151], a[88:91], v[28:31]
    ds_read_b64_tr_b16 a[136:137], v253 offset:40960
    ds_read_b64_tr_b16 a[138:139], v253 offset:41984
    v_mfma_f32_16x16x32_bf16 v[60:63], a[148:151], a[92:95], v[60:63]
    ds_read_b64_tr_b16 a[140:141], v253 offset:45056
    s_add_u32 s42, s40, 0
    v_mfma_f32_16x16x32_bf16 v[60:63], a[144:147], a[84:87], v[60:63]
    ds_read_b64_tr_b16 a[142:143], v253 offset:46080
    s_waitcnt lgkmcnt(8)
    v_mfma_f32_16x16x32_bf16 v[0:3], a[152:155], a[96:99], v[0:3]
    ds_read_b64_tr_b16 a[144:145], v230 offset:32768
    v_mfma_f32_16x16x32_bf16 v[0:3], a[156:159], a[104:107], v[0:3]
    ds_read_b64_tr_b16 a[146:147], v230 offset:33792
    v_mfma_f32_16x16x32_bf16 v[32:35], a[156:159], a[108:111], v[32:35]
    buffer_load_dwordx4 a[176:179], v243, s[48:51], s42 offen sc1
    v_mfma_f32_16x16x32_bf16 v[32:35], a[152:155], a[100:103], v[32:35]
    ds_read_b64_tr_b16 a[148:149], v230 offset:36864
    ds_read_b64_tr_b16 a[150:151], v230 offset:37888
    v_mfma_f32_16x16x32_bf16 v[16:19], a[160:163], a[96:99], v[16:19]
    buffer_load_dwordx4 a[180:183], v240, s[48:51], s42 offen offset:1024 sc1
    v_mfma_f32_16x16x32_bf16 v[16:19], a[164:167], a[104:107], v[16:19]
    ds_read_b64_tr_b16 a[152:153], v230 offset:40960
    ds_read_b64_tr_b16 a[154:155], v230 offset:41984
    v_mfma_f32_16x16x32_bf16 v[48:51], a[164:167], a[108:111], v[48:51]
    ds_read_b64_tr_b16 a[156:157], v230 offset:45056
    v_mfma_f32_16x16x32_bf16 v[48:51], a[160:163], a[100:103], v[48:51]
    ds_read_b64_tr_b16 a[158:159], v230 offset:46080
    s_waitcnt lgkmcnt(8)
    v_mfma_f32_16x16x32_bf16 v[4:7], a[128:131], a[96:99], v[4:7]
    buffer_load_dwordx4 a[184:187], v243, s[48:51], s42 offen offset:2048 sc1
    v_mfma_f32_16x16x32_bf16 v[4:7], a[132:135], a[104:107], v[4:7]
    ds_read_b64_tr_b16 a[160:161], v231 offset:32768
    ds_read_b64_tr_b16 a[162:163], v231 offset:33792
    v_mfma_f32_16x16x32_bf16 v[36:39], a[132:135], a[108:111], v[36:39]
    ds_read_b64_tr_b16 a[164:165], v231 offset:36864
    v_mfma_f32_16x16x32_bf16 v[36:39], a[128:131], a[100:103], v[36:39]
    ds_read_b64_tr_b16 a[166:167], v231 offset:37888
    v_mfma_f32_16x16x32_bf16 v[20:23], a[136:139], a[96:99], v[20:23]
    buffer_load_dwordx4 a[188:191], v240, s[48:51], s42 offen offset:3072 sc1
    v_mfma_f32_16x16x32_bf16 v[20:23], a[140:143], a[104:107], v[20:23]
    ds_read_b64_tr_b16 a[128:129], v231 offset:40960
    ds_read_b64_tr_b16 a[130:131], v231 offset:41984
    v_mfma_f32_16x16x32_bf16 v[52:55], a[140:143], a[108:111], v[52:55]
    ds_read_b64_tr_b16 a[132:133], v231 offset:45056
    v_mfma_f32_16x16x32_bf16 v[52:55], a[136:139], a[100:103], v[52:55]
    ds_read_b64_tr_b16 a[134:135], v231 offset:46080
    s_barrier
    s_waitcnt lgkmcnt(8)
    v_mfma_f32_16x16x32_bf16 v[8:11], a[144:147], a[96:99], v[8:11]
    v_subrev_u32 v254, 65536, v254
    ds_read_b64_tr_b16 a[136:137], v254
    s_add_u32 m0, s62, 65536
    v_mfma_f32_16x16x32_bf16 v[8:11], a[148:151], a[104:107], v[8:11]
    ds_read_b64_tr_b16 a[138:139], v254 offset:1024
    v_add_u32 v239, 393216, v239
    v_mfma_f32_16x16x32_bf16 v[40:43], a[148:151], a[108:111], v[40:43]
    buffer_load_dwordx4 v239, s[28:31], 0 offen lds
    v_mfma_f32_16x16x32_bf16 v[40:43], a[144:147], a[100:103], v[40:43]
    ds_read_b64_tr_b16 a[140:141], v254 offset:4096
    ds_read_b64_tr_b16 a[142:143], v254 offset:5120
    v_mfma_f32_16x16x32_bf16 v[24:27], a[152:155], a[96:99], v[24:27]
    ds_read_b64_tr_b16 a[144:145], v254 offset:8192
    v_mfma_f32_16x16x32_bf16 v[24:27], a[156:159], a[104:107], v[24:27]
    ds_read_b64_tr_b16 a[146:147], v254 offset:9216
    v_mfma_f32_16x16x32_bf16 v[56:59], a[156:159], a[108:111], v[56:59]
    buffer_load_dwordx4 v239, s[28:31], s11 offen offset:1024 lds
    v_mfma_f32_16x16x32_bf16 v[56:59], a[152:155], a[100:103], v[56:59]
    ds_read_b64_tr_b16 a[148:149], v254 offset:12288
    ds_read_b64_tr_b16 a[150:151], v254 offset:13312
    s_waitcnt lgkmcnt(8)
    v_mfma_f32_16x16x32_bf16 v[12:15], a[160:163], a[96:99], v[12:15]
    v_subrev_u32 v253, 65536, v253
    ds_read_b64_tr_b16 a[152:153], v253
    v_mfma_f32_16x16x32_bf16 v[12:15], a[164:167], a[104:107], v[12:15]
    ds_read_b64_tr_b16 a[154:155], v253 offset:1024
    v_mfma_f32_16x16x32_bf16 v[44:47], a[164:167], a[108:111], v[44:47]
    buffer_load_dwordx4 v239, s[28:31], s12 offen offset:2048 lds
    v_mfma_f32_16x16x32_bf16 v[44:47], a[160:163], a[100:103], v[44:47]
    ds_read_b64_tr_b16 a[156:157], v253 offset:4096
    ds_read_b64_tr_b16 a[158:159], v253 offset:5120
    v_mfma_f32_16x16x32_bf16 v[28:31], a[128:131], a[96:99], v[28:31]
    buffer_load_dwordx4 v239, s[28:31], s13 offen offset:3072 lds
    v_mfma_f32_16x16x32_bf16 v[28:31], a[132:135], a[104:107], v[28:31]
    ds_read_b64_tr_b16 a[160:161], v253 offset:8192
    ds_read_b64_tr_b16 a[162:163], v253 offset:9216
    v_mfma_f32_16x16x32_bf16 v[60:63], a[132:135], a[108:111], v[60:63]
    ds_read_b64_tr_b16 a[164:165], v253 offset:12288
    s_add_u32 s42, s40, 4096
    v_mfma_f32_16x16x32_bf16 v[60:63], a[128:131], a[100:103], v[60:63]
    ds_read_b64_tr_b16 a[166:167], v253 offset:13312
    s_waitcnt lgkmcnt(8)
    v_mfma_f32_16x16x32_bf16 v[0:3], a[136:139], a[112:115], v[0:3]
    v_subrev_u32 v230, 65536, v230
    ds_read_b64_tr_b16 a[128:129], v230
    v_mfma_f32_16x16x32_bf16 v[0:3], a[140:143], a[120:123], v[0:3]
    ds_read_b64_tr_b16 a[130:131], v230 offset:1024
    v_mfma_f32_16x16x32_bf16 v[32:35], a[140:143], a[124:127], v[32:35]
    buffer_load_dwordx4 a[192:195], v243, s[48:51], s42 offen sc1
    v_mfma_f32_16x16x32_bf16 v[32:35], a[136:139], a[116:119], v[32:35]
    ds_read_b64_tr_b16 a[132:133], v230 offset:4096
    ds_read_b64_tr_b16 a[134:135], v230 offset:5120
    v_mfma_f32_16x16x32_bf16 v[16:19], a[144:147], a[112:115], v[16:19]
    buffer_load_dwordx4 a[196:199], v240, s[48:51], s42 offen offset:1024 sc1
    v_mfma_f32_16x16x32_bf16 v[16:19], a[148:151], a[120:123], v[16:19]
    ds_read_b64_tr_b16 a[136:137], v230 offset:8192
    ds_read_b64_tr_b16 a[138:139], v230 offset:9216
    v_mfma_f32_16x16x32_bf16 v[48:51], a[148:151], a[124:127], v[48:51]
    ds_read_b64_tr_b16 a[140:141], v230 offset:12288
    v_mfma_f32_16x16x32_bf16 v[48:51], a[144:147], a[116:119], v[48:51]
    ds_read_b64_tr_b16 a[142:143], v230 offset:13312
    s_waitcnt lgkmcnt(8)
    v_mfma_f32_16x16x32_bf16 v[4:7], a[152:155], a[112:115], v[4:7]
    v_subrev_u32 v231, 65536, v231
    ds_read_b64_tr_b16 a[144:145], v231
    buffer_load_dwordx4 a[200:203], v243, s[48:51], s42 offen offset:2048 sc1
    v_mfma_f32_16x16x32_bf16 v[4:7], a[156:159], a[120:123], v[4:7]
    ds_read_b64_tr_b16 a[146:147], v231 offset:1024
    v_mfma_f32_16x16x32_bf16 v[36:39], a[156:159], a[124:127], v[36:39]
    ds_read_b64_tr_b16 a[148:149], v231 offset:4096
    v_mfma_f32_16x16x32_bf16 v[36:39], a[152:155], a[116:119], v[36:39]
    ds_read_b64_tr_b16 a[150:151], v231 offset:5120
    v_mfma_f32_16x16x32_bf16 v[20:23], a[160:163], a[112:115], v[20:23]
    buffer_load_dwordx4 a[204:207], v240, s[48:51], s42 offen offset:3072 sc1
    v_mfma_f32_16x16x32_bf16 v[20:23], a[164:167], a[120:123], v[20:23]
    ds_read_b64_tr_b16 a[152:153], v231 offset:8192
    ds_read_b64_tr_b16 a[154:155], v231 offset:9216
    v_mfma_f32_16x16x32_bf16 v[52:55], a[164:167], a[124:127], v[52:55]
    ds_read_b64_tr_b16 a[156:157], v231 offset:12288
    v_mfma_f32_16x16x32_bf16 v[52:55], a[160:163], a[116:119], v[52:55]
    ds_read_b64_tr_b16 a[158:159], v231 offset:13312
    s_waitcnt vmcnt(16)
    s_barrier
    s_waitcnt lgkmcnt(8)
    v_mfma_f32_16x16x32_bf16 v[8:11], a[128:131], a[112:115], v[8:11]
    ds_read_b64_tr_b16 a[160:161], v254 offset:16384
    s_add_u32 m0, s62, 81920
    v_mfma_f32_16x16x32_bf16 v[8:11], a[132:135], a[120:123], v[8:11]
    ds_read_b64_tr_b16 a[162:163], v254 offset:17408
    v_mfma_f32_16x16x32_bf16 v[40:43], a[132:135], a[124:127], v[40:43]
    buffer_load_dwordx4 v238, s[32:35], 0 offen lds
    v_mfma_f32_16x16x32_bf16 v[40:43], a[128:131], a[116:119], v[40:43]
    ds_read_b64_tr_b16 a[164:165], v254 offset:20480
    ds_read_b64_tr_b16 a[166:167], v254 offset:21504
    v_mfma_f32_16x16x32_bf16 v[24:27], a[136:139], a[112:115], v[24:27]
    ds_read_b64_tr_b16 a[128:129], v253 offset:16384
    v_mfma_f32_16x16x32_bf16 v[24:27], a[140:143], a[120:123], v[24:27]
    ds_read_b64_tr_b16 a[130:131], v253 offset:17408
    v_mfma_f32_16x16x32_bf16 v[56:59], a[140:143], a[124:127], v[56:59]
    buffer_load_dwordx4 v238, s[32:35], s14 offen offset:1024 lds
    v_mfma_f32_16x16x32_bf16 v[56:59], a[136:139], a[116:119], v[56:59]
    ds_read_b64_tr_b16 a[132:133], v253 offset:20480
    ds_read_b64_tr_b16 a[134:135], v253 offset:21504
    s_waitcnt lgkmcnt(8)
    v_mfma_f32_16x16x32_bf16 v[12:15], a[144:147], a[112:115], v[12:15]
    buffer_load_dwordx4 v238, s[32:35], s15 offen offset:2048 lds
    v_mfma_f32_16x16x32_bf16 v[12:15], a[148:151], a[120:123], v[12:15]
    ds_read_b64_tr_b16 a[136:137], v230 offset:16384
    ds_read_b64_tr_b16 a[138:139], v230 offset:17408
    v_mfma_f32_16x16x32_bf16 v[44:47], a[148:151], a[124:127], v[44:47]
    ds_read_b64_tr_b16 a[140:141], v230 offset:20480
    v_mfma_f32_16x16x32_bf16 v[44:47], a[144:147], a[116:119], v[44:47]
    ds_read_b64_tr_b16 a[142:143], v230 offset:21504
    v_mfma_f32_16x16x32_bf16 v[28:31], a[152:155], a[112:115], v[28:31]
    buffer_load_dwordx4 v238, s[32:35], s16 offen offset:3072 lds
    v_mfma_f32_16x16x32_bf16 v[28:31], a[156:159], a[120:123], v[28:31]
    ds_read_b64_tr_b16 a[144:145], v231 offset:16384
    ds_read_b64_tr_b16 a[146:147], v231 offset:17408
    v_mfma_f32_16x16x32_bf16 v[60:63], a[156:159], a[124:127], v[60:63]
    ds_read_b64_tr_b16 a[148:149], v231 offset:20480
    s_add_u32 s42, s40, 8192
    v_mfma_f32_16x16x32_bf16 v[60:63], a[152:155], a[116:119], v[60:63]
    ds_read_b64_tr_b16 a[150:151], v231 offset:21504
    s_waitcnt lgkmcnt(8)
    v_mfma_f32_16x16x32_bf16 v[64:67], a[160:163], a[0:3], 0
    buffer_load_dwordx4 a[208:211], v243, s[48:51], s42 offen sc1
    v_mfma_f32_16x16x32_bf16 v[64:67], a[164:167], a[8:11], v[64:67]
    ds_read_b64_tr_b16 a[152:153], v254 offset:24576
    ds_read_b64_tr_b16 a[154:155], v254 offset:25600
    v_mfma_f32_16x16x32_bf16 v[80:83], a[164:167], a[12:15], 0
    ds_read_b64_tr_b16 a[156:157], v254 offset:28672
    v_mfma_f32_16x16x32_bf16 v[80:83], a[160:163], a[4:7], v[80:83]
    ds_read_b64_tr_b16 a[158:159], v254 offset:29696
    v_mfma_f32_16x16x32_bf16 v[68:71], a[128:131], a[0:3], 0
    buffer_load_dwordx4 a[212:215], v240, s[48:51], s42 offen offset:1024 sc1
    v_mfma_f32_16x16x32_bf16 v[68:71], a[132:135], a[8:11], v[68:71]
    ds_read_b64_tr_b16 a[160:161], v253 offset:24576
    ds_read_b64_tr_b16 a[162:163], v253 offset:25600
    v_cvt_pk_bf16_f32 v32, v32, v33
    v_cvt_pk_bf16_f32 v33, v34, v35
    v_mfma_f32_16x16x32_bf16 v[84:87], a[132:135], a[12:15], 0
    ds_read_b64_tr_b16 a[164:165], v253 offset:28672
    v_cvt_pk_bf16_f32 v34, v36, v37
    v_cvt_pk_bf16_f32 v35, v38, v39
    v_cvt_pk_bf16_f32 v36, v40, v41
    v_mfma_f32_16x16x32_bf16 v[84:87], a[128:131], a[4:7], v[84:87]
    ds_read_b64_tr_b16 a[166:167], v253 offset:29696
    v_cvt_pk_bf16_f32 v37, v42, v43
    v_cvt_pk_bf16_f32 v38, v44, v45
    s_waitcnt lgkmcnt(8)
    v_mfma_f32_16x16x32_bf16 v[72:75], a[136:139], a[0:3], 0
    buffer_load_dwordx4 a[216:219], v243, s[48:51], s42 offen offset:2048 sc1
    v_mfma_f32_16x16x32_bf16 v[72:75], a[140:143], a[8:11], v[72:75]
    ds_read_b64_tr_b16 a[128:129], v230 offset:24576
    ds_read_b64_tr_b16 a[130:131], v230 offset:25600
    v_cvt_pk_bf16_f32 v39, v46, v47
    v_mfma_f32_16x16x32_bf16 v[88:91], a[140:143], a[12:15], 0
    ds_read_b64_tr_b16 a[132:133], v230 offset:28672
    v_permlane16_swap_b32 v32, v36
    v_permlane16_swap_b32 v33, v37
    v_permlane16_swap_b32 v34, v38
    v_mfma_f32_16x16x32_bf16 v[88:91], a[136:139], a[4:7], v[88:91]
    ds_read_b64_tr_b16 a[134:135], v230 offset:29696
    v_permlane16_swap_b32 v35, v39
    v_cvt_pk_bf16_f32 v48, v48, v49
    v_mfma_f32_16x16x32_bf16 v[76:79], a[144:147], a[0:3], 0
    buffer_load_dwordx4 a[220:223], v240, s[48:51], s42 offen offset:3072 sc1
    v_mfma_f32_16x16x32_bf16 v[76:79], a[148:151], a[8:11], v[76:79]
    ds_read_b64_tr_b16 a[136:137], v231 offset:24576
    ds_read_b64_tr_b16 a[138:139], v231 offset:25600
    v_cvt_pk_bf16_f32 v49, v50, v51
    v_cvt_pk_bf16_f32 v50, v52, v53
    v_mfma_f32_16x16x32_bf16 v[92:95], a[148:151], a[12:15], 0
    ds_read_b64_tr_b16 a[140:141], v231 offset:28672
    v_cvt_pk_bf16_f32 v51, v54, v55
    v_cvt_pk_bf16_f32 v52, v56, v57
    v_cvt_pk_bf16_f32 v53, v58, v59
    v_mfma_f32_16x16x32_bf16 v[92:95], a[144:147], a[4:7], v[92:95]
    ds_read_b64_tr_b16 a[142:143], v231 offset:29696
    v_cvt_pk_bf16_f32 v54, v60, v61
    v_cvt_pk_bf16_f32 v55, v62, v63
    s_waitcnt lgkmcnt(8)
    v_mfma_f32_16x16x32_bf16 v[64:67], a[152:155], a[16:19], v[64:67]
    ds_read_b64_tr_b16 a[144:145], v254 offset:32768
    s_add_u32 m0, s62, 98304
    v_add_u32 v238, 229376, v238
    v_permlane16_swap_b32 v48, v52
    v_mfma_f32_16x16x32_bf16 v[64:67], a[156:159], a[24:27], v[64:67]
    ds_read_b64_tr_b16 a[146:147], v254 offset:33792
    v_permlane16_swap_b32 v49, v53
    v_permlane16_swap_b32 v50, v54
    v_mfma_f32_16x16x32_bf16 v[80:83], a[156:159], a[28:31], v[80:83]
    buffer_load_dwordx4 v238, s[32:35], 0 offen lds
    v_mfma_f32_16x16x32_bf16 v[80:83], a[152:155], a[20:23], v[80:83]
    ds_read_b64_tr_b16 a[148:149], v254 offset:36864
    ds_read_b64_tr_b16 a[150:151], v254 offset:37888
    v_permlane16_swap_b32 v51, v55
    v_mfma_f32_16x16x32_bf16 v[68:71], a[160:163], a[16:19], v[68:71]
    ds_read_b64_tr_b16 a[152:153], v253 offset:32768
    ds_write_b128 v250, v[32:35] offset:6528
    ds_write_b128 v250, v[36:39] offset:6544
    v_mfma_f32_16x16x32_bf16 v[68:71], a[164:167], a[24:27], v[68:71]
    ds_read_b64_tr_b16 a[154:155], v253 offset:33792
    ds_write_b128 v250, v[48:51] offset:6656
    ds_write_b128 v250, v[52:55] offset:6672
    v_mfma_f32_16x16x32_bf16 v[84:87], a[164:167], a[28:31], v[84:87]
    buffer_load_dwordx4 v238, s[32:35], s14 offen offset:1024 lds
    v_mfma_f32_16x16x32_bf16 v[84:87], a[160:163], a[20:23], v[84:87]
    ds_read_b64_tr_b16 a[156:157], v253 offset:36864
    ds_read_b64_tr_b16 a[158:159], v253 offset:37888
    s_waitcnt lgkmcnt(12)
    v_mfma_f32_16x16x32_bf16 v[72:75], a[128:131], a[16:19], v[72:75]
    ds_read_b64_tr_b16 a[160:161], v230 offset:32768
    ds_read_b128 v[40:43], v236
    v_mfma_f32_16x16x32_bf16 v[72:75], a[132:135], a[24:27], v[72:75]
    ds_read_b64_tr_b16 a[162:163], v230 offset:33792
    ds_read_b128 v[44:47], v236 offset:1024
    v_mfma_f32_16x16x32_bf16 v[88:91], a[132:135], a[28:31], v[88:91]
    buffer_load_dwordx4 v238, s[32:35], s15 offen offset:2048 lds
    v_mfma_f32_16x16x32_bf16 v[88:91], a[128:131], a[20:23], v[88:91]
    ds_read_b64_tr_b16 a[164:165], v230 offset:36864
    ds_read_b64_tr_b16 a[166:167], v230 offset:37888
    v_mfma_f32_16x16x32_bf16 v[76:79], a[136:139], a[16:19], v[76:79]
    buffer_load_dwordx4 v238, s[32:35], s16 offen offset:3072 lds
    v_mfma_f32_16x16x32_bf16 v[76:79], a[140:143], a[24:27], v[76:79]
    ds_read_b64_tr_b16 a[128:129], v231 offset:32768
    ds_read_b64_tr_b16 a[130:131], v231 offset:33792
    v_mfma_f32_16x16x32_bf16 v[92:95], a[140:143], a[28:31], v[92:95]
    ds_read_b64_tr_b16 a[132:133], v231 offset:36864
    ds_read_b64_tr_b16 a[134:135], v231 offset:37888
    s_add_u32 s42, s40, 12288
    v_mfma_f32_16x16x32_bf16 v[92:95], a[136:139], a[20:23], v[92:95]
    s_waitcnt lgkmcnt(8)
    buffer_store_dwordx4 v[40:43], v245, s[48:51], 0 offen sc1
    v_mfma_f32_16x16x32_bf16 v[64:67], a[144:147], a[32:35], v[64:67]
    ds_read_b64_tr_b16 a[136:137], v254 offset:40960
    v_mfma_f32_16x16x32_bf16 v[64:67], a[148:151], a[40:43], v[64:67]
    ds_read_b64_tr_b16 a[138:139], v254 offset:41984
    v_mfma_f32_16x16x32_bf16 v[80:83], a[148:151], a[44:47], v[80:83]
    ds_read_b64_tr_b16 a[140:141], v254 offset:45056
    ds_read_b64_tr_b16 a[142:143], v254 offset:46080
    buffer_load_dwordx4 a[224:227], v243, s[48:51], s42 offen sc1
    v_mfma_f32_16x16x32_bf16 v[80:83], a[144:147], a[36:39], v[80:83]
    s_waitcnt lgkmcnt(10)
    buffer_store_dwordx4 v[44:47], v245, s[48:51], 0 offen offset:1024 sc1
    v_mfma_f32_16x16x32_bf16 v[68:71], a[152:155], a[32:35], v[68:71]
    buffer_load_dwordx4 a[228:231], v240, s[48:51], s42 offen offset:1024 sc1
    v_mfma_f32_16x16x32_bf16 v[68:71], a[156:159], a[40:43], v[68:71]
    ds_read_b64_tr_b16 a[144:145], v253 offset:40960
    ds_read_b64_tr_b16 a[146:147], v253 offset:41984
    v_cvt_pk_bf16_f32 v0, v0, v1
    v_mfma_f32_16x16x32_bf16 v[84:87], a[156:159], a[44:47], v[84:87]
    ds_read_b64_tr_b16 a[148:149], v253 offset:45056
    v_cvt_pk_bf16_f32 v1, v2, v3
    v_cvt_pk_bf16_f32 v2, v4, v5
    v_cvt_pk_bf16_f32 v3, v6, v7
    v_mfma_f32_16x16x32_bf16 v[84:87], a[152:155], a[36:39], v[84:87]
    ds_read_b64_tr_b16 a[150:151], v253 offset:46080
    v_cvt_pk_bf16_f32 v4, v8, v9
    v_cvt_pk_bf16_f32 v5, v10, v11
    s_waitcnt lgkmcnt(8)
    v_mfma_f32_16x16x32_bf16 v[72:75], a[160:163], a[32:35], v[72:75]
    buffer_load_dwordx4 a[232:235], v243, s[48:51], s42 offen offset:2048 sc1
    v_mfma_f32_16x16x32_bf16 v[72:75], a[164:167], a[40:43], v[72:75]
    ds_read_b64_tr_b16 a[152:153], v230 offset:40960
    ds_read_b64_tr_b16 a[154:155], v230 offset:41984
    v_cvt_pk_bf16_f32 v6, v12, v13
    v_mfma_f32_16x16x32_bf16 v[88:91], a[164:167], a[44:47], v[88:91]
    ds_read_b64_tr_b16 a[156:157], v230 offset:45056
    v_cvt_pk_bf16_f32 v7, v14, v15
    v_permlane16_swap_b32 v0, v4
    v_permlane16_swap_b32 v1, v5
    v_mfma_f32_16x16x32_bf16 v[88:91], a[160:163], a[36:39], v[88:91]
    ds_read_b64_tr_b16 a[158:159], v230 offset:46080
    v_permlane16_swap_b32 v2, v6
    v_permlane16_swap_b32 v3, v7
    v_mfma_f32_16x16x32_bf16 v[76:79], a[128:131], a[32:35], v[76:79]
    buffer_load_dwordx4 a[236:239], v240, s[48:51], s42 offen offset:3072 sc1
    v_mfma_f32_16x16x32_bf16 v[76:79], a[132:135], a[40:43], v[76:79]
    ds_read_b64_tr_b16 a[160:161], v231 offset:40960
    ds_read_b64_tr_b16 a[162:163], v231 offset:41984
    v_cvt_pk_bf16_f32 v16, v16, v17
    v_mfma_f32_16x16x32_bf16 v[92:95], a[132:135], a[44:47], v[92:95]
    ds_read_b64_tr_b16 a[164:165], v231 offset:45056
    v_cvt_pk_bf16_f32 v17, v18, v19
    v_mfma_f32_16x16x32_bf16 v[92:95], a[128:131], a[36:39], v[92:95]
    ds_read_b64_tr_b16 a[166:167], v231 offset:46080
    s_waitcnt vmcnt(22)
    s_barrier
    s_waitcnt lgkmcnt(8)
    v_mfma_f32_16x16x32_bf16 v[64:67], a[136:139], a[48:51], v[64:67]
    ds_read_b64_tr_b16 a[128:129], v254 offset:49152
    s_add_u32 m0, s62, 0
    v_add_u32 v238, 229376, v238
    v_cvt_pk_bf16_f32 v18, v20, v21
    v_mfma_f32_16x16x32_bf16 v[64:67], a[140:143], a[56:59], v[64:67]
    ds_read_b64_tr_b16 a[130:131], v254 offset:50176
    v_cvt_pk_bf16_f32 v19, v22, v23
    v_cvt_pk_bf16_f32 v20, v24, v25
    v_mfma_f32_16x16x32_bf16 v[80:83], a[140:143], a[60:63], v[80:83]
    buffer_load_dwordx4 v238, s[32:35], 0 offen lds
    v_mfma_f32_16x16x32_bf16 v[80:83], a[136:139], a[52:55], v[80:83]
    ds_read_b64_tr_b16 a[132:133], v254 offset:53248
    ds_read_b64_tr_b16 a[134:135], v254 offset:54272
    v_cvt_pk_bf16_f32 v21, v26, v27
    v_mfma_f32_16x16x32_bf16 v[68:71], a[144:147], a[48:51], v[68:71]
    ds_read_b64_tr_b16 a[136:137], v253 offset:49152
    v_cvt_pk_bf16_f32 v22, v28, v29
    v_cvt_pk_bf16_f32 v23, v30, v31
    v_permlane16_swap_b32 v16, v20
    v_mfma_f32_16x16x32_bf16 v[68:71], a[148:151], a[56:59], v[68:71]
    ds_read_b64_tr_b16 a[138:139], v253 offset:50176
    v_permlane16_swap_b32 v17, v21
    v_permlane16_swap_b32 v18, v22
    v_mfma_f32_16x16x32_bf16 v[84:87], a[148:151], a[60:63], v[84:87]
    buffer_load_dwordx4 v238, s[32:35], s14 offen offset:1024 lds
    v_mfma_f32_16x16x32_bf16 v[84:87], a[144:147], a[52:55], v[84:87]
    ds_read_b64_tr_b16 a[140:141], v253 offset:53248
    ds_read_b64_tr_b16 a[142:143], v253 offset:54272
    v_permlane16_swap_b32 v19, v23
    s_waitcnt lgkmcnt(8)
    v_mfma_f32_16x16x32_bf16 v[72:75], a[152:155], a[48:51], v[72:75]
    ds_read_b64_tr_b16 a[144:145], v230 offset:49152
    v_mfma_f32_16x16x32_bf16 v[72:75], a[156:159], a[56:59], v[72:75]
    ds_read_b64_tr_b16 a[146:147], v230 offset:50176
    ds_write_b128 v250, v[0:3] offset:2176
    v_mfma_f32_16x16x32_bf16 v[88:91], a[156:159], a[60:63], v[88:91]
    buffer_load_dwordx4 v238, s[32:35], s15 offen offset:2048 lds
    v_mfma_f32_16x16x32_bf16 v[88:91], a[152:155], a[52:55], v[88:91]
    ds_read_b64_tr_b16 a[148:149], v230 offset:53248
    ds_read_b64_tr_b16 a[150:151], v230 offset:54272
    v_mfma_f32_16x16x32_bf16 v[76:79], a[160:163], a[48:51], v[76:79]
    buffer_load_dwordx4 v238, s[32:35], s16 offen offset:3072 lds
    v_mfma_f32_16x16x32_bf16 v[76:79], a[164:167], a[56:59], v[76:79]
    ds_read_b64_tr_b16 a[152:153], v231 offset:49152
    ds_read_b64_tr_b16 a[154:155], v231 offset:50176
    v_mfma_f32_16x16x32_bf16 v[92:95], a[164:167], a[60:63], v[92:95]
    ds_read_b64_tr_b16 a[156:157], v231 offset:53248
    s_add_u32 s42, s40, 49152
    v_mfma_f32_16x16x32_bf16 v[92:95], a[160:163], a[52:55], v[92:95]
    ds_read_b64_tr_b16 a[158:159], v231 offset:54272
    s_waitcnt lgkmcnt(9)
    v_mfma_f32_16x16x32_bf16 v[64:67], a[128:131], a[64:67], v[64:67]
    ds_read_b64_tr_b16 a[160:161], v254 offset:57344
    v_mfma_f32_16x16x32_bf16 v[64:67], a[132:135], a[72:75], v[64:67]
    ds_read_b64_tr_b16 a[162:163], v254 offset:58368
    v_mfma_f32_16x16x32_bf16 v[80:83], a[132:135], a[76:79], v[80:83]
    buffer_load_dwordx4 a[240:243], v243, s[48:51], s42 offen sc1
    v_mfma_f32_16x16x32_bf16 v[80:83], a[128:131], a[68:71], v[80:83]
    ds_read_b64_tr_b16 a[164:165], v254 offset:61440
    ds_read_b64_tr_b16 a[166:167], v254 offset:62464
    v_mfma_f32_16x16x32_bf16 v[68:71], a[136:139], a[64:67], v[68:71]
    buffer_load_dwordx4 a[244:247], v240, s[48:51], s42 offen offset:1024 sc1
    v_mfma_f32_16x16x32_bf16 v[68:71], a[140:143], a[72:75], v[68:71]
    ds_read_b64_tr_b16 a[128:129], v253 offset:57344
    ds_read_b64_tr_b16 a[130:131], v253 offset:58368
    v_mfma_f32_16x16x32_bf16 v[84:87], a[140:143], a[76:79], v[84:87]
    s_waitcnt vmcnt(9)
    buffer_store_dword v241, v223, s[48:51], 0 offen sc1
    v_mfma_f32_16x16x32_bf16 v[84:87], a[136:139], a[68:71], v[84:87]
    ds_read_b64_tr_b16 a[132:133], v253 offset:61440
    ds_read_b64_tr_b16 a[134:135], v253 offset:62464
    ds_write_b128 v250, v[4:7] offset:2192
    s_waitcnt lgkmcnt(9)
    v_mfma_f32_16x16x32_bf16 v[72:75], a[144:147], a[64:67], v[72:75]
    buffer_load_dwordx4 a[248:251], v243, s[48:51], s42 offen offset:2048 sc1
    v_mfma_f32_16x16x32_bf16 v[72:75], a[148:151], a[72:75], v[72:75]
    ds_read_b64_tr_b16 a[136:137], v230 offset:57344
    ds_read_b64_tr_b16 a[138:139], v230 offset:58368
    v_mfma_f32_16x16x32_bf16 v[88:91], a[148:151], a[76:79], v[88:91]
    ds_read_b64_tr_b16 a[140:141], v230 offset:61440
    v_mfma_f32_16x16x32_bf16 v[88:91], a[144:147], a[68:71], v[88:91]
    ds_read_b64_tr_b16 a[142:143], v230 offset:62464
    v_mfma_f32_16x16x32_bf16 v[76:79], a[152:155], a[64:67], v[76:79]
    buffer_load_dwordx4 a[252:255], v240, s[48:51], s42 offen offset:3072 sc1
    v_mfma_f32_16x16x32_bf16 v[76:79], a[156:159], a[72:75], v[76:79]
    ds_read_b64_tr_b16 a[144:145], v231 offset:57344
    ds_read_b64_tr_b16 a[146:147], v231 offset:58368
    v_mfma_f32_16x16x32_bf16 v[92:95], a[156:159], a[76:79], v[92:95]
    ds_read_b64_tr_b16 a[148:149], v231 offset:61440
    v_mfma_f32_16x16x32_bf16 v[92:95], a[152:155], a[68:71], v[92:95]
    ds_read_b64_tr_b16 a[150:151], v231 offset:62464
    s_waitcnt lgkmcnt(9)
    v_mfma_f32_16x16x32_bf16 v[64:67], a[160:163], a[80:83], v[64:67]
    v_add_u32 v254, 65536, v254
    ds_read_b64_tr_b16 a[152:153], v254
    s_add_u32 m0, s62, 16384
    v_mfma_f32_16x16x32_bf16 v[64:67], a[164:167], a[88:91], v[64:67]
    ds_read_b64_tr_b16 a[154:155], v254 offset:1024
    v_add_u32 v238, 229376, v238
    v_mfma_f32_16x16x32_bf16 v[80:83], a[164:167], a[92:95], v[80:83]
    buffer_load_dwordx4 v238, s[32:35], 0 offen lds
    v_mfma_f32_16x16x32_bf16 v[80:83], a[160:163], a[84:87], v[80:83]
    ds_read_b64_tr_b16 a[156:157], v254 offset:4096
    ds_read_b64_tr_b16 a[158:159], v254 offset:5120
    v_mfma_f32_16x16x32_bf16 v[68:71], a[128:131], a[80:83], v[68:71]
    v_add_u32 v253, 65536, v253
    ds_read_b64_tr_b16 a[160:161], v253
    v_mfma_f32_16x16x32_bf16 v[68:71], a[132:135], a[88:91], v[68:71]
    ds_read_b64_tr_b16 a[162:163], v253 offset:1024
    ds_write_b128 v250, v[16:19] offset:2304
    v_mfma_f32_16x16x32_bf16 v[84:87], a[132:135], a[92:95], v[84:87]
    buffer_load_dwordx4 v238, s[32:35], s14 offen offset:1024 lds
    v_mfma_f32_16x16x32_bf16 v[84:87], a[128:131], a[84:87], v[84:87]
    ds_read_b64_tr_b16 a[164:165], v253 offset:4096
    ds_read_b64_tr_b16 a[166:167], v253 offset:5120
    s_waitcnt lgkmcnt(9)
    v_mfma_f32_16x16x32_bf16 v[72:75], a[136:139], a[80:83], v[72:75]
    v_add_u32 v230, 65536, v230
    ds_read_b64_tr_b16 a[128:129], v230
    buffer_load_dwordx4 v238, s[32:35], s15 offen offset:2048 lds
    v_mfma_f32_16x16x32_bf16 v[72:75], a[140:143], a[88:91], v[72:75]
    ds_read_b64_tr_b16 a[130:131], v230 offset:1024
    v_mfma_f32_16x16x32_bf16 v[88:91], a[140:143], a[92:95], v[88:91]
    ds_read_b64_tr_b16 a[132:133], v230 offset:4096
    v_mfma_f32_16x16x32_bf16 v[88:91], a[136:139], a[84:87], v[88:91]
    ds_read_b64_tr_b16 a[134:135], v230 offset:5120
    v_mfma_f32_16x16x32_bf16 v[76:79], a[144:147], a[80:83], v[76:79]
    v_add_u32 v231, 65536, v231
    ds_read_b64_tr_b16 a[136:137], v231
    buffer_load_dwordx4 v238, s[32:35], s16 offen offset:3072 lds
    v_mfma_f32_16x16x32_bf16 v[76:79], a[148:151], a[88:91], v[76:79]
    ds_read_b64_tr_b16 a[138:139], v231 offset:1024
    v_mfma_f32_16x16x32_bf16 v[92:95], a[148:151], a[92:95], v[92:95]
    buffer_load_dword v242, v246, s[48:51], 0 offen sc1
    v_mfma_f32_16x16x32_bf16 v[92:95], a[144:147], a[84:87], v[92:95]
    ds_read_b64_tr_b16 a[140:141], v231 offset:4096
    ds_read_b64_tr_b16 a[142:143], v231 offset:5120
    s_waitcnt lgkmcnt(8)
    v_mfma_f32_16x16x32_bf16 v[64:67], a[152:155], a[96:99], v[64:67]
    ds_read_b64_tr_b16 a[144:145], v254 offset:8192
    s_add_u32 s42, s40, 53248
    v_mfma_f32_16x16x32_bf16 v[64:67], a[156:159], a[104:107], v[64:67]
    ds_read_b64_tr_b16 a[146:147], v254 offset:9216
    v_lshl_add_u32 v236, v255, 4, s20
    v_mfma_f32_16x16x32_bf16 v[80:83], a[156:159], a[108:111], v[80:83]
    buffer_load_dwordx4 v[96:99], v243, s[48:51], s42 offen sc1
    v_mfma_f32_16x16x32_bf16 v[80:83], a[152:155], a[100:103], v[80:83]
    ds_read_b64_tr_b16 a[148:149], v254 offset:12288
    ds_read_b64_tr_b16 a[150:151], v254 offset:13312
    v_mfma_f32_16x16x32_bf16 v[68:71], a[160:163], a[96:99], v[68:71]
    ds_read_b64_tr_b16 a[152:153], v253 offset:8192
    v_mfma_f32_16x16x32_bf16 v[68:71], a[164:167], a[104:107], v[68:71]
    ds_read_b64_tr_b16 a[154:155], v253 offset:9216
    ds_write_b128 v250, v[20:23] offset:2320
    v_mfma_f32_16x16x32_bf16 v[84:87], a[164:167], a[108:111], v[84:87]
    buffer_load_dwordx4 v[100:103], v240, s[48:51], s42 offen offset:1024 sc1
    v_mfma_f32_16x16x32_bf16 v[84:87], a[160:163], a[100:103], v[84:87]
    ds_read_b64_tr_b16 a[156:157], v253 offset:12288
    ds_read_b64_tr_b16 a[158:159], v253 offset:13312
    s_waitcnt lgkmcnt(9)
    v_mfma_f32_16x16x32_bf16 v[72:75], a[128:131], a[96:99], v[72:75]
    buffer_load_dwordx4 v[104:107], v243, s[48:51], s42 offen offset:2048 sc1
    v_mfma_f32_16x16x32_bf16 v[72:75], a[132:135], a[104:107], v[72:75]
    ds_read_b64_tr_b16 a[160:161], v230 offset:8192
    ds_read_b64_tr_b16 a[162:163], v230 offset:9216
    v_mfma_f32_16x16x32_bf16 v[88:91], a[132:135], a[108:111], v[88:91]
    ds_read_b64_tr_b16 a[164:165], v230 offset:12288
    v_lshl_add_u32 v245, v255, 4, s23
    v_mfma_f32_16x16x32_bf16 v[88:91], a[128:131], a[100:103], v[88:91]
    ds_read_b64_tr_b16 a[166:167], v230 offset:13312
    v_and_b32 v244, 7, v255
    v_mfma_f32_16x16x32_bf16 v[76:79], a[136:139], a[96:99], v[76:79]
    buffer_load_dwordx4 v[108:111], v240, s[48:51], s42 offen offset:3072 sc1
    v_mfma_f32_16x16x32_bf16 v[76:79], a[140:143], a[104:107], v[76:79]
    ds_read_b64_tr_b16 a[128:129], v231 offset:8192
    ds_read_b64_tr_b16 a[130:131], v231 offset:9216
    v_mfma_f32_16x16x32_bf16 v[92:95], a[140:143], a[108:111], v[92:95]
    ds_read_b64_tr_b16 a[132:133], v231 offset:12288
    v_mfma_f32_16x16x32_bf16 v[92:95], a[136:139], a[100:103], v[92:95]
    ds_read_b64_tr_b16 a[134:135], v231 offset:13312
    s_waitcnt lgkmcnt(10)
    s_barrier
    s_waitcnt lgkmcnt(8)
    v_mfma_f32_16x16x32_bf16 v[64:67], a[144:147], a[112:115], v[64:67]
    ds_read_b64_tr_b16 a[136:137], v254 offset:16384
    s_add_u32 m0, s62, 32768
    v_mfma_f32_16x16x32_bf16 v[64:67], a[148:151], a[120:123], v[64:67]
    ds_read_b64_tr_b16 a[138:139], v254 offset:17408
    v_add_u32 v238, 229376, v238
    v_mfma_f32_16x16x32_bf16 v[80:83], a[148:151], a[124:127], v[80:83]
    buffer_load_dwordx4 v238, s[32:35], 0 offen lds
    v_mfma_f32_16x16x32_bf16 v[80:83], a[144:147], a[116:119], v[80:83]
    ds_read_b64_tr_b16 a[140:141], v254 offset:20480
    ds_read_b64_tr_b16 a[142:143], v254 offset:21504
    v_mfma_f32_16x16x32_bf16 v[68:71], a[152:155], a[112:115], v[68:71]
    buffer_load_dwordx4 v238, s[32:35], s14 offen offset:1024 lds
    v_mfma_f32_16x16x32_bf16 v[68:71], a[156:159], a[120:123], v[68:71]
    ds_read_b64_tr_b16 a[144:145], v254 offset:24576
    ds_read_b64_tr_b16 a[146:147], v254 offset:25600
    v_mfma_f32_16x16x32_bf16 v[84:87], a[156:159], a[124:127], v[84:87]
    buffer_load_dwordx4 v238, s[32:35], s15 offen offset:2048 lds
    v_mfma_f32_16x16x32_bf16 v[84:87], a[152:155], a[116:119], v[84:87]
    ds_read_b64_tr_b16 a[148:149], v254 offset:28672
    ds_read_b64_tr_b16 a[150:151], v254 offset:29696
    s_waitcnt lgkmcnt(8)
    v_mfma_f32_16x16x32_bf16 v[72:75], a[160:163], a[112:115], v[72:75]
    ds_read_b64_tr_b16 a[152:153], v253 offset:16384
    v_lshrrev_b32 v252, 2, v244
    v_mfma_f32_16x16x32_bf16 v[72:75], a[164:167], a[120:123], v[72:75]
    ds_read_b64_tr_b16 a[154:155], v253 offset:17408
    v_lshl_add_u32 v244, v244, 2, s21
    v_mfma_f32_16x16x32_bf16 v[88:91], a[164:167], a[124:127], v[88:91]
    buffer_load_dwordx4 v238, s[32:35], s16 offen offset:3072 lds
    v_mfma_f32_16x16x32_bf16 v[88:91], a[160:163], a[116:119], v[88:91]
    ds_read_b64_tr_b16 a[156:157], v253 offset:20480
    ds_read_b64_tr_b16 a[158:159], v253 offset:21504
    s_add_u32 s42, s41, 0
    v_mfma_f32_16x16x32_bf16 v[76:79], a[128:131], a[112:115], v[76:79]
    buffer_load_dwordx4 v[112:115], v243, s[48:51], s42 offen sc1
    v_mfma_f32_16x16x32_bf16 v[76:79], a[132:135], a[120:123], v[76:79]
    ds_read_b64_tr_b16 a[160:161], v253 offset:24576
    ds_read_b64_tr_b16 a[162:163], v253 offset:25600
    v_mfma_f32_16x16x32_bf16 v[92:95], a[132:135], a[124:127], v[92:95]
    buffer_load_dwordx4 v[116:119], v240, s[48:51], s42 offen offset:1024 sc1
    v_mfma_f32_16x16x32_bf16 v[92:95], a[128:131], a[116:119], v[92:95]
    ds_read_b64_tr_b16 a[164:165], v253 offset:28672
    ds_read_b64_tr_b16 a[166:167], v253 offset:29696
    s_waitcnt lgkmcnt(8)
    v_mfma_f32_16x16x32_bf16 v[0:3], a[136:139], a[0:3], 0
    ds_read_b64_tr_b16 a[128:129], v230 offset:16384
    v_mfma_f32_16x16x32_bf16 v[0:3], a[140:143], a[8:11], v[0:3]
    ds_read_b64_tr_b16 a[130:131], v230 offset:17408
    v_mfma_f32_16x16x32_bf16 v[32:35], a[140:143], a[12:15], 0
    buffer_load_dwordx4 v[120:123], v243, s[48:51], s42 offen offset:2048 sc1
    v_mfma_f32_16x16x32_bf16 v[32:35], a[136:139], a[4:7], v[32:35]
    ds_read_b64_tr_b16 a[132:133], v230 offset:20480
    ds_read_b64_tr_b16 a[134:135], v230 offset:21504
    v_mfma_f32_16x16x32_bf16 v[16:19], a[144:147], a[0:3], 0
    buffer_load_dwordx4 v[124:127], v240, s[48:51], s42 offen offset:3072 sc1
    v_mfma_f32_16x16x32_bf16 v[16:19], a[148:151], a[8:11], v[16:19]
    ds_read_b64_tr_b16 a[136:137], v230 offset:24576
    ds_read_b64_tr_b16 a[138:139], v230 offset:25600
    v_cvt_pk_bf16_f32 v64, v64, v65
    v_mfma_f32_16x16x32_bf16 v[48:51], a[148:151], a[12:15], 0
    ds_read_b64_tr_b16 a[140:141], v230 offset:28672
    s_waitcnt vmcnt(12)
    v_cmp_gt_u32 vcc, s78, v242
    s_cbranch_vccnz L_B_p4_slow
L_B_p4_ok:
    v_mfma_f32_16x16x32_bf16 v[48:51], a[144:147], a[4:7], v[48:51]
    ds_read_b64_tr_b16 a[142:143], v230 offset:29696
    v_cvt_pk_bf16_f32 v65, v66, v67
    v_cvt_pk_bf16_f32 v66, v68, v69
    s_waitcnt lgkmcnt(8)
    v_mfma_f32_16x16x32_bf16 v[4:7], a[152:155], a[0:3], 0
    ds_read_b64_tr_b16 a[144:145], v231 offset:16384
    s_mov_b32 m0, s70
    v_cvt_pk_bf16_f32 v67, v70, v71
    v_cvt_pk_bf16_f32 v68, v72, v73
    v_mfma_f32_16x16x32_bf16 v[4:7], a[156:159], a[8:11], v[4:7]
    ds_read_b64_tr_b16 a[146:147], v231 offset:17408
    v_cvt_pk_bf16_f32 v69, v74, v75
    v_cvt_pk_bf16_f32 v70, v76, v77
    v_mfma_f32_16x16x32_bf16 v[36:39], a[156:159], a[12:15], 0
    buffer_load_dwordx4 v247, s[48:51], 0 offen sc1 lds
    v_mfma_f32_16x16x32_bf16 v[36:39], a[152:155], a[4:7], v[36:39]
    ds_read_b64_tr_b16 a[148:149], v231 offset:20480
    ds_read_b64_tr_b16 a[150:151], v231 offset:21504
    v_cvt_pk_bf16_f32 v71, v78, v79
    v_mfma_f32_16x16x32_bf16 v[20:23], a[160:163], a[0:3], 0
    buffer_load_dwordx4 v247, s[48:51], 0 offen offset:1024 sc1 lds
    v_mfma_f32_16x16x32_bf16 v[20:23], a[164:167], a[8:11], v[20:23]
    ds_read_b64_tr_b16 a[152:153], v231 offset:24576
    ds_read_b64_tr_b16 a[154:155], v231 offset:25600
    v_permlane16_swap_b32 v64, v68
    v_permlane16_swap_b32 v65, v69
    v_mfma_f32_16x16x32_bf16 v[52:55], a[164:167], a[12:15], 0
    ds_read_b64_tr_b16 a[156:157], v231 offset:28672
    v_permlane16_swap_b32 v66, v70
    v_permlane16_swap_b32 v67, v71
    v_cvt_pk_bf16_f32 v72, v80, v81
    v_mfma_f32_16x16x32_bf16 v[52:55], a[160:163], a[4:7], v[52:55]
    ds_read_b64_tr_b16 a[158:159], v231 offset:29696
    v_cvt_pk_bf16_f32 v73, v82, v83
    v_cvt_pk_bf16_f32 v74, v84, v85
    s_waitcnt lgkmcnt(8)
    v_mfma_f32_16x16x32_bf16 v[8:11], a[128:131], a[0:3], 0
    ds_read_b64_tr_b16 a[160:161], v254 offset:32768
    ds_read_b64_tr_b16 a[162:163], v254 offset:33792
    s_add_u32 m0, s62, 49152
    v_add_u32 v238, 229376, v238
    v_cvt_pk_bf16_f32 v75, v86, v87
    v_cvt_pk_bf16_f32 v76, v88, v89
    v_mfma_f32_16x16x32_bf16 v[8:11], a[132:135], a[8:11], v[8:11]
    ds_read_b128 v[176:179], v250 offset:6528
    ds_read_b128 v[180:183], v250 offset:6544
    v_mfma_f32_16x16x32_bf16 v[40:43], a[132:135], a[12:15], 0
    ds_read_b64_tr_b16 a[164:165], v254 offset:36864
    buffer_load_dwordx4 v238, s[32:35], 0 offen lds
    v_cvt_pk_bf16_f32 v77, v90, v91
    v_mfma_f32_16x16x32_bf16 v[40:43], a[128:131], a[4:7], v[40:43]
    ds_read_b64_tr_b16 a[166:167], v254 offset:37888
    v_cvt_pk_bf16_f32 v78, v92, v93
    ds_read_b128 v[184:187], v250 offset:5440
    v_mfma_f32_16x16x32_bf16 v[24:27], a[136:139], a[0:3], 0
    ds_read_b64_tr_b16 a[128:129], v254 offset:40960
    v_cvt_pk_bf16_f32 v79, v94, v95
    v_permlane16_swap_b32 v72, v76
    v_permlane16_swap_b32 v73, v77
    v_permlane16_swap_b32 v74, v78
    v_mfma_f32_16x16x32_bf16 v[24:27], a[140:143], a[8:11], v[24:27]
    ds_read_b64_tr_b16 a[130:131], v254 offset:41984
    v_permlane16_swap_b32 v75, v79
    ds_read_b128 v[188:191], v250 offset:5456
    v_mfma_f32_16x16x32_bf16 v[56:59], a[140:143], a[12:15], 0
    ds_read_b64_tr_b16 a[132:133], v254 offset:45056
    buffer_load_dwordx4 v238, s[32:35], s14 offen offset:1024 lds
    v_mov_b32 v214, 0xf149f2ca
    v_mfma_f32_16x16x32_bf16 v[56:59], a[136:139], a[4:7], v[56:59]
    ds_read_b64_tr_b16 a[134:135], v254 offset:46080
    ds_read_b128 v[192:195], v250 offset:4352
    ds_read_b128 v[196:199], v250 offset:4368
    s_waitcnt lgkmcnt(14)
    v_mfma_f32_16x16x32_bf16 v[12:15], a[144:147], a[0:3], 0
    ds_read_b64_tr_b16 a[136:137], v253 offset:32768
    v_mfma_f32_16x16x32_bf16 v[12:15], a[148:151], a[8:11], v[12:15]
    ds_read_b64_tr_b16 a[138:139], v253 offset:33792
    v_mfma_f32_16x16x32_bf16 v[44:47], a[148:151], a[12:15], 0
    buffer_load_dwordx4 v238, s[32:35], s15 offen offset:2048 lds
    v_mfma_f32_16x16x32_bf16 v[44:47], a[144:147], a[4:7], v[44:47]
    ds_read_b64_tr_b16 a[140:141], v253 offset:36864
    ds_read_b64_tr_b16 a[142:143], v253 offset:37888
    s_waitcnt lgkmcnt(14)
    v_mfma_f32_4x4x4_16b_bf16 v[200:203], v[176:177], v[72:73], 0
    s_waitcnt lgkmcnt(11)
    v_mfma_f32_4x4x4_16b_bf16 v[204:207], v[184:185], v[72:73], 0
    s_waitcnt lgkmcnt(5)
    v_mfma_f32_4x4x4_16b_bf16 v[208:211], v[192:193], v[72:73], 0
    v_mfma_f32_4x4x4_16b_bf16 v[200:203], v[178:179], v[74:75], v[200:203]
    v_mfma_f32_4x4x4_16b_bf16 v[204:207], v[186:187], v[74:75], v[204:207]
    v_mfma_f32_4x4x4_16b_bf16 v[208:211], v[194:195], v[74:75], v[208:211]
    v_mfma_f32_16x16x32_bf16 v[28:31], a[152:155], a[0:3], 0
    buffer_load_dwordx4 v238, s[32:35], s16 offen offset:3072 lds
    v_mfma_f32_16x16x32_bf16 v[28:31], a[156:159], a[8:11], v[28:31]
    ds_read_b64_tr_b16 a[144:145], v253 offset:40960
    ds_read_b64_tr_b16 a[146:147], v253 offset:41984
    v_mfma_f32_4x4x4_16b_bf16 v[200:203], v[180:181], v[76:77], v[200:203]
    v_mfma_f32_4x4x4_16b_bf16 v[204:207], v[188:189], v[76:77], v[204:207]
    s_waitcnt lgkmcnt(6)
    v_mfma_f32_4x4x4_16b_bf16 v[208:211], v[196:197], v[76:77], v[208:211]
    v_mfma_f32_4x4x4_16b_bf16 v[200:203], v[182:183], v[78:79], v[200:203]
    v_mfma_f32_4x4x4_16b_bf16 v[204:207], v[190:191], v[78:79], v[204:207]
    v_mfma_f32_4x4x4_16b_bf16 v[208:211], v[198:199], v[78:79], v[208:211]
    v_mfma_f32_16x16x32_bf16 v[60:63], a[156:159], a[12:15], 0
    ds_read_b64_tr_b16 a[148:149], v253 offset:45056
    s_add_u32 s42, s41, 4096
    ds_read_b64_tr_b16 v[176:177], v249 offset:6656
    ds_read_b64_tr_b16 v[178:179], v249 offset:6672
    v_mfma_f32_16x16x32_bf16 v[60:63], a[152:155], a[4:7], v[60:63]
    ds_read_b64_tr_b16 a[150:151], v253 offset:46080
    ds_read_b64_tr_b16 v[180:181], v249 offset:6664
    ds_read_b64_tr_b16 v[182:183], v249 offset:6680
    v_mfma_f32_16x16x32_bf16 v[0:3], a[160:163], a[16:19], v[0:3]
    ds_read_b64_tr_b16 a[152:153], v230 offset:32768
    v_cndmask_b32 v201, v209, v201, s[72:73]
    v_cndmask_b32 v202, v210, v202, s[74:75]
    v_cndmask_b32 v203, v211, v203, s[76:77]
    v_mfma_f32_16x16x32_bf16 v[0:3], a[164:167], a[24:27], v[0:3]
    ds_read_b64_tr_b16 a[154:155], v230 offset:33792
    v_max3_f32 v212, v200, v201, v202
    v_max3_f32 v213, v203, v204, v205
    v_mfma_f32_16x16x32_bf16 v[32:35], a[164:167], a[28:31], v[32:35]
    buffer_load_dwordx4 v[128:131], v243, s[48:51], s42 offen sc1
    v_mfma_f32_16x16x32_bf16 v[32:35], a[160:163], a[20:23], v[32:35]
    ds_read_b64_tr_b16 a[156:157], v230 offset:36864
    ds_read_b64_tr_b16 a[158:159], v230 offset:37888
    v_max3_f32 v212, v212, v206, v207
    v_mfma_f32_16x16x32_bf16 v[16:19], a[128:131], a[16:19], v[16:19]
    buffer_load_dwordx4 v[132:135], v240, s[48:51], s42 offen offset:1024 sc1
    v_mfma_f32_16x16x32_bf16 v[16:19], a[132:135], a[24:27], v[16:19]
    ds_read_b64_tr_b16 a[160:161], v230 offset:40960
    ds_read_b64_tr_b16 a[162:163], v230 offset:41984
    v_max_f32 v212, v212, v213
    v_mul_f32 v212, 0xbeb8aa3b, v212
    v_mfma_f32_16x16x32_bf16 v[48:51], a[132:135], a[28:31], v[48:51]
    ds_read_b64_tr_b16 a[164:165], v230 offset:45056
    ds_read_b64_tr_b16 v[184:185], v249 offset:5568
    ds_read_b64_tr_b16 v[186:187], v249 offset:5584
    ds_read_b64_tr_b16 v[188:189], v249 offset:5576
    v_mfma_f32_16x16x32_bf16 v[48:51], a[128:131], a[20:23], v[48:51]
    ds_read_b64_tr_b16 a[166:167], v230 offset:46080
    ds_read_b64_tr_b16 v[190:191], v249 offset:5592
    v_fma_f32 v200, v200, s7, v212
    s_waitcnt lgkmcnt(14)
    v_mfma_f32_16x16x32_bf16 v[4:7], a[136:139], a[16:19], v[4:7]
    buffer_load_dwordx4 v[136:139], v243, s[48:51], s42 offen offset:2048 sc1
    v_mfma_f32_16x16x32_bf16 v[4:7], a[140:143], a[24:27], v[4:7]
    ds_read_b64_tr_b16 a[128:129], v231 offset:32768
    ds_read_b64_tr_b16 a[130:131], v231 offset:33792
    v_fma_f32 v201, v201, s7, v212
    v_mfma_f32_16x16x32_bf16 v[36:39], a[140:143], a[28:31], v[36:39]
    ds_read_b64_tr_b16 a[132:133], v231 offset:36864
    v_fma_f32 v202, v202, s7, v212
    v_fma_f32 v203, v203, s7, v212
    v_fma_f32 v204, v204, s7, v212
    v_mfma_f32_16x16x32_bf16 v[36:39], a[136:139], a[20:23], v[36:39]
    ds_read_b64_tr_b16 a[134:135], v231 offset:37888
    v_fma_f32 v205, v205, s7, v212
    v_fma_f32 v206, v206, s7, v212
    v_mfma_f32_16x16x32_bf16 v[20:23], a[144:147], a[16:19], v[20:23]
    buffer_load_dwordx4 v[140:143], v240, s[48:51], s42 offen offset:3072 sc1
    v_mfma_f32_16x16x32_bf16 v[20:23], a[148:151], a[24:27], v[20:23]
    ds_read_b64_tr_b16 a[136:137], v231 offset:40960
    ds_read_b64_tr_b16 a[138:139], v231 offset:41984
    v_fma_f32 v207, v207, s7, v212
    v_mfma_f32_16x16x32_bf16 v[52:55], a[148:151], a[28:31], v[52:55]
    v_exp_f32 v200, v200
    v_mfma_f32_16x16x32_bf16 v[52:55], a[144:147], a[20:23], v[52:55]
    ds_read_b64_tr_b16 a[140:141], v231 offset:45056
    ds_read_b64_tr_b16 a[142:143], v231 offset:46080
    s_barrier
    s_waitcnt lgkmcnt(9)
    v_mfma_f32_16x16x32_bf16 v[8:11], a[152:155], a[16:19], v[8:11]
    v_subrev_u32 v254, 65536, v254
    ds_read_b64_tr_b16 a[144:145], v254
    s_add_u32 m0, s62, 65536
    v_add_u32 v238, 229376, v238
    v_mfma_f32_16x16x32_bf16 v[8:11], a[156:159], a[24:27], v[8:11]
    ds_read_b64_tr_b16 a[146:147], v254 offset:1024
    v_exp_f32 v201, v201
    v_mfma_f32_16x16x32_bf16 v[40:43], a[156:159], a[28:31], v[40:43]
    buffer_load_dwordx4 v238, s[32:35], 0 offen lds
    v_mfma_f32_16x16x32_bf16 v[40:43], a[152:155], a[20:23], v[40:43]
    ds_read_b64_tr_b16 a[148:149], v254 offset:4096
    ds_read_b64_tr_b16 a[150:151], v254 offset:5120
    v_exp_f32 v202, v202
    v_mfma_f32_16x16x32_bf16 v[24:27], a[160:163], a[16:19], v[24:27]
    v_exp_f32 v203, v203
    v_exp_f32 v204, v204
    v_mfma_f32_16x16x32_bf16 v[24:27], a[164:167], a[24:27], v[24:27]
    ds_read_b64_tr_b16 a[152:153], v254 offset:8192
    ds_read_b64_tr_b16 a[154:155], v254 offset:9216
    v_exp_f32 v205, v205
    v_mfma_f32_16x16x32_bf16 v[56:59], a[164:167], a[28:31], v[56:59]
    buffer_load_dwordx4 v238, s[32:35], s14 offen offset:1024 lds
    v_mfma_f32_16x16x32_bf16 v[56:59], a[160:163], a[20:23], v[56:59]
    ds_read_b64_tr_b16 a[156:157], v254 offset:12288
    ds_read_b64_tr_b16 a[158:159], v254 offset:13312
    s_waitcnt lgkmcnt(8)
    v_mfma_f32_16x16x32_bf16 v[12:15], a[128:131], a[16:19], v[12:15]
    v_subrev_u32 v253, 65536, v253
    ds_read_b64_tr_b16 a[160:161], v253
    v_exp_f32 v206, v206
    v_exp_f32 v207, v207
    v_mfma_f32_16x16x32_bf16 v[12:15], a[132:135], a[24:27], v[12:15]
    ds_read_b64_tr_b16 a[162:163], v253 offset:1024
    v_add_f32 v208, v200, v201
    v_add_f32 v209, v202, v203
    v_mfma_f32_16x16x32_bf16 v[44:47], a[132:135], a[28:31], v[44:47]
    buffer_load_dwordx4 v238, s[32:35], s15 offen offset:2048 lds
    v_mfma_f32_16x16x32_bf16 v[44:47], a[128:131], a[20:23], v[44:47]
    ds_read_b64_tr_b16 a[164:165], v253 offset:4096
    ds_read_b64_tr_b16 a[166:167], v253 offset:5120
    v_add_f32 v210, v204, v205
    v_mfma_f32_16x16x32_bf16 v[28:31], a[136:139], a[16:19], v[28:31]
    buffer_load_dwordx4 v238, s[32:35], s16 offen offset:3072 lds
    v_mfma_f32_16x16x32_bf16 v[28:31], a[140:143], a[24:27], v[28:31]
    ds_read_b64_tr_b16 a[128:129], v253 offset:8192
    ds_read_b64_tr_b16 a[130:131], v253 offset:9216
    v_add_f32 v211, v206, v207
    v_add_f32 v208, v208, v209
    v_mfma_f32_16x16x32_bf16 v[60:63], a[140:143], a[28:31], v[60:63]
    ds_read_b64_tr_b16 a[132:133], v253 offset:12288
    s_add_u32 s42, s41, 8192
    v_add_f32 v210, v210, v211
    v_add_f32 v208, v208, v210
    v_mfma_f32_16x16x32_bf16 v[60:63], a[136:139], a[20:23], v[60:63]
    ds_read_b64_tr_b16 a[134:135], v253 offset:13312
    v_rcp_f32 v213, v208
    s_waitcnt lgkmcnt(8)
    v_mfma_f32_16x16x32_bf16 v[0:3], a[144:147], a[32:35], v[0:3]
    v_subrev_u32 v230, 65536, v230
    ds_read_b64_tr_b16 a[136:137], v230
    ds_read_b64_tr_b16 v[192:193], v249 offset:4480
    ds_read_b64_tr_b16 v[194:195], v249 offset:4496
    v_mfma_f32_16x16x32_bf16 v[0:3], a[148:151], a[40:43], v[0:3]
    ds_read_b64_tr_b16 a[138:139], v230 offset:1024
    ds_read_b64_tr_b16 v[196:197], v249 offset:4488
    ds_read_b64_tr_b16 v[198:199], v249 offset:4504
    v_mfma_f32_16x16x32_bf16 v[32:35], a[148:151], a[44:47], v[32:35]
    buffer_load_dwordx4 v[144:147], v243, s[48:51], s42 offen sc1
    v_mfma_f32_16x16x32_bf16 v[32:35], a[144:147], a[36:39], v[32:35]
    ds_read_b64_tr_b16 a[140:141], v230 offset:4096
    ds_read_b64_tr_b16 a[142:143], v230 offset:5120
    v_mul_f32 v200, v200, v213
    v_mul_f32 v201, v201, v213
    v_mfma_f32_16x16x32_bf16 v[16:19], a[152:155], a[32:35], v[16:19]
    buffer_load_dwordx4 v[148:151], v240, s[48:51], s42 offen offset:1024 sc1
    v_mfma_f32_16x16x32_bf16 v[16:19], a[156:159], a[40:43], v[16:19]
    ds_read_b64_tr_b16 a[144:145], v230 offset:8192
    ds_read_b64_tr_b16 a[146:147], v230 offset:9216
    v_mul_f32 v202, v202, v213
    v_mfma_f32_16x16x32_bf16 v[48:51], a[156:159], a[44:47], v[48:51]
    ds_read_b64_tr_b16 a[148:149], v230 offset:12288
    v_mul_f32 v203, v203, v213
    v_mul_f32 v204, v204, v213
    v_mul_f32 v205, v205, v213
    v_mfma_f32_16x16x32_bf16 v[48:51], a[152:155], a[36:39], v[48:51]
    ds_read_b64_tr_b16 a[150:151], v230 offset:13312
    v_mul_f32 v206, v206, v213
    v_mul_f32 v207, v207, v213
    s_waitcnt lgkmcnt(12)
    v_mfma_f32_16x16x32_bf16 v[4:7], a[160:163], a[32:35], v[4:7]
    v_subrev_u32 v231, 65536, v231
    ds_read_b64_tr_b16 a[152:153], v231
    buffer_load_dwordx4 v[152:155], v243, s[48:51], s42 offen offset:2048 sc1
    v_mfma_f32_16x16x32_bf16 v[4:7], a[164:167], a[40:43], v[4:7]
    ds_read_b64_tr_b16 a[154:155], v231 offset:1024
    v_cvt_pk_bf16_f32 v208, v200, v201
    v_cvt_pk_bf16_f32 v209, v202, v203
    v_mfma_f32_16x16x32_bf16 v[36:39], a[164:167], a[44:47], v[36:39]
    ds_read_b64_tr_b16 a[156:157], v231 offset:4096
    v_cvt_pk_bf16_f32 v226, v204, v205
    v_cvt_pk_bf16_f32 v227, v206, v207
    v_and_b32 v224, v208, v234
    v_mfma_f32_16x16x32_bf16 v[36:39], a[160:163], a[36:39], v[36:39]
    ds_read_b64_tr_b16 a[158:159], v231 offset:5120
    v_and_b32 v225, v209, v233
    v_bfi_b32 v228, v234, 0, v208
    v_mfma_f32_16x16x32_bf16 v[20:23], a[128:131], a[32:35], v[20:23]
    buffer_load_dwordx4 v[156:159], v240, s[48:51], s42 offen offset:3072 sc1
    v_mfma_f32_16x16x32_bf16 v[20:23], a[132:135], a[40:43], v[20:23]
    ds_read_b64_tr_b16 a[160:161], v231 offset:8192
    ds_read_b64_tr_b16 a[162:163], v231 offset:9216
    v_bfi_b32 v229, v233, 0, v209
    v_mfma_f32_16x16x32_bf16 v[52:55], a[132:135], a[44:47], v[52:55]
    ds_read_b64_tr_b16 a[164:165], v231 offset:12288
    v_mfma_f32_16x16x32_bf16 v[52:55], a[128:131], a[36:39], v[52:55]
    ds_read_b64_tr_b16 a[166:167], v231 offset:13312
    v_mfma_f32_4x4x4_16b_bf16 v[80:83], v[176:177], v[224:225], 0
    v_mfma_f32_4x4x4_16b_bf16 v[84:87], v[178:179], v[224:225], 0
    v_mfma_f32_4x4x4_16b_bf16 v[88:91], v[180:181], v[224:225], 0
    v_mfma_f32_4x4x4_16b_bf16 v[92:95], v[182:183], v[224:225], 0
    v_mfma_f32_4x4x4_16b_bf16 v[80:83], v[184:185], v[226:227], v[80:83]
    v_mfma_f32_4x4x4_16b_bf16 v[84:87], v[186:187], v[226:227], v[84:87]
    v_mfma_f32_4x4x4_16b_bf16 v[88:91], v[188:189], v[226:227], v[88:91]
    v_mfma_f32_4x4x4_16b_bf16 v[92:95], v[190:191], v[226:227], v[92:95]
    s_waitcnt lgkmcnt(8)
    v_mfma_f32_16x16x32_bf16 v[8:11], a[136:139], a[32:35], v[8:11]
    ds_read_b64_tr_b16 a[128:129], v254 offset:16384
    s_add_u32 m0, s62, 81920
    v_mfma_f32_16x16x32_bf16 v[8:11], a[140:143], a[40:43], v[8:11]
    ds_read_b64_tr_b16 a[130:131], v254 offset:17408
    v_add_u32 v238, 229376, v238
    v_mfma_f32_4x4x4_16b_bf16 v[80:83], v[192:193], v[228:229], v[80:83]
    v_mfma_f32_4x4x4_16b_bf16 v[84:87], v[194:195], v[228:229], v[84:87]
    v_mfma_f32_4x4x4_16b_bf16 v[88:91], v[196:197], v[228:229], v[88:91]
    v_mfma_f32_4x4x4_16b_bf16 v[92:95], v[198:199], v[228:229], v[92:95]
    v_mfma_f32_16x16x32_bf16 v[40:43], a[140:143], a[44:47], v[40:43]
    ds_read_b64_tr_b16 a[132:133], v254 offset:20480
    ds_read_b64_tr_b16 a[134:135], v254 offset:21504
    buffer_load_dwordx4 v238, s[32:35], 0 offen lds
    s_waitcnt vmcnt(17)
    v_mfma_f32_16x16x32_bf16 v[40:43], a[136:139], a[36:39], v[40:43]
    ds_read_b128 v[176:179], v250 offset:2176
    ds_read_b128 v[180:183], v250 offset:2192
    v_mfma_f32_16x16x32_bf16 v[24:27], a[144:147], a[32:35], v[24:27]
    ds_read_b64_tr_b16 a[136:137], v254 offset:24576
    ds_read_b64_tr_b16 a[138:139], v254 offset:25600
    v_cvt_pk_bf16_f32 v80, v80, v81
    v_cvt_pk_bf16_f32 v81, v82, v83
    v_cvt_pk_bf16_f32 v82, v84, v85
    v_cvt_pk_bf16_f32 v83, v86, v87
    v_mfma_f32_16x16x32_bf16 v[24:27], a[148:151], a[40:43], v[24:27]
    ds_read_b128 v[184:187], v250 offset:1088
    ds_read_b128 v[188:191], v250 offset:1104
    v_mfma_f32_16x16x32_bf16 v[56:59], a[148:151], a[44:47], v[56:59]
    ds_read_b64_tr_b16 a[140:141], v254 offset:28672
    ds_read_b64_tr_b16 a[142:143], v254 offset:29696
    buffer_load_dwordx4 v238, s[32:35], s14 offen offset:1024 lds
    v_mfma_f32_16x16x32_bf16 v[56:59], a[144:147], a[36:39], v[56:59]
    buffer_store_dwordx4 v[80:83], v251, s[48:51], s5 offen offset:256 sc1
    s_waitcnt lgkmcnt(12)
    v_mfma_f32_16x16x32_bf16 v[12:15], a[152:155], a[32:35], v[12:15]
    v_cvt_pk_bf16_f32 v84, v88, v89
    v_cvt_pk_bf16_f32 v85, v90, v91
    ds_read_b128 v[192:195], v250
    v_mfma_f32_16x16x32_bf16 v[12:15], a[156:159], a[40:43], v[12:15]
    ds_read_b64_tr_b16 a[144:145], v253 offset:16384
    ds_read_b64_tr_b16 a[146:147], v253 offset:17408
    ds_read_b128 v[196:199], v250 offset:16
    v_mfma_f32_16x16x32_bf16 v[44:47], a[156:159], a[44:47], v[44:47]
    buffer_load_dwordx4 v238, s[32:35], s15 offen offset:2048 lds
    v_mfma_f32_16x16x32_bf16 v[44:47], a[152:155], a[36:39], v[44:47]
    ds_read_b64_tr_b16 a[148:149], v253 offset:20480
    ds_read_b64_tr_b16 a[150:151], v253 offset:21504
    v_cvt_pk_bf16_f32 v86, v92, v93
    v_cvt_pk_bf16_f32 v87, v94, v95
    v_mfma_f32_16x16x32_bf16 v[28:31], a[160:163], a[32:35], v[28:31]
    buffer_load_dwordx4 v238, s[32:35], s16 offen offset:3072 lds
    v_mfma_f32_16x16x32_bf16 v[28:31], a[164:167], a[40:43], v[28:31]
    ds_read_b64_tr_b16 a[152:153], v253 offset:24576
    ds_read_b64_tr_b16 a[154:155], v253 offset:25600
    s_waitcnt lgkmcnt(14)
    v_mfma_f32_4x4x4_16b_bf16 v[200:203], v[176:177], v[64:65], 0
    s_waitcnt lgkmcnt(11)
    v_mfma_f32_4x4x4_16b_bf16 v[204:207], v[184:185], v[64:65], 0
    s_waitcnt lgkmcnt(7)
    v_mfma_f32_4x4x4_16b_bf16 v[208:211], v[192:193], v[64:65], 0
    v_mfma_f32_4x4x4_16b_bf16 v[200:203], v[178:179], v[66:67], v[200:203]
    v_mfma_f32_4x4x4_16b_bf16 v[204:207], v[186:187], v[66:67], v[204:207]
    v_mfma_f32_4x4x4_16b_bf16 v[208:211], v[194:195], v[66:67], v[208:211]
    v_mfma_f32_16x16x32_bf16 v[60:63], a[164:167], a[44:47], v[60:63]
    ds_read_b64_tr_b16 a[156:157], v253 offset:28672
    ds_read_b64_tr_b16 a[158:159], v253 offset:29696
    s_add_u32 s42, s41, 12288
    v_mfma_f32_16x16x32_bf16 v[60:63], a[160:163], a[36:39], v[60:63]
    buffer_store_dwordx4 v[84:87], v251, s[48:51], s5 offen offset:1280 sc1
    v_mfma_f32_4x4x4_16b_bf16 v[200:203], v[180:181], v[68:69], v[200:203]
    v_mfma_f32_4x4x4_16b_bf16 v[204:207], v[188:189], v[68:69], v[204:207]
    s_waitcnt lgkmcnt(6)
    v_mfma_f32_4x4x4_16b_bf16 v[208:211], v[196:197], v[68:69], v[208:211]
    v_mfma_f32_4x4x4_16b_bf16 v[200:203], v[182:183], v[70:71], v[200:203]
    v_mfma_f32_4x4x4_16b_bf16 v[204:207], v[190:191], v[70:71], v[204:207]
    v_mfma_f32_4x4x4_16b_bf16 v[208:211], v[198:199], v[70:71], v[208:211]
    v_mfma_f32_16x16x32_bf16 v[0:3], a[128:131], a[48:51], v[0:3]
    ds_read_b64_tr_b16 a[160:161], v230 offset:16384
    ds_read_b64_tr_b16 v[176:177], v249 offset:2304
    ds_read_b64_tr_b16 v[178:179], v249 offset:2320
    ds_read_b64_tr_b16 v[180:181], v249 offset:2312
    v_mfma_f32_16x16x32_bf16 v[0:3], a[132:135], a[56:59], v[0:3]
    ds_read_b64_tr_b16 a[162:163], v230 offset:17408
    ds_read_b64_tr_b16 v[182:183], v249 offset:2328
    v_cndmask_b32 v209, v209, v214, s[68:69]
    v_mfma_f32_16x16x32_bf16 v[32:35], a[132:135], a[60:63], v[32:35]
    buffer_load_dwordx4 v[160:163], v243, s[48:51], s42 offen sc1
    v_mfma_f32_16x16x32_bf16 v[32:35], a[128:131], a[52:55], v[32:35]
    ds_read_b64_tr_b16 a[164:165], v230 offset:20480
    ds_read_b64_tr_b16 a[166:167], v230 offset:21504
    v_cndmask_b32 v210, v210, v214, s[68:69]
    v_cndmask_b32 v211, v211, v214, s[68:69]
    v_mfma_f32_16x16x32_bf16 v[16:19], a[136:139], a[48:51], v[16:19]
    buffer_load_dwordx4 v[164:167], v240, s[48:51], s42 offen offset:1024 sc1
    v_mfma_f32_16x16x32_bf16 v[16:19], a[140:143], a[56:59], v[16:19]
    ds_read_b64_tr_b16 a[128:129], v230 offset:24576
    ds_read_b64_tr_b16 a[130:131], v230 offset:25600
    v_cndmask_b32 v204, v204, v214, s[66:67]
    v_mfma_f32_16x16x32_bf16 v[48:51], a[140:143], a[60:63], v[48:51]
    ds_read_b64_tr_b16 a[132:133], v230 offset:28672
    v_cndmask_b32 v205, v205, v214, s[66:67]
    v_cndmask_b32 v206, v206, v214, s[66:67]
    v_cndmask_b32 v207, v207, v214, s[66:67]
    v_mfma_f32_16x16x32_bf16 v[48:51], a[136:139], a[52:55], v[48:51]
    ds_read_b64_tr_b16 a[134:135], v230 offset:29696
    v_cndmask_b32 v201, v209, v201, s[72:73]
    v_cndmask_b32 v202, v210, v202, s[74:75]
    v_cndmask_b32 v203, v211, v203, s[76:77]
    s_waitcnt lgkmcnt(12)
    v_mfma_f32_16x16x32_bf16 v[4:7], a[144:147], a[48:51], v[4:7]
    buffer_load_dwordx4 v[168:171], v243, s[48:51], s42 offen offset:2048 sc1
    v_mfma_f32_16x16x32_bf16 v[4:7], a[148:151], a[56:59], v[4:7]
    ds_read_b64_tr_b16 a[136:137], v231 offset:16384
    ds_read_b64_tr_b16 a[138:139], v231 offset:17408
    v_max3_f32 v212, v200, v201, v202
    v_mfma_f32_16x16x32_bf16 v[36:39], a[148:151], a[60:63], v[36:39]
    ds_read_b64_tr_b16 a[140:141], v231 offset:20480
    v_max3_f32 v213, v203, v204, v205
    v_max3_f32 v212, v212, v206, v207
    v_max_f32 v212, v212, v213
    v_mfma_f32_16x16x32_bf16 v[36:39], a[144:147], a[52:55], v[36:39]
    ds_read_b64_tr_b16 a[142:143], v231 offset:21504
    v_mul_f32 v212, 0xbeb8aa3b, v212
    ds_read_b64_tr_b16 v[184:185], v249 offset:1216
    v_mfma_f32_16x16x32_bf16 v[20:23], a[152:155], a[48:51], v[20:23]
    buffer_load_dwordx4 v[172:175], v240, s[48:51], s42 offen offset:3072 sc1
    v_mfma_f32_16x16x32_bf16 v[20:23], a[156:159], a[56:59], v[20:23]
    ds_read_b64_tr_b16 a[144:145], v231 offset:24576
    ds_read_b64_tr_b16 a[146:147], v231 offset:25600
    ds_read_b64_tr_b16 v[186:187], v249 offset:1232
    ds_read_b64_tr_b16 v[188:189], v249 offset:1224
    v_mfma_f32_16x16x32_bf16 v[52:55], a[156:159], a[60:63], v[52:55]
    ds_read_b64_tr_b16 a[148:149], v231 offset:28672
    ds_read_b64_tr_b16 v[190:191], v249 offset:1240
    v_mfma_f32_16x16x32_bf16 v[52:55], a[152:155], a[52:55], v[52:55]
    ds_read_b64_tr_b16 a[150:151], v231 offset:29696
    v_fma_f32 v200, v200, s7, v212
    s_waitcnt vmcnt(22)
    s_barrier
    s_waitcnt lgkmcnt(12)
    v_mfma_f32_16x16x32_bf16 v[8:11], a[160:163], a[48:51], v[8:11]
    ds_read_b64_tr_b16 a[152:153], v254 offset:32768
    s_add_u32 s42, s40, 32768
    v_fma_f32 v201, v201, s7, v212
    v_fma_f32 v202, v202, s7, v212
    v_mfma_f32_16x16x32_bf16 v[8:11], a[164:167], a[56:59], v[8:11]
    ds_read_b64_tr_b16 a[154:155], v254 offset:33792
    v_fma_f32 v203, v203, s7, v212
    v_fma_f32 v204, v204, s7, v212
    v_mfma_f32_16x16x32_bf16 v[40:43], a[164:167], a[60:63], v[40:43]
    buffer_load_dwordx4 a[0:3], v243, s[48:51], s42 offen sc1
    v_mfma_f32_16x16x32_bf16 v[40:43], a[160:163], a[52:55], v[40:43]
    ds_read_b64_tr_b16 a[156:157], v254 offset:36864
    ds_read_b64_tr_b16 a[158:159], v254 offset:37888
    v_fma_f32 v205, v205, s7, v212
    v_mfma_f32_16x16x32_bf16 v[24:27], a[128:131], a[48:51], v[24:27]
    v_fma_f32 v206, v206, s7, v212
    v_fma_f32 v207, v207, s7, v212
    v_exp_f32 v200, v200
    v_mfma_f32_16x16x32_bf16 v[24:27], a[132:135], a[56:59], v[24:27]
    ds_read_b64_tr_b16 a[160:161], v254 offset:40960
    ds_read_b64_tr_b16 a[162:163], v254 offset:41984
    v_exp_f32 v201, v201
    v_mfma_f32_16x16x32_bf16 v[56:59], a[132:135], a[60:63], v[56:59]
    buffer_load_dwordx4 a[4:7], v240, s[48:51], s42 offen offset:1024 sc1
    v_mfma_f32_16x16x32_bf16 v[56:59], a[128:131], a[52:55], v[56:59]
    ds_read_b64_tr_b16 a[164:165], v254 offset:45056
    ds_read_b64_tr_b16 a[166:167], v254 offset:46080
    v_exp_f32 v202, v202
    s_waitcnt lgkmcnt(8)
    v_mfma_f32_16x16x32_bf16 v[12:15], a[136:139], a[48:51], v[12:15]
    buffer_load_dwordx4 a[8:11], v243, s[48:51], s42 offen offset:2048 sc1
    v_mfma_f32_16x16x32_bf16 v[12:15], a[140:143], a[56:59], v[12:15]
    ds_read_b64_tr_b16 a[128:129], v253 offset:32768
    ds_read_b64_tr_b16 a[130:131], v253 offset:33792
    v_mfma_f32_16x16x32_bf16 v[44:47], a[140:143], a[60:63], v[44:47]
    v_exp_f32 v203, v203
    v_exp_f32 v204, v204
    v_mfma_f32_16x16x32_bf16 v[44:47], a[136:139], a[52:55], v[44:47]
    ds_read_b64_tr_b16 a[132:133], v253 offset:36864
    ds_read_b64_tr_b16 a[134:135], v253 offset:37888
    v_exp_f32 v205, v205
    v_mfma_f32_16x16x32_bf16 v[28:31], a[144:147], a[48:51], v[28:31]
    buffer_load_dwordx4 a[12:15], v240, s[48:51], s42 offen offset:3072 sc1
    v_mfma_f32_16x16x32_bf16 v[28:31], a[148:151], a[56:59], v[28:31]
    ds_read_b64_tr_b16 a[136:137], v253 offset:40960
    ds_read_b64_tr_b16 a[138:139], v253 offset:41984
    v_exp_f32 v206, v206
    v_mfma_f32_16x16x32_bf16 v[60:63], a[148:151], a[60:63], v[60:63]
    ds_read_b64_tr_b16 a[140:141], v253 offset:45056
    s_add_u32 s42, s40, 36864
    v_exp_f32 v207, v207
    v_mfma_f32_16x16x32_bf16 v[60:63], a[144:147], a[52:55], v[60:63]
    ds_read_b64_tr_b16 a[142:143], v253 offset:46080
    v_add_f32 v208, v200, v201
    v_add_f32 v209, v202, v203
    s_waitcnt lgkmcnt(8)
    v_mfma_f32_16x16x32_bf16 v[0:3], a[152:155], a[64:67], v[0:3]
    buffer_load_dwordx4 a[16:19], v243, s[48:51], s42 offen sc1
    v_mfma_f32_16x16x32_bf16 v[0:3], a[156:159], a[72:75], v[0:3]
    ds_read_b64_tr_b16 a[144:145], v230 offset:32768
    ds_read_b64_tr_b16 a[146:147], v230 offset:33792
    v_add_f32 v210, v204, v205
    v_mfma_f32_16x16x32_bf16 v[32:35], a[156:159], a[76:79], v[32:35]
    ds_read_b64_tr_b16 a[148:149], v230 offset:36864
    v_add_f32 v211, v206, v207
    v_add_f32 v208, v208, v209
    v_add_f32 v210, v210, v211
    v_mfma_f32_16x16x32_bf16 v[32:35], a[152:155], a[68:71], v[32:35]
    ds_read_b64_tr_b16 a[150:151], v230 offset:37888
    v_add_f32 v208, v208, v210
    v_rcp_f32 v213, v208
    v_mfma_f32_16x16x32_bf16 v[16:19], a[160:163], a[64:67], v[16:19]
    buffer_load_dwordx4 a[20:23], v240, s[48:51], s42 offen offset:1024 sc1
    v_mfma_f32_16x16x32_bf16 v[16:19], a[164:167], a[72:75], v[16:19]
    ds_read_b64_tr_b16 a[152:153], v230 offset:40960
    ds_read_b64_tr_b16 a[154:155], v230 offset:41984
    ds_read_b64_tr_b16 v[192:193], v249 offset:128
    v_mfma_f32_16x16x32_bf16 v[48:51], a[164:167], a[76:79], v[48:51]
    ds_read_b64_tr_b16 a[156:157], v230 offset:45056
    ds_read_b64_tr_b16 v[194:195], v249 offset:144
    ds_read_b64_tr_b16 v[196:197], v249 offset:136
    ds_read_b64_tr_b16 v[198:199], v249 offset:152
    v_mfma_f32_16x16x32_bf16 v[48:51], a[160:163], a[68:71], v[48:51]
    ds_read_b64_tr_b16 a[158:159], v230 offset:46080
    v_mul_f32 v200, v200, v213
    v_mul_f32 v201, v201, v213
    s_waitcnt lgkmcnt(12)
    v_mfma_f32_16x16x32_bf16 v[4:7], a[128:131], a[64:67], v[4:7]
    buffer_load_dwordx4 a[24:27], v243, s[48:51], s42 offen offset:2048 sc1
    v_mfma_f32_16x16x32_bf16 v[4:7], a[132:135], a[72:75], v[4:7]
    ds_read_b64_tr_b16 a[160:161], v231 offset:32768
    ds_read_b64_tr_b16 a[162:163], v231 offset:33792
    v_mul_f32 v202, v202, v213
    v_mul_f32 v203, v203, v213
    v_mfma_f32_16x16x32_bf16 v[36:39], a[132:135], a[76:79], v[36:39]
    ds_read_b64_tr_b16 a[164:165], v231 offset:36864
    v_mul_f32 v204, v204, v213
    v_mul_f32 v205, v205, v213
    v_mul_f32 v206, v206, v213
    v_mfma_f32_16x16x32_bf16 v[36:39], a[128:131], a[68:71], v[36:39]
    ds_read_b64_tr_b16 a[166:167], v231 offset:37888
    v_mul_f32 v207, v207, v213
    v_cvt_pk_bf16_f32 v208, v200, v201
    v_mfma_f32_16x16x32_bf16 v[20:23], a[136:139], a[64:67], v[20:23]
    ds_read_b64_tr_b16 a[128:129], v231 offset:40960
    buffer_load_dwordx4 a[28:31], v240, s[48:51], s42 offen offset:3072 sc1
    v_cvt_pk_bf16_f32 v209, v202, v203
    v_mfma_f32_16x16x32_bf16 v[20:23], a[140:143], a[72:75], v[20:23]
    ds_read_b64_tr_b16 a[130:131], v231 offset:41984
    v_cvt_pk_bf16_f32 v226, v204, v205
    buffer_load_dword v242, v244, s[48:51], 0 offen offset:128 sc1
    v_mfma_f32_16x16x32_bf16 v[52:55], a[140:143], a[76:79], v[52:55]
    ds_read_b64_tr_b16 a[132:133], v231 offset:45056
    v_cvt_pk_bf16_f32 v227, v206, v207
    v_and_b32 v224, v208, v234
    v_and_b32 v225, v209, v233
    v_mfma_f32_16x16x32_bf16 v[52:55], a[136:139], a[68:71], v[52:55]
    ds_read_b64_tr_b16 a[134:135], v231 offset:46080
    v_bfi_b32 v228, v234, 0, v208
    v_bfi_b32 v229, v233, 0, v209
    s_waitcnt lgkmcnt(8)
    v_mfma_f32_16x16x32_bf16 v[8:11], a[144:147], a[64:67], v[8:11]
    ds_read_b64_tr_b16 a[136:137], v254 offset:49152
    s_add_u32 s42, s40, 40960
    v_mfma_f32_16x16x32_bf16 v[8:11], a[148:151], a[72:75], v[8:11]
    ds_read_b64_tr_b16 a[138:139], v254 offset:50176
    v_mfma_f32_4x4x4_16b_bf16 v[80:83], v[176:177], v[224:225], 0
    v_mfma_f32_4x4x4_16b_bf16 v[84:87], v[178:179], v[224:225], 0
    v_mfma_f32_4x4x4_16b_bf16 v[88:91], v[180:181], v[224:225], 0
    v_mfma_f32_4x4x4_16b_bf16 v[92:95], v[182:183], v[224:225], 0
    v_mfma_f32_4x4x4_16b_bf16 v[80:83], v[184:185], v[226:227], v[80:83]
    v_mfma_f32_4x4x4_16b_bf16 v[84:87], v[186:187], v[226:227], v[84:87]
    v_mfma_f32_4x4x4_16b_bf16 v[88:91], v[188:189], v[226:227], v[88:91]
    v_mfma_f32_4x4x4_16b_bf16 v[92:95], v[190:191], v[226:227], v[92:95]
    v_mfma_f32_16x16x32_bf16 v[40:43], a[148:151], a[76:79], v[40:43]
    buffer_load_dwordx4 a[32:35], v243, s[48:51], s42 offen sc1
    v_mfma_f32_16x16x32_bf16 v[40:43], a[144:147], a[68:71], v[40:43]
    ds_read_b64_tr_b16 a[140:141], v254 offset:53248
    ds_read_b64_tr_b16 a[142:143], v254 offset:54272
    v_mfma_f32_4x4x4_16b_bf16 v[80:83], v[192:193], v[228:229], v[80:83]
    v_mfma_f32_4x4x4_16b_bf16 v[84:87], v[194:195], v[228:229], v[84:87]
    v_mfma_f32_4x4x4_16b_bf16 v[88:91], v[196:197], v[228:229], v[88:91]
    v_mfma_f32_4x4x4_16b_bf16 v[92:95], v[198:199], v[228:229], v[92:95]
    v_mfma_f32_16x16x32_bf16 v[24:27], a[152:155], a[64:67], v[24:27]
    ds_read_b64_tr_b16 a[144:145], v254 offset:57344
    v_mfma_f32_16x16x32_bf16 v[24:27], a[156:159], a[72:75], v[24:27]
    ds_read_b64_tr_b16 a[146:147], v254 offset:58368
    v_mfma_f32_16x16x32_bf16 v[56:59], a[156:159], a[76:79], v[56:59]
    buffer_load_dwordx4 a[36:39], v240, s[48:51], s42 offen offset:1024 sc1
    v_mfma_f32_16x16x32_bf16 v[56:59], a[152:155], a[68:71], v[56:59]
    ds_read_b64_tr_b16 a[148:149], v254 offset:61440
    ds_read_b64_tr_b16 a[150:151], v254 offset:62464
    v_cvt_pk_bf16_f32 v80, v80, v81
    v_cvt_pk_bf16_f32 v81, v82, v83
    s_waitcnt lgkmcnt(8)
    v_mfma_f32_16x16x32_bf16 v[12:15], a[160:163], a[64:67], v[12:15]
    buffer_load_dwordx4 a[40:43], v243, s[48:51], s42 offen offset:2048 sc1
    v_mfma_f32_16x16x32_bf16 v[12:15], a[164:167], a[72:75], v[12:15]
    ds_read_b64_tr_b16 a[152:153], v253 offset:49152
    ds_read_b64_tr_b16 a[154:155], v253 offset:50176
    v_cvt_pk_bf16_f32 v82, v84, v85
    v_cvt_pk_bf16_f32 v83, v86, v87
    v_mfma_f32_16x16x32_bf16 v[44:47], a[164:167], a[76:79], v[44:47]
    buffer_store_dwordx4 v[80:83], v251, s[48:51], s5 offen sc1
    v_mfma_f32_16x16x32_bf16 v[44:47], a[160:163], a[68:71], v[44:47]
    ds_read_b64_tr_b16 a[156:157], v253 offset:53248
    ds_read_b64_tr_b16 a[158:159], v253 offset:54272
    v_mfma_f32_16x16x32_bf16 v[28:31], a[128:131], a[64:67], v[28:31]
    buffer_load_dwordx4 a[44:47], v240, s[48:51], s42 offen offset:3072 sc1
    v_mfma_f32_16x16x32_bf16 v[28:31], a[132:135], a[72:75], v[28:31]
    ds_read_b64_tr_b16 a[160:161], v253 offset:57344
    ds_read_b64_tr_b16 a[162:163], v253 offset:58368
    v_cvt_pk_bf16_f32 v84, v88, v89
    v_cvt_pk_bf16_f32 v85, v90, v91
    v_mfma_f32_16x16x32_bf16 v[60:63], a[132:135], a[76:79], v[60:63]
    ds_read_b64_tr_b16 a[164:165], v253 offset:61440
    s_add_u32 m0, s62, 0
    s_add_u32 s42, s40, 45056
    v_mfma_f32_16x16x32_bf16 v[60:63], a[128:131], a[68:71], v[60:63]
    ds_read_b64_tr_b16 a[166:167], v253 offset:62464
    v_cvt_pk_bf16_f32 v86, v92, v93
    v_cvt_pk_bf16_f32 v87, v94, v95
    s_waitcnt lgkmcnt(8)
    v_mfma_f32_16x16x32_bf16 v[0:3], a[136:139], a[80:83], v[0:3]
    buffer_store_dwordx4 v[84:87], v251, s[48:51], s5 offen offset:1024 sc1
    v_mfma_f32_16x16x32_bf16 v[0:3], a[140:143], a[88:91], v[0:3]
    ds_read_b64_tr_b16 a[128:129], v230 offset:49152
    ds_read_b64_tr_b16 a[130:131], v230 offset:50176
    v_mfma_f32_16x16x32_bf16 v[32:35], a[140:143], a[92:95], v[32:35]
    buffer_load_dwordx4 v243, s[48:51], s42 offen sc1 lds
    v_mfma_f32_16x16x32_bf16 v[32:35], a[136:139], a[84:87], v[32:35]
    ds_read_b64_tr_b16 a[132:133], v230 offset:53248
    ds_read_b64_tr_b16 a[134:135], v230 offset:54272
    v_mfma_f32_16x16x32_bf16 v[16:19], a[144:147], a[80:83], v[16:19]
    buffer_load_dwordx4 v240, s[48:51], s42 offen offset:1024 sc1 lds
    v_mfma_f32_16x16x32_bf16 v[16:19], a[148:151], a[88:91], v[16:19]
    ds_read_b64_tr_b16 a[136:137], v230 offset:57344
    ds_read_b64_tr_b16 a[138:139], v230 offset:58368
    v_mfma_f32_16x16x32_bf16 v[48:51], a[148:151], a[92:95], v[48:51]
    ds_read_b64_tr_b16 a[140:141], v230 offset:61440
    v_mfma_f32_16x16x32_bf16 v[48:51], a[144:147], a[84:87], v[48:51]
    ds_read_b64_tr_b16 a[142:143], v230 offset:62464
    s_waitcnt lgkmcnt(8)
    v_mfma_f32_16x16x32_bf16 v[4:7], a[152:155], a[80:83], v[4:7]
    buffer_load_dwordx4 v243, s[48:51], s42 offen offset:2048 sc1 lds
    v_mfma_f32_16x16x32_bf16 v[4:7], a[156:159], a[88:91], v[4:7]
    ds_read_b64_tr_b16 a[144:145], v231 offset:49152
    ds_read_b64_tr_b16 a[146:147], v231 offset:50176
    v_mfma_f32_16x16x32_bf16 v[36:39], a[156:159], a[92:95], v[36:39]
    ds_read_b64_tr_b16 a[148:149], v231 offset:53248
    v_mfma_f32_16x16x32_bf16 v[36:39], a[152:155], a[84:87], v[36:39]
    ds_read_b64_tr_b16 a[150:151], v231 offset:54272
    v_mfma_f32_16x16x32_bf16 v[20:23], a[160:163], a[80:83], v[20:23]
    ds_read_b64_tr_b16 a[152:153], v231 offset:57344
    buffer_load_dwordx4 v240, s[48:51], s42 offen offset:3072 sc1 lds
    v_mfma_f32_16x16x32_bf16 v[20:23], a[164:167], a[88:91], v[20:23]
    ds_read_b64_tr_b16 a[154:155], v231 offset:58368
    s_waitcnt vmcnt(10)
    v_cmp_gt_u32 vcc, v252, v242
    s_cbranch_vccnz L_B_p5_slow
L_B_p5_ok:
    v_mfma_f32_16x16x32_bf16 v[52:55], a[164:167], a[92:95], v[52:55]
    ds_read_b64_tr_b16 a[156:157], v231 offset:61440
    v_mfma_f32_16x16x32_bf16 v[52:55], a[160:163], a[84:87], v[52:55]
    ds_read_b64_tr_b16 a[158:159], v231 offset:62464
    s_barrier
    s_waitcnt lgkmcnt(8)
    v_mfma_f32_16x16x32_bf16 v[8:11], a[128:131], a[80:83], v[8:11]
    v_add_u32 v254, 65536, v254
    ds_read_b64_tr_b16 a[160:161], v254
    s_add_u32 s3, s9, 0
    v_mfma_f32_16x16x32_bf16 v[8:11], a[132:135], a[88:91], v[8:11]
    ds_read_b64_tr_b16 a[162:163], v254 offset:1024
    v_mfma_f32_16x16x32_bf16 v[40:43], a[132:135], a[92:95], v[40:43]
    buffer_load_dwordx4 a[48:51], v236, s[48:51], s3 offen sc1
    v_mfma_f32_16x16x32_bf16 v[40:43], a[128:131], a[84:87], v[40:43]
    ds_read_b64_tr_b16 a[164:165], v254 offset:4096
    ds_read_b64_tr_b16 a[166:167], v254 offset:5120
    v_mfma_f32_16x16x32_bf16 v[24:27], a[136:139], a[80:83], v[24:27]
    ds_read_b64_tr_b16 a[128:129], v254 offset:8192
    v_mfma_f32_16x16x32_bf16 v[24:27], a[140:143], a[88:91], v[24:27]
    ds_read_b64_tr_b16 a[130:131], v254 offset:9216
    v_mfma_f32_16x16x32_bf16 v[56:59], a[140:143], a[92:95], v[56:59]
    buffer_load_dwordx4 a[52:55], v245, s[48:51], s3 offen sc1
    v_mfma_f32_16x16x32_bf16 v[56:59], a[136:139], a[84:87], v[56:59]
    ds_read_b64_tr_b16 a[132:133], v254 offset:12288
    ds_read_b64_tr_b16 a[134:135], v254 offset:13312
    s_waitcnt lgkmcnt(8)
    v_mfma_f32_16x16x32_bf16 v[12:15], a[144:147], a[80:83], v[12:15]
    v_add_u32 v253, 65536, v253
    ds_read_b64_tr_b16 a[136:137], v253
    buffer_load_dwordx4 a[56:59], v236, s[48:51], s3 offen offset:1024 sc1
    v_mfma_f32_16x16x32_bf16 v[12:15], a[148:151], a[88:91], v[12:15]
    ds_read_b64_tr_b16 a[138:139], v253 offset:1024
    v_mfma_f32_16x16x32_bf16 v[44:47], a[148:151], a[92:95], v[44:47]
    ds_read_b64_tr_b16 a[140:141], v253 offset:4096
    v_mfma_f32_16x16x32_bf16 v[44:47], a[144:147], a[84:87], v[44:47]
    ds_read_b64_tr_b16 a[142:143], v253 offset:5120
    v_mfma_f32_16x16x32_bf16 v[28:31], a[152:155], a[80:83], v[28:31]
    buffer_load_dwordx4 a[60:63], v245, s[48:51], s3 offen offset:1024 sc1
    v_mfma_f32_16x16x32_bf16 v[28:31], a[156:159], a[88:91], v[28:31]
    ds_read_b64_tr_b16 a[144:145], v253 offset:8192
    ds_read_b64_tr_b16 a[146:147], v253 offset:9216
    v_mfma_f32_16x16x32_bf16 v[60:63], a[156:159], a[92:95], v[60:63]
    ds_read_b64_tr_b16 a[148:149], v253 offset:12288
    s_add_u32 s3, s9, 2048
    v_mfma_f32_16x16x32_bf16 v[60:63], a[152:155], a[84:87], v[60:63]
    ds_read_b64_tr_b16 a[150:151], v253 offset:13312
    s_waitcnt lgkmcnt(8)
    v_mfma_f32_16x16x32_bf16 v[0:3], a[160:163], a[96:99], v[0:3]
    v_add_u32 v230, 65536, v230
    ds_read_b64_tr_b16 a[152:153], v230
    buffer_load_dwordx4 v[176:179], v236, s[48:51], s3 offen sc1
    v_mfma_f32_16x16x32_bf16 v[0:3], a[164:167], a[104:107], v[0:3]
    ds_read_b64_tr_b16 a[154:155], v230 offset:1024
    v_mfma_f32_16x16x32_bf16 v[32:35], a[164:167], a[108:111], v[32:35]
    ds_read_b64_tr_b16 a[156:157], v230 offset:4096
    v_mfma_f32_16x16x32_bf16 v[32:35], a[160:163], a[100:103], v[32:35]
    ds_read_b64_tr_b16 a[158:159], v230 offset:5120
    v_mfma_f32_16x16x32_bf16 v[16:19], a[128:131], a[96:99], v[16:19]
    ds_read_b64_tr_b16 a[160:161], v230 offset:8192
    ds_read_b64_tr_b16 a[162:163], v230 offset:9216
    buffer_load_dwordx4 v[180:183], v245, s[48:51], s3 offen sc1
    s_waitcnt vmcnt(10)
    v_mfma_f32_16x16x32_bf16 v[16:19], a[132:135], a[104:107], v[16:19]
    buffer_store_dword v241, v248, s[48:51], 0 offen offset:384 sc1
    v_mfma_f32_16x16x32_bf16 v[48:51], a[132:135], a[108:111], v[48:51]
    ds_read_b64_tr_b16 a[164:165], v230 offset:12288
    v_mfma_f32_16x16x32_bf16 v[48:51], a[128:131], a[100:103], v[48:51]
    ds_read_b64_tr_b16 a[166:167], v230 offset:13312
    s_waitcnt lgkmcnt(8)
    v_mfma_f32_16x16x32_bf16 v[4:7], a[136:139], a[96:99], v[4:7]
    v_add_u32 v231, 65536, v231
    ds_read_b64_tr_b16 a[128:129], v231
    buffer_load_dwordx4 v[184:187], v236, s[48:51], s3 offen offset:1024 sc1
    v_mfma_f32_16x16x32_bf16 v[4:7], a[140:143], a[104:107], v[4:7]
    ds_read_b64_tr_b16 a[130:131], v231 offset:1024
    v_mfma_f32_16x16x32_bf16 v[36:39], a[140:143], a[108:111], v[36:39]
    ds_read_b64_tr_b16 a[132:133], v231 offset:4096
    v_mfma_f32_16x16x32_bf16 v[36:39], a[136:139], a[100:103], v[36:39]
    ds_read_b64_tr_b16 a[134:135], v231 offset:5120
    v_mfma_f32_16x16x32_bf16 v[20:23], a[144:147], a[96:99], v[20:23]
    buffer_load_dwordx4 v[188:191], v245, s[48:51], s3 offen offset:1024 sc1
    v_mfma_f32_16x16x32_bf16 v[20:23], a[148:151], a[104:107], v[20:23]
    ds_read_b64_tr_b16 a[136:137], v231 offset:8192
    ds_read_b64_tr_b16 a[138:139], v231 offset:9216
    v_mfma_f32_16x16x32_bf16 v[52:55], a[148:151], a[108:111], v[52:55]
    ds_read_b64_tr_b16 a[140:141], v231 offset:12288
    v_mfma_f32_16x16x32_bf16 v[52:55], a[144:147], a[100:103], v[52:55]
    ds_read_b64_tr_b16 a[142:143], v231 offset:13312
    s_barrier
    s_waitcnt lgkmcnt(8)
    v_mfma_f32_16x16x32_bf16 v[8:11], a[152:155], a[96:99], v[8:11]
    ds_read_b64_tr_b16 a[144:145], v254 offset:16384
    s_add_u32 s3, s9, 4096
    v_mfma_f32_16x16x32_bf16 v[8:11], a[156:159], a[104:107], v[8:11]
    ds_read_b64_tr_b16 a[146:147], v254 offset:17408
    v_mfma_f32_16x16x32_bf16 v[40:43], a[156:159], a[108:111], v[40:43]
    buffer_load_dwordx4 v[192:195], v236, s[48:51], s3 offen sc1
    v_mfma_f32_16x16x32_bf16 v[40:43], a[152:155], a[100:103], v[40:43]
    ds_read_b64_tr_b16 a[148:149], v254 offset:20480
    ds_read_b64_tr_b16 a[150:151], v254 offset:21504
    v_mfma_f32_16x16x32_bf16 v[24:27], a[160:163], a[96:99], v[24:27]
    ds_read_b64_tr_b16 a[152:153], v254 offset:24576
    v_mfma_f32_16x16x32_bf16 v[24:27], a[164:167], a[104:107], v[24:27]
    ds_read_b64_tr_b16 a[154:155], v254 offset:25600
    v_mfma_f32_16x16x32_bf16 v[56:59], a[164:167], a[108:111], v[56:59]
    buffer_load_dwordx4 v[196:199], v245, s[48:51], s3 offen sc1
    v_mfma_f32_16x16x32_bf16 v[56:59], a[160:163], a[100:103], v[56:59]
    ds_read_b64_tr_b16 a[156:157], v254 offset:28672
    ds_read_b64_tr_b16 a[158:159], v254 offset:29696
    s_waitcnt lgkmcnt(8)
    v_mfma_f32_16x16x32_bf16 v[12:15], a[128:131], a[96:99], v[12:15]
    ds_read_b64_tr_b16 a[160:161], v253 offset:16384
    v_mfma_f32_16x16x32_bf16 v[12:15], a[132:135], a[104:107], v[12:15]
    ds_read_b64_tr_b16 a[162:163], v253 offset:17408
    v_mfma_f32_16x16x32_bf16 v[44:47], a[132:135], a[108:111], v[44:47]
    buffer_load_dwordx4 v[200:203], v236, s[48:51], s3 offen offset:1024 sc1
    v_mfma_f32_16x16x32_bf16 v[44:47], a[128:131], a[100:103], v[44:47]
    ds_read_b64_tr_b16 a[164:165], v253 offset:20480
    ds_read_b64_tr_b16 a[166:167], v253 offset:21504
    v_mfma_f32_16x16x32_bf16 v[28:31], a[136:139], a[96:99], v[28:31]
    ds_read_b64_tr_b16 a[128:129], v253 offset:24576
    v_mfma_f32_16x16x32_bf16 v[28:31], a[140:143], a[104:107], v[28:31]
    ds_read_b64_tr_b16 a[130:131], v253 offset:25600
    v_mfma_f32_16x16x32_bf16 v[60:63], a[140:143], a[108:111], v[60:63]
    buffer_load_dwordx4 v[204:207], v245, s[48:51], s3 offen offset:1024 sc1
    v_mfma_f32_16x16x32_bf16 v[60:63], a[136:139], a[100:103], v[60:63]
    ds_read_b64_tr_b16 a[132:133], v253 offset:28672
    ds_read_b64_tr_b16 a[134:135], v253 offset:29696
    s_waitcnt lgkmcnt(8)
    v_mfma_f32_16x16x32_bf16 v[0:3], a[144:147], a[112:115], v[0:3]
    ds_read_b64_tr_b16 a[136:137], v230 offset:16384
    ds_read_b64_tr_b16 a[138:139], v230 offset:17408
    s_add_u32 s3, s9, 6144
    v_mfma_f32_16x16x32_bf16 v[0:3], a[148:151], a[120:123], v[0:3]
    buffer_load_dword v242, v244, s[48:51], 0 offen offset:256 sc1
    v_mfma_f32_16x16x32_bf16 v[32:35], a[148:151], a[124:127], v[32:35]
    buffer_load_dwordx4 v[208:211], v236, s[48:51], s3 offen sc1
    v_mfma_f32_16x16x32_bf16 v[32:35], a[144:147], a[116:119], v[32:35]
    ds_read_b64_tr_b16 a[140:141], v230 offset:20480
    ds_read_b64_tr_b16 a[142:143], v230 offset:21504
    v_mfma_f32_16x16x32_bf16 v[16:19], a[152:155], a[112:115], v[16:19]
    ds_read_b64_tr_b16 a[144:145], v230 offset:24576
    v_mfma_f32_16x16x32_bf16 v[16:19], a[156:159], a[120:123], v[16:19]
    ds_read_b64_tr_b16 a[146:147], v230 offset:25600
    v_mfma_f32_16x16x32_bf16 v[48:51], a[156:159], a[124:127], v[48:51]
    buffer_load_dwordx4 v[212:215], v245, s[48:51], s3 offen sc1
    v_mfma_f32_16x16x32_bf16 v[48:51], a[152:155], a[116:119], v[48:51]
    ds_read_b64_tr_b16 a[148:149], v230 offset:28672
    ds_read_b64_tr_b16 a[150:151], v230 offset:29696
    s_waitcnt lgkmcnt(8)
    v_mfma_f32_16x16x32_bf16 v[4:7], a[160:163], a[112:115], v[4:7]
    ds_read_b64_tr_b16 a[152:153], v231 offset:16384
    v_mfma_f32_16x16x32_bf16 v[4:7], a[164:167], a[120:123], v[4:7]
    ds_read_b64_tr_b16 a[154:155], v231 offset:17408
    v_mfma_f32_16x16x32_bf16 v[36:39], a[164:167], a[124:127], v[36:39]
    buffer_load_dwordx4 v[216:219], v236, s[48:51], s3 offen offset:1024 sc1
    v_mfma_f32_16x16x32_bf16 v[36:39], a[160:163], a[116:119], v[36:39]
    ds_read_b64_tr_b16 a[156:157], v231 offset:20480
    ds_read_b64_tr_b16 a[158:159], v231 offset:21504
    v_mfma_f32_16x16x32_bf16 v[20:23], a[128:131], a[112:115], v[20:23]
    ds_read_b64_tr_b16 a[160:161], v231 offset:24576
    v_mfma_f32_16x16x32_bf16 v[20:23], a[132:135], a[120:123], v[20:23]
    ds_read_b64_tr_b16 a[162:163], v231 offset:25600
    v_mfma_f32_16x16x32_bf16 v[52:55], a[132:135], a[124:127], v[52:55]
    buffer_load_dwordx4 v[220:223], v245, s[48:51], s3 offen offset:1024 sc1
    v_mfma_f32_16x16x32_bf16 v[52:55], a[128:131], a[116:119], v[52:55]
    ds_read_b64_tr_b16 a[164:165], v231 offset:28672
    ds_read_b64_tr_b16 a[166:167], v231 offset:29696
    s_waitcnt lgkmcnt(8)
    v_mfma_f32_16x16x32_bf16 v[8:11], a[136:139], a[112:115], v[8:11]
    s_add_u32 s42, s40, 16384
    v_mfma_f32_16x16x32_bf16 v[8:11], a[140:143], a[120:123], v[8:11]
    v_mfma_f32_16x16x32_bf16 v[40:43], a[140:143], a[124:127], v[40:43]
    buffer_load_dwordx4 a[64:67], v243, s[48:51], s42 offen sc1
    v_mfma_f32_16x16x32_bf16 v[40:43], a[136:139], a[116:119], v[40:43]
    v_mfma_f32_16x16x32_bf16 v[24:27], a[144:147], a[112:115], v[24:27]
    v_mov_b32 v224, 0xbfb8aa3b
    v_mfma_f32_16x16x32_bf16 v[24:27], a[148:151], a[120:123], v[24:27]
    v_mov_b32 v225, 0xbfb8aa3b
    v_mfma_f32_16x16x32_bf16 v[56:59], a[148:151], a[124:127], v[56:59]
    buffer_load_dwordx4 a[68:71], v240, s[48:51], s42 offen offset:1024 sc1
    v_mfma_f32_16x16x32_bf16 v[56:59], a[144:147], a[116:119], v[56:59]
    s_waitcnt lgkmcnt(0)
    v_mfma_f32_16x16x32_bf16 v[12:15], a[152:155], a[112:115], v[12:15]
    v_mov_b32 v226, 1.0
    v_mfma_f32_16x16x32_bf16 v[12:15], a[156:159], a[120:123], v[12:15]
    v_mfma_f32_16x16x32_bf16 v[44:47], a[156:159], a[124:127], v[44:47]
    buffer_load_dwordx4 a[72:75], v243, s[48:51], s42 offen offset:2048 sc1
    v_mfma_f32_16x16x32_bf16 v[44:47], a[152:155], a[116:119], v[44:47]
    v_mfma_f32_16x16x32_bf16 v[28:31], a[160:163], a[112:115], v[28:31]
    v_mov_b32 v227, 1.0
    v_mfma_f32_16x16x32_bf16 v[28:31], a[164:167], a[120:123], v[28:31]
    v_mfma_f32_16x16x32_bf16 v[60:63], a[164:167], a[124:127], v[60:63]
    buffer_load_dwordx4 a[76:79], v240, s[48:51], s42 offen offset:3072 sc1
    v_mfma_f32_16x16x32_bf16 v[60:63], a[160:163], a[116:119], v[60:63]
    s_waitcnt vmcnt(8)
    v_cmp_gt_u32 vcc, v252, v242
    s_cbranch_vccnz L_B_p6_slow
L_B_p6_ok:
    s_add_u32 s3, s9, 24576
    buffer_load_dwordx4 a[128:131], v236, s[48:51], s3 offen sc1
    v_pk_mul_f32 v[228:229], v[0:1], v[224:225]
    v_pk_mul_f32 v[230:231], v[2:3], v[224:225]
    v_exp_f32 v228, v228
    v_exp_f32 v229, v229
    v_exp_f32 v230, v230
    v_exp_f32 v231, v231
    v_pk_mul_f32 v[16:17], v[0:1], v[16:17]
    v_pk_mul_f32 v[18:19], v[2:3], v[18:19]
    v_pk_add_f32 v[228:229], v[228:229], v[226:227]
    v_pk_add_f32 v[230:231], v[230:231], v[226:227]
    v_rcp_f32 v228, v228
    v_rcp_f32 v229, v229
    v_rcp_f32 v230, v230
    buffer_load_dwordx4 a[132:135], v245, s[48:51], s3 offen sc1
    v_rcp_f32 v231, v231
    v_pk_mul_f32 v[16:17], v[16:17], v[228:229]
    v_pk_mul_f32 v[18:19], v[18:19], v[230:231]
    v_cvt_pk_bf16_f32 v0, v16, v17
    v_cvt_pk_bf16_f32 v1, v18, v19
    v_pk_mul_f32 v[228:229], v[4:5], v[224:225]
    v_pk_mul_f32 v[230:231], v[6:7], v[224:225]
    v_exp_f32 v228, v228
    v_exp_f32 v229, v229
    v_exp_f32 v230, v230
    v_exp_f32 v231, v231
    v_pk_mul_f32 v[20:21], v[4:5], v[20:21]
    v_pk_mul_f32 v[22:23], v[6:7], v[22:23]
    buffer_load_dwordx4 a[136:139], v236, s[48:51], s3 offen offset:1024 sc1
    v_pk_add_f32 v[228:229], v[228:229], v[226:227]
    v_pk_add_f32 v[230:231], v[230:231], v[226:227]
    v_rcp_f32 v228, v228
    v_rcp_f32 v229, v229
    v_rcp_f32 v230, v230
    v_rcp_f32 v231, v231
    v_pk_mul_f32 v[20:21], v[20:21], v[228:229]
    v_pk_mul_f32 v[22:23], v[22:23], v[230:231]
    v_cvt_pk_bf16_f32 v2, v20, v21
    v_cvt_pk_bf16_f32 v3, v22, v23
    buffer_store_dwordx4 v[0:3], v251, s[48:51], s6 offen sc1
    v_pk_mul_f32 v[228:229], v[8:9], v[224:225]
    v_pk_mul_f32 v[230:231], v[10:11], v[224:225]
    buffer_load_dwordx4 a[140:143], v245, s[48:51], s3 offen offset:1024 sc1
    v_exp_f32 v228, v228
    v_exp_f32 v229, v229
    v_exp_f32 v230, v230
    v_exp_f32 v231, v231
    v_pk_mul_f32 v[24:25], v[8:9], v[24:25]
    v_pk_mul_f32 v[26:27], v[10:11], v[26:27]
    v_pk_add_f32 v[228:229], v[228:229], v[226:227]
    v_pk_add_f32 v[230:231], v[230:231], v[226:227]
    v_rcp_f32 v228, v228
    v_rcp_f32 v229, v229
    v_rcp_f32 v230, v230
    v_rcp_f32 v231, v231
    v_pk_mul_f32 v[24:25], v[24:25], v[228:229]
    s_add_u32 s3, s9, 26624
    buffer_load_dwordx4 a[144:147], v236, s[48:51], s3 offen sc1
    v_pk_mul_f32 v[26:27], v[26:27], v[230:231]
    v_cvt_pk_bf16_f32 v4, v24, v25
    v_cvt_pk_bf16_f32 v5, v26, v27
    v_pk_mul_f32 v[228:229], v[12:13], v[224:225]
    v_pk_mul_f32 v[230:231], v[14:15], v[224:225]
    v_exp_f32 v228, v228
    v_exp_f32 v229, v229
    v_exp_f32 v230, v230
    v_exp_f32 v231, v231
    v_pk_mul_f32 v[28:29], v[12:13], v[28:29]
    v_pk_mul_f32 v[30:31], v[14:15], v[30:31]
    v_pk_add_f32 v[228:229], v[228:229], v[226:227]
    v_pk_add_f32 v[230:231], v[230:231], v[226:227]
    buffer_load_dwordx4 a[148:151], v245, s[48:51], s3 offen sc1
    v_rcp_f32 v228, v228
    v_rcp_f32 v229, v229
    v_rcp_f32 v230, v230
    v_rcp_f32 v231, v231
    v_pk_mul_f32 v[28:29], v[28:29], v[228:229]
    v_pk_mul_f32 v[30:31], v[30:31], v[230:231]
    v_cvt_pk_bf16_f32 v6, v28, v29
    v_cvt_pk_bf16_f32 v7, v30, v31
    buffer_store_dwordx4 v[4:7], v251, s[48:51], s6 offen offset:1024 sc1
    v_pk_mul_f32 v[228:229], v[32:33], v[224:225]
    v_pk_mul_f32 v[230:231], v[34:35], v[224:225]
    v_exp_f32 v228, v228
    v_exp_f32 v229, v229
    buffer_load_dwordx4 a[152:155], v236, s[48:51], s3 offen offset:1024 sc1
    v_exp_f32 v230, v230
    v_exp_f32 v231, v231
    v_pk_mul_f32 v[48:49], v[32:33], v[48:49]
    v_pk_mul_f32 v[50:51], v[34:35], v[50:51]
    v_pk_add_f32 v[228:229], v[228:229], v[226:227]
    v_pk_add_f32 v[230:231], v[230:231], v[226:227]
    v_rcp_f32 v228, v228
    v_rcp_f32 v229, v229
    v_rcp_f32 v230, v230
    v_rcp_f32 v231, v231
    v_pk_mul_f32 v[48:49], v[48:49], v[228:229]
    v_pk_mul_f32 v[50:51], v[50:51], v[230:231]
    v_cvt_pk_bf16_f32 v32, v48, v49
    buffer_load_dwordx4 a[156:159], v245, s[48:51], s3 offen offset:1024 sc1
    v_cvt_pk_bf16_f32 v33, v50, v51
    v_pk_mul_f32 v[228:229], v[36:37], v[224:225]
    v_pk_mul_f32 v[230:231], v[38:39], v[224:225]
    v_exp_f32 v228, v228
    v_exp_f32 v229, v229
    v_exp_f32 v230, v230
    v_exp_f32 v231, v231
    v_pk_mul_f32 v[52:53], v[36:37], v[52:53]
    v_pk_mul_f32 v[54:55], v[38:39], v[54:55]
    v_pk_add_f32 v[228:229], v[228:229], v[226:227]
    v_pk_add_f32 v[230:231], v[230:231], v[226:227]
    v_rcp_f32 v228, v228
    v_rcp_f32 v229, v229
    v_rcp_f32 v230, v230
    v_rcp_f32 v231, v231
    v_pk_mul_f32 v[52:53], v[52:53], v[228:229]
    v_pk_mul_f32 v[54:55], v[54:55], v[230:231]
    v_cvt_pk_bf16_f32 v34, v52, v53
    v_cvt_pk_bf16_f32 v35, v54, v55
    buffer_store_dwordx4 v[32:35], v251, s[48:51], s6 offen offset:256 sc1
    v_pk_mul_f32 v[228:229], v[40:41], v[224:225]
    v_pk_mul_f32 v[230:231], v[42:43], v[224:225]
    v_exp_f32 v228, v228
    v_exp_f32 v229, v229
    v_exp_f32 v230, v230
    v_exp_f32 v231, v231
    v_pk_mul_f32 v[56:57], v[40:41], v[56:57]
    v_pk_mul_f32 v[58:59], v[42:43], v[58:59]
    v_pk_add_f32 v[228:229], v[228:229], v[226:227]
    v_pk_add_f32 v[230:231], v[230:231], v[226:227]
    v_rcp_f32 v228, v228
    v_rcp_f32 v229, v229
    v_rcp_f32 v230, v230
    v_rcp_f32 v231, v231
    v_pk_mul_f32 v[56:57], v[56:57], v[228:229]
    v_pk_mul_f32 v[58:59], v[58:59], v[230:231]
    v_cvt_pk_bf16_f32 v36, v56, v57
    v_cvt_pk_bf16_f32 v37, v58, v59
    v_pk_mul_f32 v[228:229], v[44:45], v[224:225]
    v_pk_mul_f32 v[230:231], v[46:47], v[224:225]
    v_exp_f32 v228, v228
    v_exp_f32 v229, v229
    v_exp_f32 v230, v230
    v_exp_f32 v231, v231
    v_pk_mul_f32 v[60:61], v[44:45], v[60:61]
    v_pk_mul_f32 v[62:63], v[46:47], v[62:63]
    v_pk_add_f32 v[228:229], v[228:229], v[226:227]
    v_pk_add_f32 v[230:231], v[230:231], v[226:227]
    v_rcp_f32 v228, v228
    v_rcp_f32 v229, v229
    v_rcp_f32 v230, v230
    v_rcp_f32 v231, v231
    v_pk_mul_f32 v[60:61], v[60:61], v[228:229]
    v_pk_mul_f32 v[62:63], v[62:63], v[230:231]
    v_cvt_pk_bf16_f32 v38, v60, v61
    v_cvt_pk_bf16_f32 v39, v62, v63
    buffer_store_dwordx4 v[36:39], v251, s[48:51], s6 offen offset:1280 sc1
    v_mfma_f32_32x32x16_bf16 v[64:79], a[176:179], a[48:51], 0
    s_add_u32 s64, s62, 98304
    v_lshl_add_u32 v250, v255, 4, s64
    v_xor_b32 v249, 4096, v250
    v_xor_b32 v254, 8192, v250
    v_xor_b32 v253, 12288, v250
    s_and_b32 s64, s22, 64
    v_mfma_f32_32x32x16_bf16 a[80:95], a[180:183], a[48:51], 0
    s_mul_i32 s65, s64, 511
    s_add_u32 s65, s65, s22
    v_lshrrev_b32 v238, 3, v255
    v_and_b32 v251, 7, v255
    v_lshlrev_b32 v251, 4, v251
    v_lshl_add_u32 v238, v238, 11, v251
    v_mfma_f32_32x32x16_bf16 a[96:111], a[176:179], a[52:55], 0
    v_add_u32 v238, s65, v238
    s_lshr_b32 s65, s56, 1
    s_lshl_b32 s65, s65, 13
    s_add_u32 s65, s65, s64
    s_add_u32 s65, s65, 147456
    v_and_b32 v251, 16, v255
    v_mfma_f32_32x32x16_bf16 a[112:127], a[180:183], a[52:55], 0
    v_lshlrev_b32 v251, 1, v251
    v_and_or_b32 v251, v255, 15, v251
    v_lshlrev_b32 v251, 7, v251
    v_and_or_b32 v251, v255, 32, v251
    v_add_u32 v251, s65, v251
    v_and_b32 v246, 7, v255
    v_mfma_f32_32x32x16_bf16 v[64:79], a[184:187], a[56:59], v[64:79]
    v_lshlrev_b32 v246, 4, v246
    v_xor_b32 v234, v246, v251
    v_xor_b32 v233, 16, v234
    v_lshrrev_b32 v246, 3, v255
    v_xor_b32 v246, v246, v255
    s_add_u32 s65, s62, 147456
    v_mfma_f32_32x32x16_bf16 a[80:95], a[188:191], a[56:59], a[80:95]
    v_lshl_add_u32 v246, v246, 4, s65
    v_mfma_f32_32x32x16_bf16 a[96:111], a[184:187], a[60:63], a[96:111]
    s_add_u32 m0, s62, 147456
    s_mov_b32 s63, 15360
    buffer_load_dwordx4 v238, s[24:27], 0 offen lds
    v_mfma_f32_32x32x16_bf16 a[112:127], a[188:191], a[60:63], a[112:127]
    v_mfma_f32_32x32x16_bf16 v[64:79], a[192:195], v[176:179], v[64:79]
    buffer_load_dwordx4 v238, s[24:27], s63 offen offset:1024 lds
    v_mfma_f32_32x32x16_bf16 a[80:95], a[196:199], v[176:179], a[80:95]
    v_mfma_f32_32x32x16_bf16 a[96:111], a[192:195], v[180:183], a[96:111]
    v_mfma_f32_32x32x16_bf16 a[112:127], a[196:199], v[180:183], a[112:127]
    v_mfma_f32_32x32x16_bf16 v[64:79], a[200:203], v[184:187], v[64:79]
    buffer_load_dword v242, v244, s[48:51], 0 offen offset:384 sc1
    v_mfma_f32_32x32x16_bf16 a[80:95], a[204:207], v[184:187], a[80:95]
    v_mfma_f32_32x32x16_bf16 a[96:111], a[200:203], v[188:191], a[96:111]
    v_mfma_f32_32x32x16_bf16 a[112:127], a[204:207], v[188:191], a[112:127]
    v_mfma_f32_32x32x16_bf16 v[64:79], a[208:211], v[192:195], v[64:79]
    s_add_u32 s42, s40, 20480
    buffer_load_dwordx4 a[160:163], v243, s[48:51], s42 offen sc1
    v_mfma_f32_32x32x16_bf16 a[80:95], a[212:215], v[192:195], a[80:95]
    v_mfma_f32_32x32x16_bf16 a[96:111], a[208:211], v[196:199], a[96:111]
    buffer_load_dwordx4 a[164:167], v240, s[48:51], s42 offen offset:1024 sc1
    v_mfma_f32_32x32x16_bf16 a[112:127], a[212:215], v[196:199], a[112:127]
    v_mfma_f32_32x32x16_bf16 v[64:79], a[216:219], v[200:203], v[64:79]
    buffer_load_dwordx4 a[168:171], v243, s[48:51], s42 offen offset:2048 sc1
    v_mfma_f32_32x32x16_bf16 a[80:95], a[220:223], v[200:203], a[80:95]
    v_mfma_f32_32x32x16_bf16 a[96:111], a[216:219], v[204:207], a[96:111]
    buffer_load_dwordx4 a[172:175], v240, s[48:51], s42 offen offset:3072 sc1
    v_mfma_f32_32x32x16_bf16 a[112:127], a[220:223], v[204:207], a[112:127]
    v_xor_b32 v252, 1, v252
    s_waitcnt vmcnt(26)
    v_mfma_f32_32x32x16_bf16 v[64:79], a[224:227], v[208:211], v[64:79]
    s_waitcnt vmcnt(7)
    buffer_store_dword v241, v248, s[48:51], 0 offen offset:640 sc1
    s_waitcnt vmcnt(5)
    v_cmp_gt_u32 vcc, v252, v242
    s_cbranch_vccnz L_B_p7_slow
L_B_p7_ok:
    v_mfma_f32_32x32x16_bf16 a[80:95], a[228:231], v[208:211], a[80:95]
    s_add_u32 s3, s10, 0
    buffer_load_dwordx4 a[48:51], v236, s[48:51], s3 offen sc1
    v_mfma_f32_32x32x16_bf16 a[96:111], a[224:227], v[212:215], a[96:111]
    buffer_load_dwordx4 a[52:55], v245, s[48:51], s3 offen sc1
    v_mfma_f32_32x32x16_bf16 a[112:127], a[228:231], v[212:215], a[112:127]
    v_mfma_f32_32x32x16_bf16 v[64:79], a[232:235], v[216:219], v[64:79]
    buffer_load_dwordx4 a[56:59], v236, s[48:51], s3 offen offset:1024 sc1
    v_mfma_f32_32x32x16_bf16 a[80:95], a[236:239], v[216:219], a[80:95]
    v_mfma_f32_32x32x16_bf16 a[96:111], a[232:235], v[220:223], a[96:111]
    buffer_load_dwordx4 a[60:63], v245, s[48:51], s3 offen offset:1024 sc1
    v_mfma_f32_32x32x16_bf16 a[112:127], a[236:239], v[220:223], a[112:127]
    v_mfma_f32_32x32x16_bf16 v[64:79], a[240:243], a[128:131], v[64:79]
    s_add_u32 s3, s10, 2048
    buffer_load_dwordx4 a[176:179], v236, s[48:51], s3 offen sc1
    v_mfma_f32_32x32x16_bf16 a[80:95], a[244:247], a[128:131], a[80:95]
    v_mfma_f32_32x32x16_bf16 a[96:111], a[240:243], a[132:135], a[96:111]
    buffer_load_dwordx4 a[180:183], v245, s[48:51], s3 offen sc1
    v_mfma_f32_32x32x16_bf16 a[112:127], a[244:247], a[132:135], a[112:127]
    v_mfma_f32_32x32x16_bf16 v[64:79], a[248:251], a[136:139], v[64:79]
    buffer_load_dwordx4 a[184:187], v236, s[48:51], s3 offen offset:1024 sc1
    v_mfma_f32_32x32x16_bf16 a[80:95], a[252:255], a[136:139], a[80:95]
    v_mfma_f32_32x32x16_bf16 a[96:111], a[248:251], a[140:143], a[96:111]
    buffer_load_dwordx4 a[188:191], v245, s[48:51], s3 offen offset:1024 sc1
    v_mfma_f32_32x32x16_bf16 a[112:127], a[252:255], a[140:143], a[112:127]
    v_mfma_f32_32x32x16_bf16 v[64:79], v[96:99], a[144:147], v[64:79]
    s_add_u32 s3, s10, 4096
    buffer_load_dwordx4 v[176:179], v236, s[48:51], s3 offen sc1
    v_mfma_f32_32x32x16_bf16 a[80:95], v[100:103], a[144:147], a[80:95]
    v_mfma_f32_32x32x16_bf16 a[96:111], v[96:99], a[148:151], a[96:111]
    buffer_load_dwordx4 v[180:183], v245, s[48:51], s3 offen sc1
    v_mfma_f32_32x32x16_bf16 a[112:127], v[100:103], a[148:151], a[112:127]
    v_mfma_f32_32x32x16_bf16 v[64:79], v[104:107], a[152:155], v[64:79]
    buffer_load_dwordx4 v[184:187], v236, s[48:51], s3 offen offset:1024 sc1
    v_mfma_f32_32x32x16_bf16 a[80:95], v[108:111], a[152:155], a[80:95]
    v_mfma_f32_32x32x16_bf16 a[96:111], v[104:107], a[156:159], a[96:111]
    buffer_load_dwordx4 v[188:191], v245, s[48:51], s3 offen offset:1024 sc1
    v_mfma_f32_32x32x16_bf16 a[112:127], v[108:111], a[156:159], a[112:127]
    s_waitcnt vmcnt(11)
    v_mfma_f32_32x32x16_bf16 v[80:95], v[112:115], a[48:51], 0
    s_add_u32 s3, s10, 6144
    buffer_load_dwordx4 a[192:195], v236, s[48:51], s3 offen sc1
    v_mfma_f32_32x32x16_bf16 a[224:239], v[116:119], a[48:51], 0
    s_waitcnt vmcnt(11)
    v_mfma_f32_32x32x16_bf16 a[240:255], v[112:115], a[52:55], 0
    buffer_load_dwordx4 a[196:199], v245, s[48:51], s3 offen sc1
    v_mfma_f32_32x32x16_bf16 v[96:111], v[116:119], a[52:55], 0
    s_waitcnt vmcnt(11)
    v_mfma_f32_32x32x16_bf16 v[80:95], v[120:123], a[56:59], v[80:95]
    buffer_load_dwordx4 a[200:203], v236, s[48:51], s3 offen offset:1024 sc1
    v_mfma_f32_32x32x16_bf16 a[224:239], v[124:127], a[56:59], a[224:239]
    s_waitcnt vmcnt(11)
    v_mfma_f32_32x32x16_bf16 a[240:255], v[120:123], a[60:63], a[240:255]
    buffer_load_dwordx4 a[204:207], v245, s[48:51], s3 offen offset:1024 sc1
    v_mfma_f32_32x32x16_bf16 v[96:111], v[124:127], a[60:63], v[96:111]
    s_waitcnt vmcnt(11)
    v_mfma_f32_32x32x16_bf16 v[80:95], v[128:131], a[176:179], v[80:95]
    buffer_load_dword v242, v244, s[48:51], 0 offen offset:640 sc1
    v_mfma_f32_32x32x16_bf16 a[224:239], v[132:135], a[176:179], a[224:239]
    s_add_u32 s42, s40, 24576
    buffer_load_dwordx4 v[192:195], v243, s[48:51], s42 offen sc1
    s_waitcnt vmcnt(12)
    v_mfma_f32_32x32x16_bf16 a[240:255], v[128:131], a[180:183], a[240:255]
    buffer_load_dwordx4 v[196:199], v240, s[48:51], s42 offen offset:1024 sc1
    v_mfma_f32_32x32x16_bf16 v[96:111], v[132:135], a[180:183], v[96:111]
    buffer_load_dwordx4 v[200:203], v243, s[48:51], s42 offen offset:2048 sc1
    s_waitcnt vmcnt(13)
    v_mfma_f32_32x32x16_bf16 v[80:95], v[136:139], a[184:187], v[80:95]
    buffer_load_dwordx4 v[204:207], v240, s[48:51], s42 offen offset:3072 sc1
    v_mfma_f32_32x32x16_bf16 a[224:239], v[140:143], a[184:187], a[224:239]
    s_add_u32 s42, s40, 28672
    buffer_load_dwordx4 a[208:211], v243, s[48:51], s42 offen sc1
    s_waitcnt vmcnt(14)
    v_mfma_f32_32x32x16_bf16 a[240:255], v[136:139], a[188:191], a[240:255]
    buffer_load_dwordx4 a[212:215], v240, s[48:51], s42 offen offset:1024 sc1
    v_mfma_f32_32x32x16_bf16 v[96:111], v[140:143], a[188:191], v[96:111]
    buffer_load_dwordx4 a[216:219], v243, s[48:51], s42 offen offset:2048 sc1
    s_waitcnt vmcnt(15)
    v_mfma_f32_32x32x16_bf16 v[80:95], v[144:147], v[176:179], v[80:95]
    buffer_load_dwordx4 a[220:223], v240, s[48:51], s42 offen offset:3072 sc1
    v_mfma_f32_32x32x16_bf16 a[224:239], v[148:151], v[176:179], a[224:239]
    s_waitcnt vmcnt(15)
    v_mfma_f32_32x32x16_bf16 a[240:255], v[144:147], v[180:183], a[240:255]
    v_mfma_f32_32x32x16_bf16 v[96:111], v[148:151], v[180:183], v[96:111]
    s_waitcnt vmcnt(14)
    v_mfma_f32_32x32x16_bf16 v[80:95], v[152:155], v[184:187], v[80:95]
    s_waitcnt vmcnt(8)
    v_cmp_gt_u32 vcc, 1, v242
    s_cbranch_vccnz L_B_p8_slow
L_B_p8_ok:
    s_add_u32 s3, s9, 16384
    buffer_load_dwordx4 v[208:211], v236, s[48:51], s3 offen sc1
    v_mfma_f32_32x32x16_bf16 a[224:239], v[156:159], v[184:187], a[224:239]
    buffer_load_dwordx4 v[212:215], v245, s[48:51], s3 offen sc1
    v_mfma_f32_32x32x16_bf16 a[240:255], v[152:155], v[188:191], a[240:255]
    buffer_load_dwordx4 v[216:219], v236, s[48:51], s3 offen offset:1024 sc1
    v_mfma_f32_32x32x16_bf16 v[96:111], v[156:159], v[188:191], v[96:111]
    buffer_load_dwordx4 v[220:223], v245, s[48:51], s3 offen offset:1024 sc1
    v_mfma_f32_32x32x16_bf16 v[80:95], v[160:163], a[192:195], v[80:95]
    s_add_u32 s3, s9, 18432
    buffer_load_dwordx4 a[128:131], v236, s[48:51], s3 offen sc1
    v_mfma_f32_32x32x16_bf16 a[224:239], v[164:167], a[192:195], a[224:239]
    buffer_load_dwordx4 a[132:135], v245, s[48:51], s3 offen sc1
    v_mfma_f32_32x32x16_bf16 a[240:255], v[160:163], a[196:199], a[240:255]
    buffer_load_dwordx4 a[136:139], v236, s[48:51], s3 offen offset:1024 sc1
    v_mfma_f32_32x32x16_bf16 v[96:111], v[164:167], a[196:199], v[96:111]
    buffer_load_dwordx4 a[140:143], v245, s[48:51], s3 offen offset:1024 sc1
    v_mfma_f32_32x32x16_bf16 v[80:95], v[168:171], a[200:203], v[80:95]
    s_add_u32 s3, s9, 20480
    buffer_load_dwordx4 a[148:151], v245, s[48:51], s3 offen sc1
    v_mfma_f32_32x32x16_bf16 a[224:239], v[172:175], a[200:203], a[224:239]
    buffer_load_dwordx4 a[156:159], v245, s[48:51], s3 offen offset:1024 sc1
    v_mfma_f32_32x32x16_bf16 a[240:255], v[168:171], a[204:207], a[240:255]
    s_add_u32 s3, s9, 22528
    buffer_load_dwordx4 a[52:55], v245, s[48:51], s3 offen sc1
    v_mfma_f32_32x32x16_bf16 v[96:111], v[172:175], a[204:207], v[96:111]
    buffer_load_dwordx4 a[60:63], v245, s[48:51], s3 offen offset:1024 sc1
    s_waitcnt vmcnt(11)
    v_mfma_f32_32x32x16_bf16 v[64:79], a[0:3], v[208:211], v[64:79]
    s_add_u32 s3, s9, 8192
    buffer_load_dwordx4 v[116:119], v245, s[48:51], s3 offen sc1
    v_mfma_f32_32x32x16_bf16 a[80:95], a[4:7], v[208:211], a[80:95]
    s_nop 0
    ds_write_b128 v250, a[224:227]
    s_waitcnt vmcnt(11)
    v_mfma_f32_32x32x16_bf16 a[96:111], a[0:3], v[212:215], a[96:111]
    buffer_load_dwordx4 v[124:127], v245, s[48:51], s3 offen offset:1024 sc1
    v_mfma_f32_32x32x16_bf16 a[112:127], a[4:7], v[212:215], a[112:127]
    ds_write_b128 v250, a[228:231] offset:1024
    s_waitcnt vmcnt(11)
    v_mfma_f32_32x32x16_bf16 v[64:79], a[8:11], v[216:219], v[64:79]
    s_add_u32 s3, s9, 10240
    buffer_load_dwordx4 a[180:183], v245, s[48:51], s3 offen sc1
    v_mfma_f32_32x32x16_bf16 a[80:95], a[12:15], v[216:219], a[80:95]
    ds_write_b128 v250, a[232:235] offset:2048
    s_waitcnt vmcnt(11)
    v_mfma_f32_32x32x16_bf16 a[96:111], a[8:11], v[220:223], a[96:111]
    buffer_load_dwordx4 a[188:191], v245, s[48:51], s3 offen offset:1024 sc1
    v_mfma_f32_32x32x16_bf16 a[112:127], a[12:15], v[220:223], a[112:127]
    ds_write_b128 v250, a[236:239] offset:3072
    s_waitcnt vmcnt(11)
    v_mfma_f32_32x32x16_bf16 v[64:79], a[16:19], a[128:131], v[64:79]
    s_add_u32 s3, s9, 12288
    buffer_load_dwordx4 v[132:135], v245, s[48:51], s3 offen sc1
    ds_read_b128 v[144:147], v237
    v_mfma_f32_32x32x16_bf16 a[80:95], a[20:23], a[128:131], a[80:95]
    ds_write_b128 v250, a[240:243] offset:16384
    s_waitcnt vmcnt(11)
    v_mfma_f32_32x32x16_bf16 a[96:111], a[16:19], a[132:135], a[96:111]
    buffer_load_dwordx4 v[140:143], v245, s[48:51], s3 offen offset:1024 sc1
    ds_read_b128 v[148:151], v237 offset:1024
    v_mfma_f32_32x32x16_bf16 a[112:127], a[20:23], a[132:135], a[112:127]
    ds_write_b128 v250, a[244:247] offset:17408
    s_waitcnt vmcnt(11)
    v_mfma_f32_32x32x16_bf16 v[64:79], a[24:27], a[136:139], v[64:79]
    s_add_u32 s3, s9, 14336
    buffer_load_dwordx4 v[180:183], v245, s[48:51], s3 offen sc1
    ds_read_b128 v[152:155], v237 offset:2048
    v_mfma_f32_32x32x16_bf16 a[80:95], a[28:31], a[136:139], a[80:95]
    ds_write_b128 v250, a[248:251] offset:18432
    s_waitcnt vmcnt(11)
    v_mfma_f32_32x32x16_bf16 a[96:111], a[24:27], a[140:143], a[96:111]
    buffer_load_dwordx4 v[188:191], v245, s[48:51], s3 offen offset:1024 sc1
    ds_read_b128 v[156:159], v237 offset:3072
    v_mfma_f32_32x32x16_bf16 a[112:127], a[28:31], a[140:143], a[112:127]
    ds_write_b128 v250, a[252:255] offset:19456
    s_waitcnt vmcnt(11)
    v_mfma_f32_32x32x16_bf16 a[96:111], a[32:35], a[148:151], a[96:111]
    s_add_u32 s3, s9, 20480
    buffer_load_dwordx4 a[144:147], v236, s[48:51], s3 offen sc1
    v_mfma_f32_32x32x16_bf16 a[112:127], a[36:39], a[148:151], a[112:127]
    ds_write_b128 v250, v[96:99] offset:32768
    s_waitcnt vmcnt(11)
    v_mfma_f32_32x32x16_bf16 a[96:111], a[40:43], a[156:159], a[96:111]
    buffer_load_dwordx4 a[152:155], v236, s[48:51], s3 offen offset:1024 sc1
    v_mfma_f32_32x32x16_bf16 a[112:127], a[44:47], a[156:159], a[112:127]
    ds_write_b128 v250, v[100:103] offset:33792
    s_waitcnt vmcnt(11) lgkmcnt(9)
    v_mfma_f32_32x32x16_bf16 a[96:111], v[144:147], a[52:55], a[96:111]
    s_add_u32 s3, s9, 22528
    buffer_load_dwordx4 a[48:51], v236, s[48:51], s3 offen sc1
    s_waitcnt lgkmcnt(7)
    v_mfma_f32_32x32x16_bf16 a[112:127], v[148:151], a[52:55], a[112:127]
    ds_write_b128 v250, v[104:107] offset:34816
    s_waitcnt vmcnt(11) lgkmcnt(6)
    v_mfma_f32_32x32x16_bf16 a[96:111], v[152:155], a[60:63], a[96:111]
    buffer_load_dwordx4 a[56:59], v236, s[48:51], s3 offen offset:1024 sc1
    s_waitcnt lgkmcnt(4)
    v_mfma_f32_32x32x16_bf16 a[112:127], v[156:159], a[60:63], a[112:127]
    ds_write_b128 v250, v[108:111] offset:35840
    s_waitcnt vmcnt(11)
    v_mfma_f32_32x32x16_bf16 a[96:111], a[64:67], v[116:119], a[96:111]
    s_add_u32 s3, s9, 8192
    buffer_load_dwordx4 v[112:115], v236, s[48:51], s3 offen sc1
    v_mfma_f32_32x32x16_bf16 a[112:127], a[68:71], v[116:119], a[112:127]
    s_waitcnt vmcnt(11)
    v_mfma_f32_32x32x16_bf16 a[96:111], a[72:75], v[124:127], a[96:111]
    buffer_load_dwordx4 v[120:123], v236, s[48:51], s3 offen offset:1024 sc1
    s_waitcnt lgkmcnt(0)
    s_barrier
    ds_read_b128 v[52:55], v251
    v_mfma_f32_32x32x16_bf16 a[112:127], a[76:79], v[124:127], a[112:127]
    ds_read_b128 v[60:63], v251 offset:16
    ds_read_b128 v[0:3], v249
    s_waitcnt vmcnt(11)
    v_mfma_f32_32x32x16_bf16 a[96:111], a[160:163], a[180:183], a[96:111]
    s_add_u32 s3, s9, 10240
    buffer_load_dwordx4 a[176:179], v236, s[48:51], s3 offen sc1
    ds_read_b128 v[4:7], v249 offset:1024
    v_mfma_f32_32x32x16_bf16 a[112:127], a[164:167], a[180:183], a[112:127]
    ds_read_b128 v[8:11], v249 offset:2048
    ds_read_b128 v[12:15], v249 offset:3072
    s_waitcnt vmcnt(11)
    v_mfma_f32_32x32x16_bf16 a[96:111], a[168:171], a[188:191], a[96:111]
    buffer_load_dwordx4 a[184:187], v236, s[48:51], s3 offen offset:1024 sc1
    ds_read_b128 v[16:19], v254 offset:16384
    v_mfma_f32_32x32x16_bf16 a[112:127], a[172:175], a[188:191], a[112:127]
    ds_read_b128 v[20:23], v254 offset:17408
    ds_read_b128 v[24:27], v254 offset:18432
    s_waitcnt vmcnt(11)
    v_mfma_f32_32x32x16_bf16 a[96:111], v[192:195], v[132:135], a[96:111]
    s_add_u32 s3, s9, 12288
    buffer_load_dwordx4 v[128:131], v236, s[48:51], s3 offen sc1
    ds_read_b128 v[28:31], v254 offset:19456
    v_mfma_f32_32x32x16_bf16 a[112:127], v[196:199], v[132:135], a[112:127]
    ds_read_b128 v[32:35], v253 offset:32768
    ds_read_b128 v[36:39], v253 offset:33792
    s_waitcnt vmcnt(11)
    v_mfma_f32_32x32x16_bf16 a[96:111], v[200:203], v[140:143], a[96:111]
    buffer_load_dwordx4 v[136:139], v236, s[48:51], s3 offen offset:1024 sc1
    ds_read_b128 v[40:43], v253 offset:34816
    v_mfma_f32_32x32x16_bf16 a[112:127], v[204:207], v[140:143], a[112:127]
    ds_read_b128 v[44:47], v253 offset:35840
    v_subrev_u32 v250, 98304, v250
    v_subrev_u32 v249, 98304, v249
    v_subrev_u32 v254, 98304, v254
    s_waitcnt vmcnt(11)
    v_mfma_f32_32x32x16_bf16 a[96:111], a[208:211], v[180:183], a[96:111]
    s_add_u32 s3, s9, 14336
    buffer_load_dwordx4 v[176:179], v236, s[48:51], s3 offen sc1
    v_subrev_u32 v253, 98304, v253
    s_waitcnt lgkmcnt(13)
    v_lshlrev_b32 v48, 16, v52
    v_mfma_f32_32x32x16_bf16 a[112:127], a[212:215], v[180:183], a[112:127]
    v_and_b32 v49, 0xffff0000, v52
    v_lshlrev_b32 v50, 16, v53
    v_and_b32 v51, 0xffff0000, v53
    v_lshlrev_b32 v52, 16, v54
    v_and_b32 v53, 0xffff0000, v54
    v_lshlrev_b32 v54, 16, v55
    s_waitcnt vmcnt(11)
    v_mfma_f32_32x32x16_bf16 a[96:111], a[216:219], v[188:191], a[96:111]
    buffer_load_dwordx4 v[184:187], v236, s[48:51], s3 offen offset:1024 sc1
    v_and_b32 v55, 0xffff0000, v55
    s_waitcnt lgkmcnt(12)
    v_lshlrev_b32 v56, 16, v60
    v_mfma_f32_32x32x16_bf16 a[112:127], a[220:223], v[188:191], a[112:127]
    v_and_b32 v57, 0xffff0000, v60
    v_lshlrev_b32 v58, 16, v61
    v_and_b32 v59, 0xffff0000, v61
    v_lshlrev_b32 v60, 16, v62
    v_and_b32 v61, 0xffff0000, v62
    v_lshlrev_b32 v62, 16, v63
    s_waitcnt vmcnt(11)
    v_mfma_f32_32x32x16_bf16 a[80:95], a[36:39], a[144:147], a[80:95]
    ds_write_b128 v250, a[96:99] offset:16384
    v_mfma_f32_32x32x16_bf16 v[64:79], a[32:35], a[144:147], v[64:79]
    v_and_b32 v63, 0xffff0000, v63
    s_waitcnt lgkmcnt(12)
    v_add_f32 v80, v80, v0
    v_add_f32 v81, v81, v1
    v_add_f32 v82, v82, v2
    v_add_f32 v83, v83, v3
    s_waitcnt lgkmcnt(11)
    v_add_f32 v84, v84, v4
    s_waitcnt vmcnt(10)
    v_mfma_f32_32x32x16_bf16 a[80:95], a[44:47], a[152:155], a[80:95]
    ds_write_b128 v250, a[100:103] offset:17408
    v_mfma_f32_32x32x16_bf16 v[64:79], a[40:43], a[152:155], v[64:79]
    v_add_f32 v85, v85, v5
    v_add_f32 v86, v86, v6
    v_add_f32 v87, v87, v7
    s_waitcnt lgkmcnt(11)
    v_add_f32 v88, v88, v8
    v_add_f32 v89, v89, v9
    v_add_f32 v90, v90, v10
    s_waitcnt vmcnt(9)
    v_mfma_f32_32x32x16_bf16 a[80:95], v[148:151], a[48:51], a[80:95]
    ds_write_b128 v250, a[104:107] offset:18432
    v_mfma_f32_32x32x16_bf16 v[64:79], v[144:147], a[48:51], v[64:79]
    v_add_f32 v91, v91, v11
    s_waitcnt lgkmcnt(11)
    v_add_f32 v92, v92, v12
    v_add_f32 v93, v93, v13
    v_add_f32 v94, v94, v14
    v_add_f32 v95, v95, v15
    s_waitcnt lgkmcnt(6)
    v_add_f32 v16, v16, v32
    s_waitcnt vmcnt(8)
    v_mfma_f32_32x32x16_bf16 a[80:95], v[156:159], a[56:59], a[80:95]
    ds_write_b128 v250, a[108:111] offset:19456
    v_mfma_f32_32x32x16_bf16 v[64:79], v[152:155], a[56:59], v[64:79]
    v_add_f32 v17, v17, v33
    v_add_f32 v18, v18, v34
    v_add_f32 v19, v19, v35
    s_waitcnt lgkmcnt(6)
    v_add_f32 v20, v20, v36
    v_add_f32 v21, v21, v37
    v_add_f32 v22, v22, v38
    s_waitcnt vmcnt(7)
    v_mfma_f32_32x32x16_bf16 a[80:95], a[68:71], v[112:115], a[80:95]
    ds_write_b128 v250, a[112:115] offset:32768
    s_waitcnt vmcnt(6)
    v_mfma_f32_32x32x16_bf16 a[80:95], a[76:79], v[120:123], a[80:95]
    v_add_f32 v23, v23, v39
    s_waitcnt lgkmcnt(6)
    v_add_f32 v24, v24, v40
    v_add_f32 v25, v25, v41
    v_add_f32 v26, v26, v42
    v_add_f32 v27, v27, v43
    s_waitcnt lgkmcnt(5)
    v_add_f32 v28, v28, v44
    s_waitcnt vmcnt(5)
    v_mfma_f32_32x32x16_bf16 a[80:95], a[164:167], a[176:179], a[80:95]
    ds_write_b128 v250, a[116:119] offset:33792
    s_waitcnt vmcnt(4)
    v_mfma_f32_32x32x16_bf16 a[80:95], a[172:175], a[184:187], a[80:95]
    v_add_f32 v29, v29, v45
    v_add_f32 v30, v30, v46
    v_add_f32 v31, v31, v47
    v_add_f32 v80, v80, v16
    v_add_f32 v81, v81, v17
    v_add_f32 v82, v82, v18
    s_waitcnt vmcnt(3)
    v_mfma_f32_32x32x16_bf16 a[80:95], v[196:199], v[128:131], a[80:95]
    ds_write_b128 v250, a[120:123] offset:34816
    s_waitcnt vmcnt(2)
    v_mfma_f32_32x32x16_bf16 a[80:95], v[204:207], v[136:139], a[80:95]
    v_add_f32 v83, v83, v19
    v_add_f32 v84, v84, v20
    v_add_f32 v85, v85, v21
    v_add_f32 v86, v86, v22
    v_add_f32 v87, v87, v23
    v_add_f32 v88, v88, v24
    s_waitcnt vmcnt(1)
    v_mfma_f32_32x32x16_bf16 a[80:95], a[212:215], v[176:179], a[80:95]
    ds_write_b128 v250, a[124:127] offset:35840
    s_waitcnt vmcnt(0)
    v_mfma_f32_32x32x16_bf16 a[80:95], a[220:223], v[184:187], a[80:95]
    v_add_f32 v89, v89, v25
    v_add_f32 v90, v90, v26
    v_add_f32 v91, v91, v27
    v_add_f32 v92, v92, v28
    v_add_f32 v93, v93, v29
    v_add_f32 v94, v94, v30
    v_mfma_f32_32x32x16_bf16 v[64:79], a[64:67], v[112:115], v[64:79]
    v_add_f32 v95, v95, v31
    v_mfma_f32_32x32x16_bf16 v[64:79], a[72:75], v[120:123], v[64:79]
    s_nop 2
    ds_write_b128 v250, a[80:83]
    v_mfma_f32_32x32x16_bf16 v[64:79], a[160:163], a[176:179], v[64:79]
    ds_write_b128 v250, a[84:87] offset:1024
    v_mfma_f32_32x32x16_bf16 v[64:79], a[168:171], a[184:187], v[64:79]
    ds_write_b128 v250, a[88:91] offset:2048
    v_mfma_f32_32x32x16_bf16 v[64:79], v[192:195], v[128:131], v[64:79]
    ds_write_b128 v250, a[92:95] offset:3072
    v_mfma_f32_32x32x16_bf16 v[64:79], v[200:203], v[136:139], v[64:79]
    v_mfma_f32_32x32x16_bf16 v[64:79], a[208:211], v[176:179], v[64:79]
    v_mfma_f32_32x32x16_bf16 v[64:79], a[216:219], v[184:187], v[64:79]
    s_waitcnt lgkmcnt(0)
    s_barrier
    ds_read_b128 v[0:3], v249
    ds_read_b128 v[16:19], v254 offset:16384
    ds_read_b128 v[32:35], v253 offset:32768
    ds_read_b128 v[4:7], v249 offset:1024
    ds_read_b128 v[20:23], v254 offset:17408
    ds_read_b128 v[36:39], v253 offset:33792
    ds_read_b128 v[8:11], v249 offset:2048
    ds_read_b128 v[24:27], v254 offset:18432
    ds_read_b128 v[40:43], v253 offset:34816
    ds_read_b128 v[12:15], v249 offset:3072
    ds_read_b128 v[28:31], v254 offset:19456
    ds_read_b128 v[44:47], v253 offset:35840
    s_waitcnt lgkmcnt(9)
    v_pk_add_f32 v[16:17], v[16:17], v[32:33]
    v_pk_add_f32 v[18:19], v[18:19], v[34:35]
    s_waitcnt lgkmcnt(6)
    v_pk_add_f32 v[20:21], v[20:21], v[36:37]
    v_pk_add_f32 v[22:23], v[22:23], v[38:39]
    v_pk_add_f32 v[64:65], v[64:65], v[0:1]
    v_pk_add_f32 v[66:67], v[66:67], v[2:3]
    v_pk_add_f32 v[68:69], v[68:69], v[4:5]
    v_pk_add_f32 v[70:71], v[70:71], v[6:7]
    v_pk_add_f32 v[64:65], v[64:65], v[16:17]
    v_pk_add_f32 v[66:67], v[66:67], v[18:19]
    v_pk_add_f32 v[68:69], v[68:69], v[20:21]
    v_pk_add_f32 v[70:71], v[70:71], v[22:23]
    v_pk_mul_f32 v[0:1], v[64:65], v[224:225]
    v_pk_mul_f32 v[2:3], v[66:67], v[224:225]
    v_pk_mul_f32 v[4:5], v[68:69], v[224:225]
    v_pk_mul_f32 v[6:7], v[70:71], v[224:225]
    v_exp_f32 v0, v0
    v_exp_f32 v1, v1
    v_exp_f32 v2, v2
    v_exp_f32 v3, v3
    v_exp_f32 v4, v4
    v_exp_f32 v5, v5
    v_exp_f32 v6, v6
    v_exp_f32 v7, v7
    v_pk_mul_f32 v[80:81], v[80:81], v[64:65]
    v_pk_mul_f32 v[82:83], v[82:83], v[66:67]
    v_pk_mul_f32 v[84:85], v[84:85], v[68:69]
    v_pk_mul_f32 v[86:87], v[86:87], v[70:71]
    v_pk_add_f32 v[0:1], v[0:1], v[226:227]
    v_pk_add_f32 v[2:3], v[2:3], v[226:227]
    v_pk_add_f32 v[4:5], v[4:5], v[226:227]
    v_pk_add_f32 v[6:7], v[6:7], v[226:227]
    v_rcp_f32 v0, v0
    v_rcp_f32 v1, v1
    v_rcp_f32 v2, v2
    v_rcp_f32 v3, v3
    v_rcp_f32 v4, v4
    v_rcp_f32 v5, v5
    v_rcp_f32 v6, v6
    v_rcp_f32 v7, v7
    v_pk_fma_f32 v[48:49], v[80:81], v[0:1], v[48:49]
    v_pk_fma_f32 v[50:51], v[82:83], v[2:3], v[50:51]
    v_pk_fma_f32 v[52:53], v[84:85], v[4:5], v[52:53]
    v_pk_fma_f32 v[54:55], v[86:87], v[6:7], v[54:55]
    v_cvt_pk_bf16_f32 v0, v48, v49
    v_cvt_pk_bf16_f32 v1, v50, v51
    v_cvt_pk_bf16_f32 v2, v52, v53
    v_cvt_pk_bf16_f32 v3, v54, v55
    ds_write_b128 v234, v[0:3]
    s_waitcnt lgkmcnt(4)
    v_pk_add_f32 v[24:25], v[24:25], v[40:41]
    v_pk_add_f32 v[26:27], v[26:27], v[42:43]
    s_waitcnt lgkmcnt(1)
    v_pk_add_f32 v[28:29], v[28:29], v[44:45]
    v_pk_add_f32 v[30:31], v[30:31], v[46:47]
    v_pk_add_f32 v[72:73], v[72:73], v[8:9]
    v_pk_add_f32 v[74:75], v[74:75], v[10:11]
    v_pk_add_f32 v[76:77], v[76:77], v[12:13]
    v_pk_add_f32 v[78:79], v[78:79], v[14:15]
    v_pk_add_f32 v[72:73], v[72:73], v[24:25]
    v_pk_add_f32 v[74:75], v[74:75], v[26:27]
    v_pk_add_f32 v[76:77], v[76:77], v[28:29]
    v_pk_add_f32 v[78:79], v[78:79], v[30:31]
    v_pk_mul_f32 v[8:9], v[72:73], v[224:225]
    v_pk_mul_f32 v[10:11], v[74:75], v[224:225]
    v_pk_mul_f32 v[12:13], v[76:77], v[224:225]
    v_pk_mul_f32 v[14:15], v[78:79], v[224:225]
    v_exp_f32 v8, v8
    v_exp_f32 v9, v9
    v_exp_f32 v10, v10
    v_exp_f32 v11, v11
    v_exp_f32 v12, v12
    v_exp_f32 v13, v13
    v_exp_f32 v14, v14
    v_exp_f32 v15, v15
    v_pk_mul_f32 v[88:89], v[88:89], v[72:73]
    v_pk_mul_f32 v[90:91], v[90:91], v[74:75]
    v_pk_mul_f32 v[92:93], v[92:93], v[76:77]
    v_pk_mul_f32 v[94:95], v[94:95], v[78:79]
    v_pk_add_f32 v[8:9], v[8:9], v[226:227]
    v_pk_add_f32 v[10:11], v[10:11], v[226:227]
    v_pk_add_f32 v[12:13], v[12:13], v[226:227]
    v_pk_add_f32 v[14:15], v[14:15], v[226:227]
    v_rcp_f32 v8, v8
    v_rcp_f32 v9, v9
    v_rcp_f32 v10, v10
    v_rcp_f32 v11, v11
    v_rcp_f32 v12, v12
    v_rcp_f32 v13, v13
    v_rcp_f32 v14, v14
    v_rcp_f32 v15, v15
    v_pk_fma_f32 v[56:57], v[88:89], v[8:9], v[56:57]
    v_pk_fma_f32 v[58:59], v[90:91], v[10:11], v[58:59]
    v_pk_fma_f32 v[60:61], v[92:93], v[12:13], v[60:61]
    v_pk_fma_f32 v[62:63], v[94:95], v[14:15], v[62:63]
    v_cvt_pk_bf16_f32 v8, v56, v57
    v_cvt_pk_bf16_f32 v9, v58, v59
    v_cvt_pk_bf16_f32 v10, v60, v61
    v_cvt_pk_bf16_f32 v11, v62, v63
    ds_write_b128 v233, v[8:11]
    s_movk_i32 s63, 16384
    s_waitcnt lgkmcnt(0)
    s_barrier
    ds_read_b128 v[48:51], v246
    ds_read_b128 v[52:55], v246 offset:1024
    s_waitcnt lgkmcnt(1)
    buffer_store_dwordx4 v[48:51], v238, s[44:47], 0 offen sc1
    s_waitcnt lgkmcnt(0)
    buffer_store_dwordx4 v[52:55], v238, s[44:47], s63 offen sc1
    s_endpgm
L_B_p1_slow:
    s_mov_b32 s79, 0
L_B_p1_spin:
    buffer_load_dword v242, v106, s[52:55], 0 offen sc1
    s_add_u32 s79, s79, 1
    s_waitcnt vmcnt(0)
    v_cmp_gt_u32 vcc, v107, v242
    s_cmp_ge_u32 s79, 1000000
    s_cbranch_scc1 L_B_p1_ok
    s_cbranch_vccnz L_B_p1_spin
    s_branch L_B_p1_ok
L_B_p2_slow:
    s_mov_b32 s79, 0
L_B_p2_spin:
    v_mov_b32 v242, 15
    s_bfm_b64 exec, 2, 0
    v_mov_b32 v242, 0
    buffer_atomic_add v242, v105, s[48:51], 0 offen offset:0 sc0 sc1
    s_mov_b64 exec, -1
    s_add_u32 s79, s79, 1
    s_waitcnt vmcnt(0)
    v_cmp_gt_u32 vcc, 1, v242
    s_cmp_ge_u32 s79, 1000000
    s_cbranch_scc1 L_B_p2_ok
    s_cbranch_vccnz L_B_p2_spin
    s_branch L_B_p2_ok
L_B_p3_slow:
    s_mov_b32 s79, 0
L_B_p3_spin:
    buffer_load_dword v242, v235, s[48:51], 0 offen sc1
    s_add_u32 s79, s79, 1
    s_waitcnt vmcnt(0)
    v_cmp_gt_u32 vcc, s43, v242
    s_cmp_ge_u32 s79, 1000000
    s_cbranch_scc1 L_B_p3_ok
    s_cbranch_vccnz L_B_p3_spin
    s_branch L_B_p3_ok
L_B_p4_slow:
    s_mov_b32 s79, 0
L_B_p4_spin:
    buffer_load_dword v242, v246, s[48:51], 0 offen sc1
    s_add_u32 s79, s79, 1
    s_waitcnt vmcnt(0)
    v_cmp_gt_u32 vcc, s78, v242
    s_cmp_ge_u32 s79, 1000000
    s_cbranch_scc1 L_B_p4_ok
    s_cbranch_vccnz L_B_p4_spin
    s_branch L_B_p4_ok
L_B_p5_slow:
    s_mov_b32 s79, 0
L_B_p5_spin:
    buffer_load_dword v242, v244, s[48:51], 0 offen offset:128 sc1
    s_add_u32 s79, s79, 1
    s_waitcnt vmcnt(0)
    v_cmp_gt_u32 vcc, v252, v242
    s_cmp_ge_u32 s79, 1000000
    s_cbranch_scc1 L_B_p5_ok
    s_cbranch_vccnz L_B_p5_spin
    s_branch L_B_p5_ok
L_B_p6_slow:
    s_mov_b32 s79, 0
L_B_p6_spin:
    buffer_load_dword v242, v244, s[48:51], 0 offen offset:256 sc1
    s_add_u32 s79, s79, 1
    s_waitcnt vmcnt(0)
    v_cmp_gt_u32 vcc, v252, v242
    s_cmp_ge_u32 s79, 1000000
    s_cbranch_scc1 L_B_p6_ok
    s_cbranch_vccnz L_B_p6_spin
    s_branch L_B_p6_ok
L_B_p7_slow:
    s_mov_b32 s79, 0
L_B_p7_spin:
    buffer_load_dword v242, v244, s[48:51], 0 offen offset:384 sc1
    s_add_u32 s79, s79, 1
    s_waitcnt vmcnt(0)
    v_cmp_gt_u32 vcc, v252, v242
    s_cmp_ge_u32 s79, 1000000
    s_cbranch_scc1 L_B_p7_ok
    s_cbranch_vccnz L_B_p7_spin
    s_branch L_B_p7_ok
L_B_p8_slow:
    s_mov_b32 s79, 0
L_B_p8_spin:
    buffer_load_dword v242, v244, s[48:51], 0 offen offset:640 sc1
    s_add_u32 s79, s79, 1
    s_waitcnt vmcnt(0)
    v_cmp_gt_u32 vcc, 1, v242
    s_cmp_ge_u32 s79, 1000000
    s_cbranch_scc1 L_B_p8_ok
    s_cbranch_vccnz L_B_p8_spin
    s_branch L_B_p8_ok
L_typeC:
    s_lshr_b32 s3, s2, 3
    s_and_b32 s63, s2, 7
    s_and_b32 s57, s2, 1
    s_lshl_b32 s57, s57, 3
    s_and_b32 s64, s3, 7
    s_add_u32 s57, s57, s64
    s_lshr_b32 s58, s63, 1
    s_lshr_b32 s59, s3, 3
    s_lshl_b32 s60, s63, 2
    s_and_b32 s64, s3, 3
    s_add_u32 s60, s60, s64
    s_lshr_b32 s61, s3, 2
    s_lshl_b32 s3, s57, 1
    s_add_u32 s3, s3, s59
    s_sub_u32 s3, s3, 2
    v_and_b32 v99, 1, v97
    s_and_b32 s64, s56, 1
    s_lshl1_add_u32 s63, s3, s64
    s_mul_i32 s63, s63, 28672
    s_mul_i32 s64, s58, 896
    s_add_u32 s63, s63, s64
    v_mul_u32_u24 v98, 3584, v96
    v_add_u32 v98, s63, v98
    v_lshl_add_u32 v217, v99, 7, v98
    s_mov_b32 s34, 1835008
    s_mov_b32 s35, 0x20000
    s_waitcnt lgkmcnt(0)
    s_mov_b32 s65, s63
    v_lshrrev_b32 v224, 4, v255
    v_and_b32 v225, 7, v255
    v_xor_b32 v225, v224, v225
    v_lshrrev_b32 v224, 3, v255
    v_mul_u32_u24 v224, 3584, v224
    v_lshl_add_u32 v224, v225, 4, v224
    s_lshl_b32 s64, s59, 7
    s_sub_u32 s64, s64, 256
    s_mul_i32 s63, s58, 896
    s_add_u32 s63, s63, s64
    s_and_b32 s64, s56, 1
    s_mul_i32 s64, s64, 114688
    s_add_u32 s63, s63, s64
    v_add_u32 v252, s63, v224
    s_lshl_b32 s63, s58, 1
    s_add_u32 s63, s63, s59
    s_lshl_b32 s63, s63, 16
    s_add_u32 s63, s63, s62
    s_add_u32 s63, s63, 14876672
    v_lshl_add_u32 v239, v255, 4, s63
    v_lshrrev_b32 v224, 4, v255
    v_and_b32 v225, 7, v255
    v_xor_b32 v225, v224, v225
    v_lshrrev_b32 v224, 3, v255
    v_mul_u32_u24 v224, 3584, v224
    v_lshl_add_u32 v224, v225, 4, v224
    s_lshl_b32 s64, s59, 7
    s_add_u32 s64, s64, 256
    s_mul_i32 s63, s58, 896
    s_add_u32 s63, s63, s64
    s_and_b32 s64, s56, 1
    s_mul_i32 s64, s64, 114688
    s_add_u32 s63, s63, s64
    v_add_u32 v238, s63, v224
    s_mov_b32 s63, s65
    s_cmp_lt_u32 s56, 2
    s_cselect_b32 s32, s12, s14
    s_cselect_b32 s33, s13, s15
    buffer_load_dword a168, v217, s[32:35], 0 offen
    v_and_b32 v99, 3, v97
    v_add_u32 v99, 2, v99
    v_lshl_add_u32 v219, v99, 7, v98
    v_bfe_u32 v98, v255, 2, 3
    v_mul_u32_u24 v98, 3584, v98
    v_bfe_u32 v99, v255, 4, 1
    v_xor_b32 v99, v99, v255
    v_and_b32 v99, 3, v99
    v_lshl_add_u32 v98, v99, 4, v98
    v_lshrrev_b32 v99, 5, v255
    v_lshl_add_u32 v98, v99, 6, v98
    s_add_u32 s63, s63, 768
    v_add_u32 v165, s63, v98
    buffer_load_dwordx4 v[184:187], v165, s[32:35], 0 offen
    s_lshr_b32 s63, s3, 3
    s_lshl_b32 s63, s63, 14
    s_and_b32 s64, s3, 7
    s_lshl_b32 s64, s64, 10
    s_add_u32 s63, s63, s64
    s_and_b32 s64, s56, 1
    s_lshl_b32 s64, s64, 9
    s_add_u32 s63, s63, s64
    s_lshr_b32 s64, s56, 1
    s_lshl_b32 s64, s64, 13
    s_add_u32 s63, s63, s64
    s_lshl_b32 s64, s58, 17
    s_add_u32 s63, s63, s64
    s_add_u32 s63, s63, 15007744
    v_and_b32 v98, 31, v255
    v_lshlrev_b32 v98, 4, v98
    v_lshl_add_u32 v98, v99, 16, v98
    v_add_u32 v166, s63, v98
    s_lshr_b32 s63, s56, 1
    s_lshl1_add_u32 s63, s3, s63
    s_lshl_b32 s64, s63, 15
    s_xor_b32 s79, s58, 1
    s_and_b32 s65, s56, 1
    s_lshl1_add_u32 s65, s79, s65
    s_mov_b32 s36, s16
    s_mov_b32 s37, s17
    s_mov_b32 s38, 1835008
    s_mov_b32 s39, 0x20000
    s_lshl_b32 s79, s65, 7
    s_add_u32 s64, s64, s79
    v_lshrrev_b32 v98, 2, v255
    v_and_b32 v98, 4, v98
    v_xor_b32 v98, v98, v97
    v_lshlrev_b32 v98, 4, v98
    v_lshl_add_u32 v98, v96, 10, v98
    v_add_u32 v110, s64, v98
    s_mul_i32 s64, s65, 294912
    s_lshl_b32 s63, s63, 12
    s_add_u32 s64, s64, s63
    s_add_u32 s64, s64, 12587008
    s_lshl_b32 s63, s58, 5
    s_add_u32 s63, s63, s3
    s_and_b32 s65, s63, 7
    s_lshr_b32 s63, s63, 3
    s_lshl_b32 s63, s63, 7
    s_lshl2_add_u32 s63, s65, s63
    s_add_u32 s63, s63, 9641984
    s_cmp_lt_u32 s57, 14
    s_cselect_b32 s64, s64, 1073741824
    s_cmp_eq_u32 s56, 0
    s_cselect_b32 s63, s63, 1073741824
    v_lshl_add_u32 v111, v255, 4, s64
    v_mov_b32 v232, 1073741824
    v_writelane_b32 v232, s63, 0
    s_add_u32 m0, s62, 147456
    s_mov_b32 s78, 7168
    buffer_load_dwordx4 v110, s[36:39], 0 offen lds
    buffer_load_dwordx4 v110, s[36:39], s78 offen offset:1024 lds
    s_add_u32 s78, s78, 7168
    buffer_load_dwordx4 v110, s[36:39], s78 offen offset:2048 lds
    s_add_u32 s78, s78, 7168
    buffer_load_dwordx4 v110, s[36:39], s78 offen offset:3072 lds
    s_mov_b32 s26, 2097152
    s_mov_b32 s27, 0x20000
    s_mov_b32 s48, s22
    s_mov_b32 s49, s23
    s_mov_b32 s50, 15728640
    s_mov_b32 s51, 0x20000
    s_mov_b32 s52, s20
    s_mov_b32 s53, s21
    s_mov_b32 s54, 256
    s_mov_b32 s55, 0x20000
    s_mov_b32 s44, s18
    s_mov_b32 s45, s19
    s_mov_b32 s46, 2097152
    s_mov_b32 s47, 0x20000
    v_mov_b32 v241, 1
    s_mov_b32 s11, 27648
    s_mov_b32 s12, 55296
    s_mov_b32 s13, 82944
    s_lshl_b32 s63, s57, 2
    s_add_u32 s63, s63, s56
    s_lshl_b32 s64, s63, 7
    s_add_u32 s64, s64, 9633792
    v_and_b32 v244, 1, v255
    v_lshlrev_b32 v244, 2, v244
    v_add_u32 v105, s64, v244
    s_lshl_b32 s63, s63, 15
    s_add_u32 s63, s63, 9666560
    v_lshl_add_u32 v216, v255, 4, s63
    s_cmp_eq_u32 s56, 0
    s_cselect_b32 s63, 0, 1073741824
    s_cselect_b32 s65, 1, 0
    v_lshl_add_u32 v106, v97, 2, s63
    v_mov_b32 v107, s65
    s_mov_b32 s17, 0xbfb8aa3b
    s_mul_i32 s9, s56, 28672
    s_lshl_b32 s10, s56, 13
    s_add_u32 s10, s10, 114688
    s_lshl_b32 s40, s9, 1
    s_lshl_b32 s41, s10, 1
    v_bfe_u32 v224, v255, 2, 3
    v_and_b32 v225, 32, v255
    v_lshrrev_b32 v225, 1, v225
    v_add_u32 v225, v225, v224
    v_and_b32 v226, 1, v255
    v_lshlrev_b32 v226, 3, v226
    v_and_b32 v227, 2, v255
    v_lshl_add_u32 v254, v225, 7, v226
    v_lshl_add_u32 v254, v227, 5, v254
    v_lshrrev_b32 v224, 1, v224
    v_lshl_add_u32 v254, v224, 4, v254
    v_xor_b32 v253, 16, v254
    v_xor_b32 v233, 32, v254
    v_xor_b32 v246, 48, v254
    v_lshl_add_u32 v249, v225, 6, v226
    v_lshl_add_u32 v249, v227, 4, v249
    v_and_or_b32 v249, v255, 16, v249
    v_xor_b32 v247, 16, v249
    s_mul_i32 s4, s58, 28672
    s_lshl_b32 s63, s59, 12
    s_sub_u32 s63, s63, 8192
    s_add_u32 s4, s4, s63
    s_mul_i32 s5, s58, 28672
    s_lshl_b32 s63, s59, 11
    s_add_u32 s63, s63, 20480
    s_add_u32 s5, s5, s63
    s_mul_i32 s6, s58, 28672
    s_lshl_b32 s63, s59, 12
    s_add_u32 s63, s63, 8192
    s_add_u32 s6, s6, s63
    s_lshl_b32 s63, s57, 2
    s_add_u32 s63, s63, s56
    s_mul_i32 s64, s63, 148480
    v_and_b32 v224, 16, v255
    v_lshlrev_b32 v224, 1, v224
    v_and_or_b32 v224, v255, 15, v224
    v_lshl_add_u32 v224, v224, 4, s64
    v_and_b32 v225, 32, v255
    v_lshl_add_u32 v251, v225, 6, v224
    v_lshl_add_u32 v250, v225, 5, v224
    s_lshr_b32 s63, s63, 1
    s_lshl_b32 s63, s63, 2
    s_add_u32 s63, s63, s58
    s_lshl_b32 s63, s63, 10
    s_and_b32 s64, s56, 1
    s_lshl_b32 s65, s59, 1
    s_add_u32 s64, s64, s65
    s_lshl_b32 s64, s64, 2
    s_add_u32 s63, s63, s64
    s_add_u32 s63, s63, 9502720
    v_mov_b32 v224, 1073741824
    v_mov_b32 v225, s63
    v_cmp_eq_u32 vcc, 0, v255
    s_nop 1
    v_cndmask_b32 v248, v224, v225, vcc
    s_lshl_b32 s63, s60, 1
    s_lshr_b32 s64, s56, 1
    s_add_u32 s63, s63, s64
    s_mul_i32 s20, s63, 148480
    s_xor_b32 s64, s63, 1
    s_mul_i32 s23, s64, 148480
    s_lshl_b32 s63, s63, 5
    s_and_b32 s64, s63, 1023
    s_lshl_b32 s64, s64, 11
    s_lshr_b32 s63, s63, 10
    s_lshl_b32 s63, s63, 10
    s_add_u32 s63, s63, s64
    s_lshl_b32 s64, s61, 7
    s_add_u32 s63, s63, s64
    s_and_b32 s64, s56, 1
    s_lshl_b32 s64, s64, 6
    s_add_u32 s22, s63, s64
    s_lshl_b32 s63, s60, 2
    s_add_u32 s63, s63, s56
    s_lshl_b32 s63, s63, 10
    s_add_u32 s21, s63, 9502720
    s_mul_i32 s63, s61, 294912
    s_add_u32 s63, s63, 12587008
    s_lshl_b32 s64, s64, 4
    s_add_u32 s65, s63, s64
    v_lshl_add_u32 v243, v255, 4, s65
    s_sub_u32 s65, s63, s64
    v_lshl_add_u32 v240, v255, 4, s65
    v_lshl_add_u32 v237, v255, 4, s62
    s_lshl_b32 s63, s61, 8
    s_add_u32 s63, s63, 9646080
    s_lshl_b32 s64, s58, 9
    s_add_u32 s64, s64, 9644032
    s_lshr_b32 s65, s61, 1
    s_xor_b32 s65, s65, 1
    s_lshl_b32 s65, s65, 9
    s_add_u32 s65, s65, 9644032
    s_cmp_eq_u32 s56, 0
    s_cselect_b32 s63, s63, 1073741824
    s_cselect_b32 s64, s64, 1073741824
    s_cselect_b32 s65, s65, 1073741824
    s_cselect_b32 s43, 1, 0
    v_and_b32 v224, 24, v255
    v_lshlrev_b32 v224, 2, v224
    v_and_or_b32 v224, v255, 7, v224
    v_and_b32 v225, 63, v224
    v_lshl_add_u32 v225, v225, 2, s63
    v_lshl_add_u32 v235, v224, 2, s65
    v_cmp_lt_u32 vcc, 31, v255
    s_nop 1
    v_cndmask_b32 v235, v235, v225, vcc
    v_lshl_add_u32 v234, v224, 2, s64
    s_add_u32 m0, s62, 0
    s_nop 0
    buffer_load_dwordx4 v252, s[32:35], 0 offen lds
    buffer_load_dwordx4 v252, s[32:35], s11 offen offset:1024 lds
    buffer_load_dwordx4 v252, s[32:35], s12 offen offset:2048 lds
    buffer_load_dwordx4 v252, s[32:35], s13 offen offset:3072 lds
    s_add_u32 m0, s62, 16384
    v_add_u32 v252, 229376, v252
    buffer_load_dwordx4 v252, s[32:35], 0 offen lds
    buffer_load_dwordx4 v252, s[32:35], s11 offen offset:1024 lds
    buffer_load_dwordx4 v252, s[32:35], s12 offen offset:2048 lds
    buffer_load_dwordx4 v252, s[32:35], s13 offen offset:3072 lds
    s_add_u32 m0, s62, 32768
    v_add_u32 v252, 229376, v252
    buffer_load_dwordx4 v252, s[32:35], 0 offen lds
    buffer_load_dwordx4 v252, s[32:35], s11 offen offset:1024 lds
    buffer_load_dwordx4 v252, s[32:35], s12 offen offset:2048 lds
    buffer_load_dwordx4 v252, s[32:35], s13 offen offset:3072 lds
    v_bfe_u32 v98, v255, 2, 2
    v_lshrrev_b32 v99, 5, v255
    v_lshl_add_u32 v163, v99, 2, v98
    v_lshlrev_b32 v163, 7, v163
    v_lshrrev_b32 v98, 1, v98
    v_lshl_add_u32 v163, v98, 6, v163
    v_and_b32 v98, 1, v255
    v_lshl_add_u32 v163, v98, 5, v163
    v_and_or_b32 v163, v255, 16, v163
    v_and_b32 v98, 2, v255
    v_lshl_add_u32 v163, v98, 2, v163
    s_add_u32 s63, s62, 147456
    v_add_u32 v163, s63, v163
    v_xor_b32 v164, 64, v163
    s_waitcnt vmcnt(12)
    ds_read_b64_tr_b16 v[168:169], v163
    ds_read_b64_tr_b16 v[170:171], v163 offset:1024
    ds_read_b64_tr_b16 v[172:173], v164
    ds_read_b64_tr_b16 v[174:175], v164 offset:1024
    ds_read_b64_tr_b16 v[176:177], v163 offset:2048
    ds_read_b64_tr_b16 v[178:179], v163 offset:3072
    ds_read_b64_tr_b16 v[180:181], v164 offset:2048
    ds_read_b64_tr_b16 v[182:183], v164 offset:3072
    buffer_load_dword v242, v106, s[52:55], 0 offen sc1
    buffer_store_dwordx4 v[184:187], v166, s[48:51], 0 offen sc1
    s_waitcnt lgkmcnt(6)
    buffer_store_dwordx4 v[168:171], v111, s[48:51], 0 offen sc1
    s_waitcnt lgkmcnt(4)
    buffer_store_dwordx4 v[172:175], v111, s[48:51], 0 offen offset:1024 sc1
    s_waitcnt lgkmcnt(2)
    buffer_store_dwordx4 v[176:179], v111, s[48:51], 0 offen offset:2048 sc1
    s_waitcnt lgkmcnt(0)
    buffer_store_dwordx4 v[180:183], v111, s[48:51], 0 offen offset:3072 sc1
    s_add_u32 m0, s62, 49152
    v_add_u32 v252, 229376, v252
    buffer_load_dwordx4 v252, s[32:35], 0 offen lds
    buffer_load_dwordx4 v252, s[32:35], s11 offen offset:1024 lds
    buffer_load_dwordx4 v252, s[32:35], s12 offen offset:2048 lds
    buffer_load_dwordx4 v252, s[32:35], s13 offen offset:3072 lds
    s_waitcnt vmcnt(9)
    v_cmp_gt_u32 vcc, v107, v242
    s_cbranch_vccnz L_C_p1_slow
L_C_p1_ok:
    s_barrier
    v_mov_b32 v242, 15
    s_bfm_b64 exec, 2, 0
    v_mov_b32 v242, 0
    buffer_atomic_add v242, v105, s[48:51], 0 offen offset:0 sc0 sc1
    s_mov_b64 exec, -1
    s_add_u32 m0, s62, 65536
    v_add_u32 v252, 229376, v252
    buffer_load_dwordx4 v252, s[32:35], 0 offen lds
    buffer_load_dwordx4 v252, s[32:35], s11 offen offset:1024 lds
    buffer_load_dwordx4 v252, s[32:35], s12 offen offset:2048 lds
    buffer_load_dwordx4 v252, s[32:35], s13 offen offset:3072 lds
    s_waitcnt vmcnt(4)
    v_cmp_gt_u32 vcc, 1, v242
    s_cbranch_vccnz L_C_p2_slow
L_C_p2_ok:
    s_mov_b32 s71, 0
    buffer_load_dwordx4 a[0:3], v216, s[48:51], s71 offen sc1
    buffer_load_dwordx4 a[4:7], v216, s[48:51], s71 offen offset:1024 sc1
    buffer_load_dwordx4 a[8:11], v216, s[48:51], s71 offen offset:2048 sc1
    buffer_load_dwordx4 a[12:15], v216, s[48:51], s71 offen offset:3072 sc1
    s_barrier
    buffer_store_dword v241, v232, s[48:51], 0 offen offset:2048 sc1
    ds_read_b64_tr_b16 a[128:129], v254
    ds_read_b64_tr_b16 a[130:131], v254 offset:1024
    ds_read_b64_tr_b16 a[132:133], v254 offset:4096
    ds_read_b64_tr_b16 a[134:135], v254 offset:5120
    s_mov_b32 s71, 4096
    buffer_load_dwordx4 a[16:19], v216, s[48:51], s71 offen sc1
    ds_read_b64_tr_b16 a[136:137], v254 offset:8192
    ds_read_b64_tr_b16 a[138:139], v254 offset:9216
    ds_read_b64_tr_b16 a[140:141], v254 offset:12288
    ds_read_b64_tr_b16 a[142:143], v254 offset:13312
    buffer_load_dwordx4 a[20:23], v216, s[48:51], s71 offen offset:1024 sc1
    ds_read_b64_tr_b16 a[144:145], v253
    ds_read_b64_tr_b16 a[146:147], v253 offset:1024
    ds_read_b64_tr_b16 a[148:149], v253 offset:4096
    ds_read_b64_tr_b16 a[150:151], v253 offset:5120
    buffer_load_dwordx4 a[24:27], v216, s[48:51], s71 offen offset:2048 sc1
    ds_read_b64_tr_b16 a[152:153], v253 offset:8192
    ds_read_b64_tr_b16 a[154:155], v253 offset:9216
    ds_read_b64_tr_b16 a[156:157], v253 offset:12288
    ds_read_b64_tr_b16 a[158:159], v253 offset:13312
    buffer_load_dwordx4 a[28:31], v216, s[48:51], s71 offen offset:3072 sc1
    s_waitcnt lgkmcnt(8)
    s_waitcnt vmcnt(8)
    v_mfma_f32_16x16x32_bf16 v[0:3], a[128:131], a[0:3], 0
    ds_read_b64_tr_b16 a[160:161], v233
    s_add_u32 m0, s62, 81920
    v_add_u32 v252, 229376, v252
    s_waitcnt vmcnt(6)
    v_mfma_f32_16x16x32_bf16 v[0:3], a[132:135], a[8:11], v[0:3]
    ds_read_b64_tr_b16 a[162:163], v233 offset:1024
    s_mov_b32 s71, 8192
    s_waitcnt vmcnt(5)
    v_mfma_f32_16x16x32_bf16 v[32:35], a[132:135], a[12:15], 0
    buffer_load_dwordx4 a[32:35], v216, s[48:51], s71 offen sc1
    v_mfma_f32_16x16x32_bf16 v[32:35], a[128:131], a[4:7], v[32:35]
    ds_read_b64_tr_b16 a[164:165], v233 offset:4096
    ds_read_b64_tr_b16 a[166:167], v233 offset:5120
    v_mfma_f32_16x16x32_bf16 v[16:19], a[136:139], a[0:3], 0
    buffer_load_dwordx4 v252, s[32:35], 0 offen lds
    v_mfma_f32_16x16x32_bf16 v[16:19], a[140:143], a[8:11], v[16:19]
    ds_read_b64_tr_b16 a[128:129], v233 offset:8192
    ds_read_b64_tr_b16 a[130:131], v233 offset:9216
    v_mfma_f32_16x16x32_bf16 v[48:51], a[140:143], a[12:15], 0
    buffer_load_dwordx4 a[36:39], v216, s[48:51], s71 offen offset:1024 sc1
    v_mfma_f32_16x16x32_bf16 v[48:51], a[136:139], a[4:7], v[48:51]
    ds_read_b64_tr_b16 a[132:133], v233 offset:12288
    ds_read_b64_tr_b16 a[134:135], v233 offset:13312
    s_waitcnt lgkmcnt(8)
    v_mfma_f32_16x16x32_bf16 v[4:7], a[144:147], a[0:3], 0
    buffer_load_dwordx4 v252, s[32:35], s11 offen offset:1024 lds
    v_mfma_f32_16x16x32_bf16 v[4:7], a[148:151], a[8:11], v[4:7]
    ds_read_b64_tr_b16 a[136:137], v246
    ds_read_b64_tr_b16 a[138:139], v246 offset:1024
    v_mfma_f32_16x16x32_bf16 v[36:39], a[148:151], a[12:15], 0
    buffer_load_dwordx4 v252, s[32:35], s12 offen offset:2048 lds
    v_mfma_f32_16x16x32_bf16 v[36:39], a[144:147], a[4:7], v[36:39]
    ds_read_b64_tr_b16 a[140:141], v246 offset:4096
    ds_read_b64_tr_b16 a[142:143], v246 offset:5120
    v_mfma_f32_16x16x32_bf16 v[20:23], a[152:155], a[0:3], 0
    buffer_load_dwordx4 v252, s[32:35], s13 offen offset:3072 lds
    v_mfma_f32_16x16x32_bf16 v[20:23], a[156:159], a[8:11], v[20:23]
    ds_read_b64_tr_b16 a[144:145], v246 offset:8192
    ds_read_b64_tr_b16 a[146:147], v246 offset:9216
    v_mfma_f32_16x16x32_bf16 v[52:55], a[156:159], a[12:15], 0
    ds_read_b64_tr_b16 a[148:149], v246 offset:12288
    v_mfma_f32_16x16x32_bf16 v[52:55], a[152:155], a[4:7], v[52:55]
    ds_read_b64_tr_b16 a[150:151], v246 offset:13312
    s_barrier
    s_waitcnt lgkmcnt(8)
    v_mfma_f32_16x16x32_bf16 v[8:11], a[160:163], a[0:3], 0
    ds_read_b64_tr_b16 a[152:153], v254 offset:16384
    s_add_u32 m0, s62, 98304
    v_mfma_f32_16x16x32_bf16 v[8:11], a[164:167], a[8:11], v[8:11]
    ds_read_b64_tr_b16 a[154:155], v254 offset:17408
    v_add_u32 v252, 229376, v252
    v_mfma_f32_16x16x32_bf16 v[40:43], a[164:167], a[12:15], 0
    buffer_load_dwordx4 a[40:43], v216, s[48:51], s71 offen offset:2048 sc1
    v_mfma_f32_16x16x32_bf16 v[40:43], a[160:163], a[4:7], v[40:43]
    ds_read_b64_tr_b16 a[156:157], v254 offset:20480
    ds_read_b64_tr_b16 a[158:159], v254 offset:21504
    v_mfma_f32_16x16x32_bf16 v[24:27], a[128:131], a[0:3], 0
    ds_read_b64_tr_b16 a[160:161], v254 offset:24576
    v_mfma_f32_16x16x32_bf16 v[24:27], a[132:135], a[8:11], v[24:27]
    ds_read_b64_tr_b16 a[162:163], v254 offset:25600
    v_mfma_f32_16x16x32_bf16 v[56:59], a[132:135], a[12:15], 0
    buffer_load_dwordx4 v252, s[32:35], 0 offen lds
    v_mfma_f32_16x16x32_bf16 v[56:59], a[128:131], a[4:7], v[56:59]
    ds_read_b64_tr_b16 a[164:165], v254 offset:28672
    ds_read_b64_tr_b16 a[166:167], v254 offset:29696
    s_waitcnt lgkmcnt(8)
    v_mfma_f32_16x16x32_bf16 v[12:15], a[136:139], a[0:3], 0
    ds_read_b64_tr_b16 a[128:129], v253 offset:16384
    v_mfma_f32_16x16x32_bf16 v[12:15], a[140:143], a[8:11], v[12:15]
    ds_read_b64_tr_b16 a[130:131], v253 offset:17408
    v_mfma_f32_16x16x32_bf16 v[44:47], a[140:143], a[12:15], 0
    buffer_load_dwordx4 a[44:47], v216, s[48:51], s71 offen offset:3072 sc1
    v_mfma_f32_16x16x32_bf16 v[44:47], a[136:139], a[4:7], v[44:47]
    ds_read_b64_tr_b16 a[132:133], v253 offset:20480
    ds_read_b64_tr_b16 a[134:135], v253 offset:21504
    v_mfma_f32_16x16x32_bf16 v[28:31], a[144:147], a[0:3], 0
    buffer_load_dwordx4 v252, s[32:35], s11 offen offset:1024 lds
    v_mfma_f32_16x16x32_bf16 v[28:31], a[148:151], a[8:11], v[28:31]
    ds_read_b64_tr_b16 a[136:137], v253 offset:24576
    ds_read_b64_tr_b16 a[138:139], v253 offset:25600
    v_mfma_f32_16x16x32_bf16 v[60:63], a[148:151], a[12:15], 0
    ds_read_b64_tr_b16 a[140:141], v253 offset:28672
    s_mov_b32 s71, 12288
    v_mfma_f32_16x16x32_bf16 v[60:63], a[144:147], a[4:7], v[60:63]
    ds_read_b64_tr_b16 a[142:143], v253 offset:29696
    s_waitcnt lgkmcnt(8)
    s_waitcnt vmcnt(13)
    v_mfma_f32_16x16x32_bf16 v[0:3], a[152:155], a[16:19], v[0:3]
    ds_read_b64_tr_b16 a[144:145], v233 offset:16384
    s_waitcnt vmcnt(11)
    v_mfma_f32_16x16x32_bf16 v[0:3], a[156:159], a[24:27], v[0:3]
    ds_read_b64_tr_b16 a[146:147], v233 offset:17408
    s_waitcnt vmcnt(10)
    v_mfma_f32_16x16x32_bf16 v[32:35], a[156:159], a[28:31], v[32:35]
    buffer_load_dwordx4 a[48:51], v216, s[48:51], s71 offen sc1
    v_mfma_f32_16x16x32_bf16 v[32:35], a[152:155], a[20:23], v[32:35]
    ds_read_b64_tr_b16 a[148:149], v233 offset:20480
    ds_read_b64_tr_b16 a[150:151], v233 offset:21504
    v_mfma_f32_16x16x32_bf16 v[16:19], a[160:163], a[16:19], v[16:19]
    buffer_load_dwordx4 v252, s[32:35], s12 offen offset:2048 lds
    v_mfma_f32_16x16x32_bf16 v[16:19], a[164:167], a[24:27], v[16:19]
    ds_read_b64_tr_b16 a[152:153], v233 offset:24576
    ds_read_b64_tr_b16 a[154:155], v233 offset:25600
    v_mfma_f32_16x16x32_bf16 v[48:51], a[164:167], a[28:31], v[48:51]
    ds_read_b64_tr_b16 a[156:157], v233 offset:28672
    v_mfma_f32_16x16x32_bf16 v[48:51], a[160:163], a[20:23], v[48:51]
    ds_read_b64_tr_b16 a[158:159], v233 offset:29696
    s_waitcnt lgkmcnt(8)
    v_mfma_f32_16x16x32_bf16 v[4:7], a[128:131], a[16:19], v[4:7]
    buffer_load_dwordx4 a[52:55], v216, s[48:51], s71 offen offset:1024 sc1
    v_mfma_f32_16x16x32_bf16 v[4:7], a[132:135], a[24:27], v[4:7]
    ds_read_b64_tr_b16 a[160:161], v246 offset:16384
    ds_read_b64_tr_b16 a[162:163], v246 offset:17408
    v_mfma_f32_16x16x32_bf16 v[36:39], a[132:135], a[28:31], v[36:39]
    ds_read_b64_tr_b16 a[164:165], v246 offset:20480
    v_mfma_f32_16x16x32_bf16 v[36:39], a[128:131], a[20:23], v[36:39]
    ds_read_b64_tr_b16 a[166:167], v246 offset:21504
    v_mfma_f32_16x16x32_bf16 v[20:23], a[136:139], a[16:19], v[20:23]
    buffer_load_dwordx4 v252, s[32:35], s13 offen offset:3072 lds
    v_mfma_f32_16x16x32_bf16 v[20:23], a[140:143], a[24:27], v[20:23]
    ds_read_b64_tr_b16 a[128:129], v246 offset:24576
    ds_read_b64_tr_b16 a[130:131], v246 offset:25600
    v_mfma_f32_16x16x32_bf16 v[52:55], a[140:143], a[28:31], v[52:55]
    ds_read_b64_tr_b16 a[132:133], v246 offset:28672
    v_mfma_f32_16x16x32_bf16 v[52:55], a[136:139], a[20:23], v[52:55]
    ds_read_b64_tr_b16 a[134:135], v246 offset:29696
    s_barrier
    s_waitcnt lgkmcnt(8)
    v_mfma_f32_16x16x32_bf16 v[8:11], a[144:147], a[16:19], v[8:11]
    ds_read_b64_tr_b16 a[136:137], v254 offset:32768
    s_add_u32 m0, s62, 0
    v_mfma_f32_16x16x32_bf16 v[8:11], a[148:151], a[24:27], v[8:11]
    ds_read_b64_tr_b16 a[138:139], v254 offset:33792
    v_add_u32 v252, 229376, v252
    v_mfma_f32_16x16x32_bf16 v[40:43], a[148:151], a[28:31], v[40:43]
    buffer_load_dwordx4 a[56:59], v216, s[48:51], s71 offen offset:2048 sc1
    v_mfma_f32_16x16x32_bf16 v[40:43], a[144:147], a[20:23], v[40:43]
    ds_read_b64_tr_b16 a[140:141], v254 offset:36864
    ds_read_b64_tr_b16 a[142:143], v254 offset:37888
    v_mfma_f32_16x16x32_bf16 v[24:27], a[152:155], a[16:19], v[24:27]
    buffer_load_dwordx4 v252, s[32:35], 0 offen lds
    v_mfma_f32_16x16x32_bf16 v[24:27], a[156:159], a[24:27], v[24:27]
    ds_read_b64_tr_b16 a[144:145], v254 offset:40960
    ds_read_b64_tr_b16 a[146:147], v254 offset:41984
    v_mfma_f32_16x16x32_bf16 v[56:59], a[156:159], a[28:31], v[56:59]
    ds_read_b64_tr_b16 a[148:149], v254 offset:45056
    v_mfma_f32_16x16x32_bf16 v[56:59], a[152:155], a[20:23], v[56:59]
    ds_read_b64_tr_b16 a[150:151], v254 offset:46080
    s_waitcnt lgkmcnt(8)
    v_mfma_f32_16x16x32_bf16 v[12:15], a[160:163], a[16:19], v[12:15]
    buffer_load_dwordx4 a[60:63], v216, s[48:51], s71 offen offset:3072 sc1
    v_mfma_f32_16x16x32_bf16 v[12:15], a[164:167], a[24:27], v[12:15]
    ds_read_b64_tr_b16 a[152:153], v253 offset:32768
    ds_read_b64_tr_b16 a[154:155], v253 offset:33792
    v_mfma_f32_16x16x32_bf16 v[44:47], a[164:167], a[28:31], v[44:47]
    buffer_load_dwordx4 v252, s[32:35], s11 offen offset:1024 lds
    v_mfma_f32_16x16x32_bf16 v[44:47], a[160:163], a[20:23], v[44:47]
    ds_read_b64_tr_b16 a[156:157], v253 offset:36864
    ds_read_b64_tr_b16 a[158:159], v253 offset:37888
    v_mfma_f32_16x16x32_bf16 v[28:31], a[128:131], a[16:19], v[28:31]
    ds_read_b64_tr_b16 a[160:161], v253 offset:40960
    s_mov_b32 s71, 16384
    v_mfma_f32_16x16x32_bf16 v[28:31], a[132:135], a[24:27], v[28:31]
    ds_read_b64_tr_b16 a[162:163], v253 offset:41984
    v_mfma_f32_16x16x32_bf16 v[60:63], a[132:135], a[28:31], v[60:63]
    buffer_load_dwordx4 a[64:67], v216, s[48:51], s71 offen sc1
    v_mfma_f32_16x16x32_bf16 v[60:63], a[128:131], a[20:23], v[60:63]
    ds_read_b64_tr_b16 a[164:165], v253 offset:45056
    ds_read_b64_tr_b16 a[166:167], v253 offset:46080
    s_waitcnt lgkmcnt(8)
    s_waitcnt vmcnt(18)
    v_mfma_f32_16x16x32_bf16 v[0:3], a[136:139], a[32:35], v[0:3]
    buffer_load_dwordx4 v252, s[32:35], s12 offen offset:2048 lds
    s_waitcnt vmcnt(13)
    v_mfma_f32_16x16x32_bf16 v[0:3], a[140:143], a[40:43], v[0:3]
    ds_read_b64_tr_b16 a[128:129], v233 offset:32768
    ds_read_b64_tr_b16 a[130:131], v233 offset:33792
    s_waitcnt vmcnt(11)
    v_mfma_f32_16x16x32_bf16 v[32:35], a[140:143], a[44:47], v[32:35]
    ds_read_b64_tr_b16 a[132:133], v233 offset:36864
    v_mfma_f32_16x16x32_bf16 v[32:35], a[136:139], a[36:39], v[32:35]
    ds_read_b64_tr_b16 a[134:135], v233 offset:37888
    v_mfma_f32_16x16x32_bf16 v[16:19], a[144:147], a[32:35], v[16:19]
    buffer_load_dwordx4 a[68:71], v216, s[48:51], s71 offen offset:1024 sc1
    v_mfma_f32_16x16x32_bf16 v[16:19], a[148:151], a[40:43], v[16:19]
    ds_read_b64_tr_b16 a[136:137], v233 offset:40960
    ds_read_b64_tr_b16 a[138:139], v233 offset:41984
    v_mfma_f32_16x16x32_bf16 v[48:51], a[148:151], a[44:47], v[48:51]
    buffer_load_dwordx4 v252, s[32:35], s13 offen offset:3072 lds
    v_mfma_f32_16x16x32_bf16 v[48:51], a[144:147], a[36:39], v[48:51]
    ds_read_b64_tr_b16 a[140:141], v233 offset:45056
    ds_read_b64_tr_b16 a[142:143], v233 offset:46080
    s_waitcnt lgkmcnt(8)
    v_mfma_f32_16x16x32_bf16 v[4:7], a[152:155], a[32:35], v[4:7]
    buffer_load_dwordx4 a[72:75], v216, s[48:51], s71 offen offset:2048 sc1
    v_mfma_f32_16x16x32_bf16 v[4:7], a[156:159], a[40:43], v[4:7]
    ds_read_b64_tr_b16 a[144:145], v246 offset:32768
    ds_read_b64_tr_b16 a[146:147], v246 offset:33792
    v_mfma_f32_16x16x32_bf16 v[36:39], a[156:159], a[44:47], v[36:39]
    ds_read_b64_tr_b16 a[148:149], v246 offset:36864
    v_mfma_f32_16x16x32_bf16 v[36:39], a[152:155], a[36:39], v[36:39]
    ds_read_b64_tr_b16 a[150:151], v246 offset:37888
    v_mfma_f32_16x16x32_bf16 v[20:23], a[160:163], a[32:35], v[20:23]
    buffer_load_dwordx4 a[76:79], v216, s[48:51], s71 offen offset:3072 sc1
    v_mfma_f32_16x16x32_bf16 v[20:23], a[164:167], a[40:43], v[20:23]
    ds_read_b64_tr_b16 a[152:153], v246 offset:40960
    ds_read_b64_tr_b16 a[154:155], v246 offset:41984
    v_mfma_f32_16x16x32_bf16 v[52:55], a[164:167], a[44:47], v[52:55]
    ds_read_b64_tr_b16 a[156:157], v246 offset:45056
    v_mfma_f32_16x16x32_bf16 v[52:55], a[160:163], a[36:39], v[52:55]
    ds_read_b64_tr_b16 a[158:159], v246 offset:46080
    s_barrier
    s_waitcnt lgkmcnt(8)
    v_mfma_f32_16x16x32_bf16 v[8:11], a[128:131], a[32:35], v[8:11]
    buffer_load_dword v242, v234, s[48:51], 0 offen sc1
    v_mfma_f32_16x16x32_bf16 v[8:11], a[132:135], a[40:43], v[8:11]
    ds_read_b64_tr_b16 a[160:161], v254 offset:49152
    ds_read_b64_tr_b16 a[162:163], v254 offset:50176
    v_mfma_f32_16x16x32_bf16 v[40:43], a[132:135], a[44:47], v[40:43]
    ds_read_b64_tr_b16 a[164:165], v254 offset:53248
    ds_read_b64_tr_b16 a[166:167], v254 offset:54272
    s_mov_b32 s71, 20480
    v_mfma_f32_16x16x32_bf16 v[40:43], a[128:131], a[36:39], v[40:43]
    buffer_load_dwordx4 a[80:83], v216, s[48:51], s71 offen sc1
    v_mfma_f32_16x16x32_bf16 v[24:27], a[136:139], a[32:35], v[24:27]
    buffer_load_dwordx4 a[84:87], v216, s[48:51], s71 offen offset:1024 sc1
    v_mfma_f32_16x16x32_bf16 v[24:27], a[140:143], a[40:43], v[24:27]
    ds_read_b64_tr_b16 a[128:129], v254 offset:57344
    ds_read_b64_tr_b16 a[130:131], v254 offset:58368
    v_mfma_f32_16x16x32_bf16 v[56:59], a[140:143], a[44:47], v[56:59]
    buffer_load_dwordx4 a[88:91], v216, s[48:51], s71 offen offset:2048 sc1
    v_mfma_f32_16x16x32_bf16 v[56:59], a[136:139], a[36:39], v[56:59]
    ds_read_b64_tr_b16 a[132:133], v254 offset:61440
    ds_read_b64_tr_b16 a[134:135], v254 offset:62464
    s_waitcnt lgkmcnt(8)
    v_mfma_f32_16x16x32_bf16 v[12:15], a[144:147], a[32:35], v[12:15]
    buffer_load_dwordx4 a[92:95], v216, s[48:51], s71 offen offset:3072 sc1
    v_mfma_f32_16x16x32_bf16 v[12:15], a[148:151], a[40:43], v[12:15]
    ds_read_b64_tr_b16 a[136:137], v253 offset:49152
    ds_read_b64_tr_b16 a[138:139], v253 offset:50176
    v_mfma_f32_16x16x32_bf16 v[44:47], a[148:151], a[44:47], v[44:47]
    ds_read_b64_tr_b16 a[140:141], v253 offset:53248
    s_mov_b32 s71, 24576
    v_mfma_f32_16x16x32_bf16 v[44:47], a[144:147], a[36:39], v[44:47]
    ds_read_b64_tr_b16 a[142:143], v253 offset:54272
    v_mfma_f32_16x16x32_bf16 v[28:31], a[152:155], a[32:35], v[28:31]
    buffer_load_dwordx4 a[96:99], v216, s[48:51], s71 offen sc1
    v_mfma_f32_16x16x32_bf16 v[28:31], a[156:159], a[40:43], v[28:31]
    ds_read_b64_tr_b16 a[144:145], v253 offset:57344
    ds_read_b64_tr_b16 a[146:147], v253 offset:58368
    v_mfma_f32_16x16x32_bf16 v[60:63], a[156:159], a[44:47], v[60:63]
    buffer_load_dwordx4 a[100:103], v216, s[48:51], s71 offen offset:1024 sc1
    v_mfma_f32_16x16x32_bf16 v[60:63], a[152:155], a[36:39], v[60:63]
    ds_read_b64_tr_b16 a[148:149], v253 offset:61440
    ds_read_b64_tr_b16 a[150:151], v253 offset:62464
    s_waitcnt lgkmcnt(8)
    s_waitcnt vmcnt(20)
    v_mfma_f32_16x16x32_bf16 v[0:3], a[160:163], a[48:51], v[0:3]
    buffer_load_dwordx4 a[104:107], v216, s[48:51], s71 offen offset:2048 sc1
    s_waitcnt vmcnt(17)
    v_mfma_f32_16x16x32_bf16 v[0:3], a[164:167], a[56:59], v[0:3]
    ds_read_b64_tr_b16 a[152:153], v233 offset:49152
    ds_read_b64_tr_b16 a[154:155], v233 offset:50176
    s_waitcnt vmcnt(15)
    v_mfma_f32_16x16x32_bf16 v[32:35], a[164:167], a[60:63], v[32:35]
    buffer_load_dwordx4 a[108:111], v216, s[48:51], s71 offen offset:3072 sc1
    v_mfma_f32_16x16x32_bf16 v[32:35], a[160:163], a[52:55], v[32:35]
    ds_read_b64_tr_b16 a[156:157], v233 offset:53248
    ds_read_b64_tr_b16 a[158:159], v233 offset:54272
    s_mov_b32 s71, 28672
    v_mfma_f32_16x16x32_bf16 v[16:19], a[128:131], a[48:51], v[16:19]
    buffer_load_dwordx4 a[112:115], v216, s[48:51], s71 offen sc1
    v_mfma_f32_16x16x32_bf16 v[16:19], a[132:135], a[56:59], v[16:19]
    ds_read_b64_tr_b16 a[160:161], v233 offset:57344
    ds_read_b64_tr_b16 a[162:163], v233 offset:58368
    v_mfma_f32_16x16x32_bf16 v[48:51], a[132:135], a[60:63], v[48:51]
    buffer_load_dwordx4 a[116:119], v216, s[48:51], s71 offen offset:1024 sc1
    v_mfma_f32_16x16x32_bf16 v[48:51], a[128:131], a[52:55], v[48:51]
    ds_read_b64_tr_b16 a[164:165], v233 offset:61440
    ds_read_b64_tr_b16 a[166:167], v233 offset:62464
    s_waitcnt lgkmcnt(8)
    v_mfma_f32_16x16x32_bf16 v[4:7], a[136:139], a[48:51], v[4:7]
    buffer_load_dwordx4 a[120:123], v216, s[48:51], s71 offen offset:2048 sc1
    v_mfma_f32_16x16x32_bf16 v[4:7], a[140:143], a[56:59], v[4:7]
    ds_read_b64_tr_b16 a[128:129], v246 offset:49152
    ds_read_b64_tr_b16 a[130:131], v246 offset:50176
    v_mfma_f32_16x16x32_bf16 v[36:39], a[140:143], a[60:63], v[36:39]
    buffer_load_dwordx4 a[124:127], v216, s[48:51], s71 offen offset:3072 sc1
    v_mfma_f32_16x16x32_bf16 v[36:39], a[136:139], a[52:55], v[36:39]
    ds_read_b64_tr_b16 a[132:133], v246 offset:53248
    ds_read_b64_tr_b16 a[134:135], v246 offset:54272
    v_mfma_f32_16x16x32_bf16 v[20:23], a[144:147], a[48:51], v[20:23]
    s_waitcnt vmcnt(12)
    v_cmp_gt_u32 vcc, s43, v242
    s_cbranch_vccnz L_C_p4_slow
L_C_p4_ok:
    v_mfma_f32_16x16x32_bf16 v[20:23], a[148:151], a[56:59], v[20:23]
    ds_read_b64_tr_b16 a[136:137], v246 offset:57344
    ds_read_b64_tr_b16 a[138:139], v246 offset:58368
    v_mfma_f32_16x16x32_bf16 v[52:55], a[148:151], a[60:63], v[52:55]
    ds_read_b64_tr_b16 a[140:141], v246 offset:61440
    v_mfma_f32_16x16x32_bf16 v[52:55], a[144:147], a[52:55], v[52:55]
    ds_read_b64_tr_b16 a[142:143], v246 offset:62464
    s_barrier
    s_waitcnt lgkmcnt(8)
    v_mfma_f32_16x16x32_bf16 v[8:11], a[152:155], a[48:51], v[8:11]
    v_add_u32 v254, 65536, v254
    ds_read_b64_tr_b16 a[144:145], v254
    s_add_u32 m0, s62, 16384
    v_mfma_f32_16x16x32_bf16 v[8:11], a[156:159], a[56:59], v[8:11]
    ds_read_b64_tr_b16 a[146:147], v254 offset:1024
    v_mfma_f32_16x16x32_bf16 v[40:43], a[156:159], a[60:63], v[40:43]
    ds_read_b64_tr_b16 a[148:149], v254 offset:4096
    v_mfma_f32_16x16x32_bf16 v[40:43], a[152:155], a[52:55], v[40:43]
    ds_read_b64_tr_b16 a[150:151], v254 offset:5120
    v_mfma_f32_16x16x32_bf16 v[24:27], a[160:163], a[48:51], v[24:27]
    buffer_load_dwordx4 v239, s[48:51], 0 offen sc1 lds
    v_mfma_f32_16x16x32_bf16 v[24:27], a[164:167], a[56:59], v[24:27]
    ds_read_b64_tr_b16 a[152:153], v254 offset:8192
    ds_read_b64_tr_b16 a[154:155], v254 offset:9216
    v_mfma_f32_16x16x32_bf16 v[56:59], a[164:167], a[60:63], v[56:59]
    ds_read_b64_tr_b16 a[156:157], v254 offset:12288
    v_mfma_f32_16x16x32_bf16 v[56:59], a[160:163], a[52:55], v[56:59]
    ds_read_b64_tr_b16 a[158:159], v254 offset:13312
    s_waitcnt lgkmcnt(8)
    v_mfma_f32_16x16x32_bf16 v[12:15], a[128:131], a[48:51], v[12:15]
    v_add_u32 v253, 65536, v253
    ds_read_b64_tr_b16 a[160:161], v253
    v_mfma_f32_16x16x32_bf16 v[12:15], a[132:135], a[56:59], v[12:15]
    ds_read_b64_tr_b16 a[162:163], v253 offset:1024
    v_mfma_f32_16x16x32_bf16 v[44:47], a[132:135], a[60:63], v[44:47]
    ds_read_b64_tr_b16 a[164:165], v253 offset:4096
    v_mfma_f32_16x16x32_bf16 v[44:47], a[128:131], a[52:55], v[44:47]
    ds_read_b64_tr_b16 a[166:167], v253 offset:5120
    v_mfma_f32_16x16x32_bf16 v[28:31], a[136:139], a[48:51], v[28:31]
    buffer_load_dwordx4 v239, s[48:51], 0 offen offset:1024 sc1 lds
    v_mfma_f32_16x16x32_bf16 v[28:31], a[140:143], a[56:59], v[28:31]
    ds_read_b64_tr_b16 a[128:129], v253 offset:8192
    ds_read_b64_tr_b16 a[130:131], v253 offset:9216
    v_mfma_f32_16x16x32_bf16 v[60:63], a[140:143], a[60:63], v[60:63]
    ds_read_b64_tr_b16 a[132:133], v253 offset:12288
    v_mfma_f32_16x16x32_bf16 v[60:63], a[136:139], a[52:55], v[60:63]
    ds_read_b64_tr_b16 a[134:135], v253 offset:13312
    s_waitcnt lgkmcnt(8)
    v_mfma_f32_16x16x32_bf16 v[0:3], a[144:147], a[64:67], v[0:3]
    v_add_u32 v233, 65536, v233
    ds_read_b64_tr_b16 a[136:137], v233
    v_mfma_f32_16x16x32_bf16 v[0:3], a[148:151], a[72:75], v[0:3]
    ds_read_b64_tr_b16 a[138:139], v233 offset:1024
    v_mfma_f32_16x16x32_bf16 v[32:35], a[148:151], a[76:79], v[32:35]
    buffer_load_dwordx4 v239, s[48:51], 0 offen offset:2048 sc1 lds
    v_mfma_f32_16x16x32_bf16 v[32:35], a[144:147], a[68:71], v[32:35]
    ds_read_b64_tr_b16 a[140:141], v233 offset:4096
    ds_read_b64_tr_b16 a[142:143], v233 offset:5120
    v_mfma_f32_16x16x32_bf16 v[16:19], a[152:155], a[64:67], v[16:19]
    ds_read_b64_tr_b16 a[144:145], v233 offset:8192
    v_mfma_f32_16x16x32_bf16 v[16:19], a[156:159], a[72:75], v[16:19]
    ds_read_b64_tr_b16 a[146:147], v233 offset:9216
    v_mfma_f32_16x16x32_bf16 v[48:51], a[156:159], a[76:79], v[48:51]
    ds_read_b64_tr_b16 a[148:149], v233 offset:12288
    v_mfma_f32_16x16x32_bf16 v[48:51], a[152:155], a[68:71], v[48:51]
    ds_read_b64_tr_b16 a[150:151], v233 offset:13312
    s_waitcnt lgkmcnt(8)
    v_mfma_f32_16x16x32_bf16 v[4:7], a[160:163], a[64:67], v[4:7]
    v_add_u32 v246, 65536, v246
    ds_read_b64_tr_b16 a[152:153], v246
    v_mfma_f32_16x16x32_bf16 v[4:7], a[164:167], a[72:75], v[4:7]
    ds_read_b64_tr_b16 a[154:155], v246 offset:1024
    v_mfma_f32_16x16x32_bf16 v[36:39], a[164:167], a[76:79], v[36:39]
    buffer_load_dwordx4 v239, s[48:51], 0 offen offset:3072 sc1 lds
    v_mfma_f32_16x16x32_bf16 v[36:39], a[160:163], a[68:71], v[36:39]
    ds_read_b64_tr_b16 a[156:157], v246 offset:4096
    ds_read_b64_tr_b16 a[158:159], v246 offset:5120
    v_mfma_f32_16x16x32_bf16 v[20:23], a[128:131], a[64:67], v[20:23]
    ds_read_b64_tr_b16 a[160:161], v246 offset:8192
    v_mfma_f32_16x16x32_bf16 v[20:23], a[132:135], a[72:75], v[20:23]
    ds_read_b64_tr_b16 a[162:163], v246 offset:9216
    v_mfma_f32_16x16x32_bf16 v[52:55], a[132:135], a[76:79], v[52:55]
    ds_read_b64_tr_b16 a[164:165], v246 offset:12288
    v_mfma_f32_16x16x32_bf16 v[52:55], a[128:131], a[68:71], v[52:55]
    ds_read_b64_tr_b16 a[166:167], v246 offset:13312
    s_barrier
    s_waitcnt lgkmcnt(8)
    v_mfma_f32_16x16x32_bf16 v[8:11], a[136:139], a[64:67], v[8:11]
    buffer_load_dword v242, v235, s[48:51], 0 offen sc1
    v_mfma_f32_16x16x32_bf16 v[8:11], a[140:143], a[72:75], v[8:11]
    ds_read_b64_tr_b16 a[128:129], v254 offset:16384
    ds_read_b64_tr_b16 a[130:131], v254 offset:17408
    v_mfma_f32_16x16x32_bf16 v[40:43], a[140:143], a[76:79], v[40:43]
    ds_read_b64_tr_b16 a[132:133], v254 offset:20480
    s_add_u32 m0, s62, 32768
    v_mfma_f32_16x16x32_bf16 v[40:43], a[136:139], a[68:71], v[40:43]
    ds_read_b64_tr_b16 a[134:135], v254 offset:21504
    v_add_u32 v239, 16384, v239
    v_mfma_f32_16x16x32_bf16 v[24:27], a[144:147], a[64:67], v[24:27]
    ds_read_b64_tr_b16 a[136:137], v254 offset:24576
    v_mfma_f32_16x16x32_bf16 v[24:27], a[148:151], a[72:75], v[24:27]
    ds_read_b64_tr_b16 a[138:139], v254 offset:25600
    v_mfma_f32_16x16x32_bf16 v[56:59], a[148:151], a[76:79], v[56:59]
    buffer_load_dwordx4 v239, s[48:51], 0 offen sc1 lds
    v_mfma_f32_16x16x32_bf16 v[56:59], a[144:147], a[68:71], v[56:59]
    ds_read_b64_tr_b16 a[140:141], v254 offset:28672
    ds_read_b64_tr_b16 a[142:143], v254 offset:29696
    s_waitcnt lgkmcnt(8)
    v_mfma_f32_16x16x32_bf16 v[12:15], a[152:155], a[64:67], v[12:15]
    ds_read_b64_tr_b16 a[144:145], v253 offset:16384
    v_mfma_f32_16x16x32_bf16 v[12:15], a[156:159], a[72:75], v[12:15]
    ds_read_b64_tr_b16 a[146:147], v253 offset:17408
    v_mfma_f32_16x16x32_bf16 v[44:47], a[156:159], a[76:79], v[44:47]
    buffer_load_dwordx4 v239, s[48:51], 0 offen offset:1024 sc1 lds
    v_mfma_f32_16x16x32_bf16 v[44:47], a[152:155], a[68:71], v[44:47]
    ds_read_b64_tr_b16 a[148:149], v253 offset:20480
    ds_read_b64_tr_b16 a[150:151], v253 offset:21504
    v_mfma_f32_16x16x32_bf16 v[28:31], a[160:163], a[64:67], v[28:31]
    ds_read_b64_tr_b16 a[152:153], v253 offset:24576
    v_mfma_f32_16x16x32_bf16 v[28:31], a[164:167], a[72:75], v[28:31]
    ds_read_b64_tr_b16 a[154:155], v253 offset:25600
    v_mfma_f32_16x16x32_bf16 v[60:63], a[164:167], a[76:79], v[60:63]
    ds_read_b64_tr_b16 a[156:157], v253 offset:28672
    v_mfma_f32_16x16x32_bf16 v[60:63], a[160:163], a[68:71], v[60:63]
    ds_read_b64_tr_b16 a[158:159], v253 offset:29696
    s_waitcnt lgkmcnt(8)
    s_waitcnt vmcnt(18)
    v_mfma_f32_16x16x32_bf16 v[0:3], a[128:131], a[80:83], v[0:3]
    buffer_load_dwordx4 v239, s[48:51], 0 offen offset:2048 sc1 lds
    s_waitcnt vmcnt(17)
    v_mfma_f32_16x16x32_bf16 v[0:3], a[132:135], a[88:91], v[0:3]
    ds_read_b64_tr_b16 a[160:161], v233 offset:16384
    ds_read_b64_tr_b16 a[162:163], v233 offset:17408
    s_waitcnt vmcnt(16)
    v_mfma_f32_16x16x32_bf16 v[32:35], a[132:135], a[92:95], v[32:35]
    ds_read_b64_tr_b16 a[164:165], v233 offset:20480
    v_mfma_f32_16x16x32_bf16 v[32:35], a[128:131], a[84:87], v[32:35]
    ds_read_b64_tr_b16 a[166:167], v233 offset:21504
    v_mfma_f32_16x16x32_bf16 v[16:19], a[136:139], a[80:83], v[16:19]
    buffer_load_dwordx4 v239, s[48:51], 0 offen offset:3072 sc1 lds
    v_mfma_f32_16x16x32_bf16 v[16:19], a[140:143], a[88:91], v[16:19]
    ds_read_b64_tr_b16 a[128:129], v233 offset:24576
    ds_read_b64_tr_b16 a[130:131], v233 offset:25600
    v_mfma_f32_16x16x32_bf16 v[48:51], a[140:143], a[92:95], v[48:51]
    ds_read_b64_tr_b16 a[132:133], v233 offset:28672
    v_mfma_f32_16x16x32_bf16 v[48:51], a[136:139], a[84:87], v[48:51]
    ds_read_b64_tr_b16 a[134:135], v233 offset:29696
    s_waitcnt lgkmcnt(8)
    v_mfma_f32_16x16x32_bf16 v[4:7], a[144:147], a[80:83], v[4:7]
    buffer_load_dword a168, v219, s[32:35], 0 offen
    v_mfma_f32_16x16x32_bf16 v[4:7], a[148:151], a[88:91], v[4:7]
    ds_read_b64_tr_b16 a[136:137], v246 offset:16384
    ds_read_b64_tr_b16 a[138:139], v246 offset:17408
    v_mfma_f32_16x16x32_bf16 v[36:39], a[148:151], a[92:95], v[36:39]
    ds_read_b64_tr_b16 a[140:141], v246 offset:20480
    v_mfma_f32_16x16x32_bf16 v[36:39], a[144:147], a[84:87], v[36:39]
    ds_read_b64_tr_b16 a[142:143], v246 offset:21504
    v_mfma_f32_16x16x32_bf16 v[20:23], a[152:155], a[80:83], v[20:23]
    s_waitcnt vmcnt(5)
    v_cmp_gt_u32 vcc, s43, v242
    s_cbranch_vccnz L_C_p3_slow
L_C_p3_ok:
    v_mfma_f32_16x16x32_bf16 v[20:23], a[156:159], a[88:91], v[20:23]
    ds_read_b64_tr_b16 a[144:145], v246 offset:24576
    ds_read_b64_tr_b16 a[146:147], v246 offset:25600
    v_mfma_f32_16x16x32_bf16 v[52:55], a[156:159], a[92:95], v[52:55]
    ds_read_b64_tr_b16 a[148:149], v246 offset:28672
    v_mfma_f32_16x16x32_bf16 v[52:55], a[152:155], a[84:87], v[52:55]
    ds_read_b64_tr_b16 a[150:151], v246 offset:29696
    s_barrier
    s_waitcnt lgkmcnt(8)
    v_mfma_f32_16x16x32_bf16 v[8:11], a[160:163], a[80:83], v[8:11]
    ds_read_b64_tr_b16 a[152:153], v254 offset:32768
    s_add_u32 m0, s62, 49152
    v_mfma_f32_16x16x32_bf16 v[8:11], a[164:167], a[88:91], v[8:11]
    ds_read_b64_tr_b16 a[154:155], v254 offset:33792
    v_add_u32 v239, 16384, v239
    v_mfma_f32_16x16x32_bf16 v[40:43], a[164:167], a[92:95], v[40:43]
    buffer_load_dwordx4 v239, s[48:51], 0 offen sc1 lds
    v_mfma_f32_16x16x32_bf16 v[40:43], a[160:163], a[84:87], v[40:43]
    ds_read_b64_tr_b16 a[156:157], v254 offset:36864
    ds_read_b64_tr_b16 a[158:159], v254 offset:37888
    v_mfma_f32_16x16x32_bf16 v[24:27], a[128:131], a[80:83], v[24:27]
    ds_read_b64_tr_b16 a[160:161], v254 offset:40960
    v_mfma_f32_16x16x32_bf16 v[24:27], a[132:135], a[88:91], v[24:27]
    ds_read_b64_tr_b16 a[162:163], v254 offset:41984
    v_mfma_f32_16x16x32_bf16 v[56:59], a[132:135], a[92:95], v[56:59]
    buffer_load_dwordx4 v239, s[48:51], 0 offen offset:1024 sc1 lds
    v_mfma_f32_16x16x32_bf16 v[56:59], a[128:131], a[84:87], v[56:59]
    ds_read_b64_tr_b16 a[164:165], v254 offset:45056
    ds_read_b64_tr_b16 a[166:167], v254 offset:46080
    s_waitcnt lgkmcnt(8)
    v_mfma_f32_16x16x32_bf16 v[12:15], a[136:139], a[80:83], v[12:15]
    ds_read_b64_tr_b16 a[128:129], v253 offset:32768
    v_mfma_f32_16x16x32_bf16 v[12:15], a[140:143], a[88:91], v[12:15]
    ds_read_b64_tr_b16 a[130:131], v253 offset:33792
    v_mfma_f32_16x16x32_bf16 v[44:47], a[140:143], a[92:95], v[44:47]
    buffer_load_dwordx4 v239, s[48:51], 0 offen offset:2048 sc1 lds
    v_mfma_f32_16x16x32_bf16 v[44:47], a[136:139], a[84:87], v[44:47]
    ds_read_b64_tr_b16 a[132:133], v253 offset:36864
    ds_read_b64_tr_b16 a[134:135], v253 offset:37888
    v_mfma_f32_16x16x32_bf16 v[28:31], a[144:147], a[80:83], v[28:31]
    buffer_load_dwordx4 v239, s[48:51], 0 offen offset:3072 sc1 lds
    v_mfma_f32_16x16x32_bf16 v[28:31], a[148:151], a[88:91], v[28:31]
    ds_read_b64_tr_b16 a[136:137], v253 offset:40960
    ds_read_b64_tr_b16 a[138:139], v253 offset:41984
    v_mfma_f32_16x16x32_bf16 v[60:63], a[148:151], a[92:95], v[60:63]
    ds_read_b64_tr_b16 a[140:141], v253 offset:45056
    s_add_u32 s42, s40, 0
    v_mfma_f32_16x16x32_bf16 v[60:63], a[144:147], a[84:87], v[60:63]
    ds_read_b64_tr_b16 a[142:143], v253 offset:46080
    s_waitcnt lgkmcnt(8)
    v_mfma_f32_16x16x32_bf16 v[0:3], a[152:155], a[96:99], v[0:3]
    ds_read_b64_tr_b16 a[144:145], v233 offset:32768
    v_mfma_f32_16x16x32_bf16 v[0:3], a[156:159], a[104:107], v[0:3]
    ds_read_b64_tr_b16 a[146:147], v233 offset:33792
    v_mfma_f32_16x16x32_bf16 v[32:35], a[156:159], a[108:111], v[32:35]
    buffer_load_dwordx4 a[176:179], v243, s[48:51], s42 offen sc1
    v_mfma_f32_16x16x32_bf16 v[32:35], a[152:155], a[100:103], v[32:35]
    ds_read_b64_tr_b16 a[148:149], v233 offset:36864
    ds_read_b64_tr_b16 a[150:151], v233 offset:37888
    v_mfma_f32_16x16x32_bf16 v[16:19], a[160:163], a[96:99], v[16:19]
    buffer_load_dwordx4 a[180:183], v240, s[48:51], s42 offen offset:1024 sc1
    v_mfma_f32_16x16x32_bf16 v[16:19], a[164:167], a[104:107], v[16:19]
    ds_read_b64_tr_b16 a[152:153], v233 offset:40960
    ds_read_b64_tr_b16 a[154:155], v233 offset:41984
    v_mfma_f32_16x16x32_bf16 v[48:51], a[164:167], a[108:111], v[48:51]
    ds_read_b64_tr_b16 a[156:157], v233 offset:45056
    v_mfma_f32_16x16x32_bf16 v[48:51], a[160:163], a[100:103], v[48:51]
    ds_read_b64_tr_b16 a[158:159], v233 offset:46080
    s_waitcnt lgkmcnt(8)
    v_mfma_f32_16x16x32_bf16 v[4:7], a[128:131], a[96:99], v[4:7]
    buffer_load_dwordx4 a[184:187], v243, s[48:51], s42 offen offset:2048 sc1
    v_mfma_f32_16x16x32_bf16 v[4:7], a[132:135], a[104:107], v[4:7]
    ds_read_b64_tr_b16 a[160:161], v246 offset:32768
    ds_read_b64_tr_b16 a[162:163], v246 offset:33792
    v_mfma_f32_16x16x32_bf16 v[36:39], a[132:135], a[108:111], v[36:39]
    ds_read_b64_tr_b16 a[164:165], v246 offset:36864
    v_mfma_f32_16x16x32_bf16 v[36:39], a[128:131], a[100:103], v[36:39]
    ds_read_b64_tr_b16 a[166:167], v246 offset:37888
    v_mfma_f32_16x16x32_bf16 v[20:23], a[136:139], a[96:99], v[20:23]
    buffer_load_dwordx4 a[188:191], v240, s[48:51], s42 offen offset:3072 sc1
    v_mfma_f32_16x16x32_bf16 v[20:23], a[140:143], a[104:107], v[20:23]
    ds_read_b64_tr_b16 a[128:129], v246 offset:40960
    ds_read_b64_tr_b16 a[130:131], v246 offset:41984
    v_mfma_f32_16x16x32_bf16 v[52:55], a[140:143], a[108:111], v[52:55]
    ds_read_b64_tr_b16 a[132:133], v246 offset:45056
    v_mfma_f32_16x16x32_bf16 v[52:55], a[136:139], a[100:103], v[52:55]
    ds_read_b64_tr_b16 a[134:135], v246 offset:46080
    s_barrier
    s_waitcnt lgkmcnt(8)
    v_mfma_f32_16x16x32_bf16 v[8:11], a[144:147], a[96:99], v[8:11]
    v_subrev_u32 v254, 65536, v254
    ds_read_b64_tr_b16 a[136:137], v254
    s_add_u32 m0, s62, 65536
    v_mfma_f32_16x16x32_bf16 v[8:11], a[148:151], a[104:107], v[8:11]
    ds_read_b64_tr_b16 a[138:139], v254 offset:1024
    v_add_u32 v239, 16384, v239
    v_mfma_f32_16x16x32_bf16 v[40:43], a[148:151], a[108:111], v[40:43]
    buffer_load_dwordx4 v239, s[48:51], 0 offen sc1 lds
    v_mfma_f32_16x16x32_bf16 v[40:43], a[144:147], a[100:103], v[40:43]
    ds_read_b64_tr_b16 a[140:141], v254 offset:4096
    ds_read_b64_tr_b16 a[142:143], v254 offset:5120
    v_mfma_f32_16x16x32_bf16 v[24:27], a[152:155], a[96:99], v[24:27]
    ds_read_b64_tr_b16 a[144:145], v254 offset:8192
    v_mfma_f32_16x16x32_bf16 v[24:27], a[156:159], a[104:107], v[24:27]
    ds_read_b64_tr_b16 a[146:147], v254 offset:9216
    v_mfma_f32_16x16x32_bf16 v[56:59], a[156:159], a[108:111], v[56:59]
    buffer_load_dwordx4 v239, s[48:51], 0 offen offset:1024 sc1 lds
    v_mfma_f32_16x16x32_bf16 v[56:59], a[152:155], a[100:103], v[56:59]
    ds_read_b64_tr_b16 a[148:149], v254 offset:12288
    ds_read_b64_tr_b16 a[150:151], v254 offset:13312
    s_waitcnt lgkmcnt(8)
    v_mfma_f32_16x16x32_bf16 v[12:15], a[160:163], a[96:99], v[12:15]
    v_subrev_u32 v253, 65536, v253
    ds_read_b64_tr_b16 a[152:153], v253
    v_mfma_f32_16x16x32_bf16 v[12:15], a[164:167], a[104:107], v[12:15]
    ds_read_b64_tr_b16 a[154:155], v253 offset:1024
    v_mfma_f32_16x16x32_bf16 v[44:47], a[164:167], a[108:111], v[44:47]
    buffer_load_dwordx4 v239, s[48:51], 0 offen offset:2048 sc1 lds
    v_mfma_f32_16x16x32_bf16 v[44:47], a[160:163], a[100:103], v[44:47]
    ds_read_b64_tr_b16 a[156:157], v253 offset:4096
    ds_read_b64_tr_b16 a[158:159], v253 offset:5120
    v_mfma_f32_16x16x32_bf16 v[28:31], a[128:131], a[96:99], v[28:31]
    buffer_load_dwordx4 v239, s[48:51], 0 offen offset:3072 sc1 lds
    v_mfma_f32_16x16x32_bf16 v[28:31], a[132:135], a[104:107], v[28:31]
    ds_read_b64_tr_b16 a[160:161], v253 offset:8192
    ds_read_b64_tr_b16 a[162:163], v253 offset:9216
    v_mfma_f32_16x16x32_bf16 v[60:63], a[132:135], a[108:111], v[60:63]
    ds_read_b64_tr_b16 a[164:165], v253 offset:12288
    s_add_u32 s42, s40, 4096
    v_mfma_f32_16x16x32_bf16 v[60:63], a[128:131], a[100:103], v[60:63]
    ds_read_b64_tr_b16 a[166:167], v253 offset:13312
    s_waitcnt lgkmcnt(8)
    v_mfma_f32_16x16x32_bf16 v[0:3], a[136:139], a[112:115], v[0:3]
    v_subrev_u32 v233, 65536, v233
    ds_read_b64_tr_b16 a[128:129], v233
    v_mfma_f32_16x16x32_bf16 v[0:3], a[140:143], a[120:123], v[0:3]
    ds_read_b64_tr_b16 a[130:131], v233 offset:1024
    v_mfma_f32_16x16x32_bf16 v[32:35], a[140:143], a[124:127], v[32:35]
    buffer_load_dwordx4 a[192:195], v243, s[48:51], s42 offen sc1
    v_mfma_f32_16x16x32_bf16 v[32:35], a[136:139], a[116:119], v[32:35]
    ds_read_b64_tr_b16 a[132:133], v233 offset:4096
    ds_read_b64_tr_b16 a[134:135], v233 offset:5120
    v_mfma_f32_16x16x32_bf16 v[16:19], a[144:147], a[112:115], v[16:19]
    buffer_load_dwordx4 a[196:199], v240, s[48:51], s42 offen offset:1024 sc1
    v_mfma_f32_16x16x32_bf16 v[16:19], a[148:151], a[120:123], v[16:19]
    ds_read_b64_tr_b16 a[136:137], v233 offset:8192
    ds_read_b64_tr_b16 a[138:139], v233 offset:9216
    v_mfma_f32_16x16x32_bf16 v[48:51], a[148:151], a[124:127], v[48:51]
    ds_read_b64_tr_b16 a[140:141], v233 offset:12288
    v_mfma_f32_16x16x32_bf16 v[48:51], a[144:147], a[116:119], v[48:51]
    ds_read_b64_tr_b16 a[142:143], v233 offset:13312
    s_waitcnt lgkmcnt(8)
    v_mfma_f32_16x16x32_bf16 v[4:7], a[152:155], a[112:115], v[4:7]
    v_subrev_u32 v246, 65536, v246
    ds_read_b64_tr_b16 a[144:145], v246
    buffer_load_dwordx4 a[200:203], v243, s[48:51], s42 offen offset:2048 sc1
    v_mfma_f32_16x16x32_bf16 v[4:7], a[156:159], a[120:123], v[4:7]
    ds_read_b64_tr_b16 a[146:147], v246 offset:1024
    v_mfma_f32_16x16x32_bf16 v[36:39], a[156:159], a[124:127], v[36:39]
    ds_read_b64_tr_b16 a[148:149], v246 offset:4096
    v_mfma_f32_16x16x32_bf16 v[36:39], a[152:155], a[116:119], v[36:39]
    ds_read_b64_tr_b16 a[150:151], v246 offset:5120
    v_mfma_f32_16x16x32_bf16 v[20:23], a[160:163], a[112:115], v[20:23]
    buffer_load_dwordx4 a[204:207], v240, s[48:51], s42 offen offset:3072 sc1
    v_mfma_f32_16x16x32_bf16 v[20:23], a[164:167], a[120:123], v[20:23]
    ds_read_b64_tr_b16 a[152:153], v246 offset:8192
    ds_read_b64_tr_b16 a[154:155], v246 offset:9216
    v_mfma_f32_16x16x32_bf16 v[52:55], a[164:167], a[124:127], v[52:55]
    ds_read_b64_tr_b16 a[156:157], v246 offset:12288
    v_mfma_f32_16x16x32_bf16 v[52:55], a[160:163], a[116:119], v[52:55]
    ds_read_b64_tr_b16 a[158:159], v246 offset:13312
    s_waitcnt vmcnt(17)
    s_barrier
    s_waitcnt lgkmcnt(8)
    v_mfma_f32_16x16x32_bf16 v[8:11], a[128:131], a[112:115], v[8:11]
    ds_read_b64_tr_b16 a[160:161], v249 offset:16384
    s_add_u32 m0, s62, 81920
    v_mfma_f32_16x16x32_bf16 v[8:11], a[132:135], a[120:123], v[8:11]
    ds_read_b64_tr_b16 a[162:163], v249 offset:16896
    v_mfma_f32_16x16x32_bf16 v[40:43], a[132:135], a[124:127], v[40:43]
    buffer_load_dwordx4 v238, s[32:35], 0 offen lds
    v_mfma_f32_16x16x32_bf16 v[40:43], a[128:131], a[116:119], v[40:43]
    ds_read_b64_tr_b16 a[164:165], v249 offset:18432
    ds_read_b64_tr_b16 a[166:167], v249 offset:18944
    v_mfma_f32_16x16x32_bf16 v[24:27], a[136:139], a[112:115], v[24:27]
    ds_read_b64_tr_b16 a[128:129], v249 offset:24576
    v_mfma_f32_16x16x32_bf16 v[24:27], a[140:143], a[120:123], v[24:27]
    ds_read_b64_tr_b16 a[130:131], v249 offset:25088
    v_mfma_f32_16x16x32_bf16 v[56:59], a[140:143], a[124:127], v[56:59]
    buffer_load_dwordx4 v238, s[32:35], s11 offen offset:1024 lds
    v_mfma_f32_16x16x32_bf16 v[56:59], a[136:139], a[116:119], v[56:59]
    ds_read_b64_tr_b16 a[132:133], v249 offset:26624
    ds_read_b64_tr_b16 a[134:135], v249 offset:27136
    s_waitcnt lgkmcnt(8)
    v_mfma_f32_16x16x32_bf16 v[12:15], a[144:147], a[112:115], v[12:15]
    buffer_load_dwordx4 v238, s[32:35], s12 offen offset:2048 lds
    v_mfma_f32_16x16x32_bf16 v[12:15], a[148:151], a[120:123], v[12:15]
    ds_read_b64_tr_b16 a[136:137], v247 offset:16384
    ds_read_b64_tr_b16 a[138:139], v247 offset:16896
    v_mfma_f32_16x16x32_bf16 v[44:47], a[148:151], a[124:127], v[44:47]
    ds_read_b64_tr_b16 a[140:141], v247 offset:18432
    v_mfma_f32_16x16x32_bf16 v[44:47], a[144:147], a[116:119], v[44:47]
    ds_read_b64_tr_b16 a[142:143], v247 offset:18944
    v_mfma_f32_16x16x32_bf16 v[28:31], a[152:155], a[112:115], v[28:31]
    buffer_load_dwordx4 v238, s[32:35], s13 offen offset:3072 lds
    v_mfma_f32_16x16x32_bf16 v[28:31], a[156:159], a[120:123], v[28:31]
    ds_read_b64_tr_b16 a[144:145], v247 offset:24576
    ds_read_b64_tr_b16 a[146:147], v247 offset:25088
    v_mfma_f32_16x16x32_bf16 v[60:63], a[156:159], a[124:127], v[60:63]
    ds_read_b64_tr_b16 a[148:149], v247 offset:26624
    s_add_u32 s42, s40, 8192
    v_mfma_f32_16x16x32_bf16 v[60:63], a[152:155], a[116:119], v[60:63]
    ds_read_b64_tr_b16 a[150:151], v247 offset:27136
    s_waitcnt lgkmcnt(8)
    v_mfma_f32_16x16x32_bf16 v[64:67], a[160:163], a[0:3], 0
    buffer_load_dwordx4 a[208:211], v243, s[48:51], s42 offen sc1
    v_mfma_f32_16x16x32_bf16 v[64:67], a[164:167], a[8:11], v[64:67]
    ds_read_b64_tr_b16 a[152:153], v249 offset:20480
    ds_read_b64_tr_b16 a[154:155], v249 offset:20992
    v_mfma_f32_16x16x32_bf16 v[72:75], a[164:167], a[12:15], 0
    ds_read_b64_tr_b16 a[156:157], v249 offset:22528
    v_mul_f32 v228, s17, v0
    v_mul_f32 v229, s17, v1
    v_mul_f32 v230, s17, v2
    v_mul_f32 v231, s17, v3
    v_mfma_f32_16x16x32_bf16 v[72:75], a[160:163], a[4:7], v[72:75]
    ds_read_b64_tr_b16 a[158:159], v249 offset:23040
    v_exp_f32 v228, v228
    v_mul_f32 v16, v0, v16
    v_mfma_f32_16x16x32_bf16 v[80:83], a[128:131], a[0:3], 0
    ds_read_b64_tr_b16 a[160:161], v249 offset:28672
    buffer_load_dwordx4 a[212:215], v240, s[48:51], s42 offen offset:1024 sc1
    v_mfma_f32_16x16x32_bf16 v[80:83], a[132:135], a[8:11], v[80:83]
    ds_read_b64_tr_b16 a[162:163], v249 offset:29184
    v_exp_f32 v229, v229
    v_mul_f32 v17, v1, v17
    v_mfma_f32_16x16x32_bf16 v[88:91], a[132:135], a[12:15], 0
    ds_read_b64_tr_b16 a[164:165], v249 offset:30720
    v_exp_f32 v230, v230
    v_mul_f32 v18, v2, v18
    v_mfma_f32_16x16x32_bf16 v[88:91], a[128:131], a[4:7], v[88:91]
    ds_read_b64_tr_b16 a[166:167], v249 offset:31232
    v_exp_f32 v231, v231
    v_mul_f32 v19, v3, v19
    v_add_f32 v228, 1.0, v228
    s_waitcnt lgkmcnt(8)
    v_mfma_f32_16x16x32_bf16 v[68:71], a[136:139], a[0:3], 0
    ds_read_b64_tr_b16 a[128:129], v247 offset:20480
    buffer_load_dwordx4 a[216:219], v243, s[48:51], s42 offen offset:2048 sc1
    v_mfma_f32_16x16x32_bf16 v[68:71], a[140:143], a[8:11], v[68:71]
    ds_read_b64_tr_b16 a[130:131], v247 offset:20992
    v_add_f32 v229, 1.0, v229
    v_add_f32 v230, 1.0, v230
    v_add_f32 v231, 1.0, v231
    v_mfma_f32_16x16x32_bf16 v[76:79], a[140:143], a[12:15], 0
    ds_read_b64_tr_b16 a[132:133], v247 offset:22528
    v_rcp_f32 v228, v228
    v_rcp_f32 v229, v229
    v_mfma_f32_16x16x32_bf16 v[76:79], a[136:139], a[4:7], v[76:79]
    ds_read_b64_tr_b16 a[134:135], v247 offset:23040
    v_rcp_f32 v230, v230
    v_rcp_f32 v231, v231
    v_mfma_f32_16x16x32_bf16 v[84:87], a[144:147], a[0:3], 0
    ds_read_b64_tr_b16 a[136:137], v247 offset:28672
    buffer_load_dwordx4 a[220:223], v240, s[48:51], s42 offen offset:3072 sc1
    v_mfma_f32_16x16x32_bf16 v[84:87], a[148:151], a[8:11], v[84:87]
    ds_read_b64_tr_b16 a[138:139], v247 offset:29184
    v_mul_f32 v16, v16, v228
    v_mul_f32 v17, v17, v229
    v_mul_f32 v18, v18, v230
    v_mfma_f32_16x16x32_bf16 v[92:95], a[148:151], a[12:15], 0
    ds_read_b64_tr_b16 a[140:141], v247 offset:30720
    v_mul_f32 v19, v19, v231
    v_cvt_pk_bf16_f32 v0, v16, v17
    v_cvt_pk_bf16_f32 v1, v18, v19
    v_mul_f32 v228, s17, v4
    v_mfma_f32_16x16x32_bf16 v[92:95], a[144:147], a[4:7], v[92:95]
    ds_read_b64_tr_b16 a[142:143], v247 offset:31232
    v_mul_f32 v229, s17, v5
    v_mul_f32 v230, s17, v6
    v_mul_f32 v231, s17, v7
    s_waitcnt lgkmcnt(8)
    v_mfma_f32_16x16x32_bf16 v[64:67], a[152:155], a[16:19], v[64:67]
    ds_read_b64_tr_b16 a[144:145], v249 offset:32768
    s_add_u32 m0, s62, 98304
    v_add_u32 v238, 229376, v238
    v_exp_f32 v228, v228
    v_mfma_f32_16x16x32_bf16 v[64:67], a[156:159], a[24:27], v[64:67]
    ds_read_b64_tr_b16 a[146:147], v249 offset:33280
    v_mul_f32 v20, v4, v20
    v_exp_f32 v229, v229
    v_mfma_f32_16x16x32_bf16 v[72:75], a[156:159], a[28:31], v[72:75]
    ds_read_b64_tr_b16 a[148:149], v249 offset:34816
    buffer_load_dwordx4 v238, s[32:35], 0 offen lds
    v_mfma_f32_16x16x32_bf16 v[72:75], a[152:155], a[20:23], v[72:75]
    ds_read_b64_tr_b16 a[150:151], v249 offset:35328
    v_mul_f32 v21, v5, v21
    v_exp_f32 v230, v230
    v_mfma_f32_16x16x32_bf16 v[80:83], a[160:163], a[16:19], v[80:83]
    ds_read_b64_tr_b16 a[152:153], v249 offset:40960
    v_mul_f32 v22, v6, v22
    v_exp_f32 v231, v231
    v_mul_f32 v23, v7, v23
    v_mfma_f32_16x16x32_bf16 v[80:83], a[164:167], a[24:27], v[80:83]
    ds_read_b64_tr_b16 a[154:155], v249 offset:41472
    v_add_f32 v228, 1.0, v228
    v_add_f32 v229, 1.0, v229
    v_add_f32 v230, 1.0, v230
    v_mfma_f32_16x16x32_bf16 v[88:91], a[164:167], a[28:31], v[88:91]
    ds_read_b64_tr_b16 a[156:157], v249 offset:43008
    buffer_load_dwordx4 v238, s[32:35], s11 offen offset:1024 lds
    v_mfma_f32_16x16x32_bf16 v[88:91], a[160:163], a[20:23], v[88:91]
    ds_read_b64_tr_b16 a[158:159], v249 offset:43520
    v_add_f32 v231, 1.0, v231
    v_rcp_f32 v228, v228
    s_waitcnt lgkmcnt(8)
    v_mfma_f32_16x16x32_bf16 v[68:71], a[128:131], a[16:19], v[68:71]
    ds_read_b64_tr_b16 a[160:161], v247 offset:32768
    v_rcp_f32 v229, v229
    v_rcp_f32 v230, v230
    v_mfma_f32_16x16x32_bf16 v[68:71], a[132:135], a[24:27], v[68:71]
    ds_read_b64_tr_b16 a[162:163], v247 offset:33280
    v_rcp_f32 v231, v231
    v_mul_f32 v20, v20, v228
    v_mfma_f32_16x16x32_bf16 v[76:79], a[132:135], a[28:31], v[76:79]
    ds_read_b64_tr_b16 a[164:165], v247 offset:34816
    buffer_load_dwordx4 v238, s[32:35], s12 offen offset:2048 lds
    v_mfma_f32_16x16x32_bf16 v[76:79], a[128:131], a[20:23], v[76:79]
    ds_read_b64_tr_b16 a[166:167], v247 offset:35328
    v_mul_f32 v21, v21, v229
    v_mul_f32 v22, v22, v230
    v_mul_f32 v23, v23, v231
    v_cvt_pk_bf16_f32 v2, v20, v21
    v_mfma_f32_16x16x32_bf16 v[84:87], a[136:139], a[16:19], v[84:87]
    buffer_load_dwordx4 v238, s[32:35], s13 offen offset:3072 lds
    v_mfma_f32_16x16x32_bf16 v[84:87], a[140:143], a[24:27], v[84:87]
    ds_read_b64_tr_b16 a[128:129], v247 offset:40960
    ds_read_b64_tr_b16 a[130:131], v247 offset:41472
    v_cvt_pk_bf16_f32 v3, v22, v23
    v_mfma_f32_16x16x32_bf16 v[92:95], a[140:143], a[28:31], v[92:95]
    s_add_u32 s42, s40, 12288
    buffer_store_dwordx4 v[0:3], v251, s[48:51], s4 offen sc1
    v_mfma_f32_16x16x32_bf16 v[92:95], a[136:139], a[20:23], v[92:95]
    ds_read_b64_tr_b16 a[132:133], v247 offset:43008
    ds_read_b64_tr_b16 a[134:135], v247 offset:43520
    v_mul_f32 v228, s17, v8
    s_waitcnt lgkmcnt(8)
    v_mfma_f32_16x16x32_bf16 v[64:67], a[144:147], a[32:35], v[64:67]
    ds_read_b64_tr_b16 a[136:137], v249 offset:36864
    v_mul_f32 v229, s17, v9
    v_mul_f32 v230, s17, v10
    v_mul_f32 v231, s17, v11
    v_mfma_f32_16x16x32_bf16 v[64:67], a[148:151], a[40:43], v[64:67]
    ds_read_b64_tr_b16 a[138:139], v249 offset:37376
    v_exp_f32 v228, v228
    v_mul_f32 v24, v8, v24
    v_mfma_f32_16x16x32_bf16 v[72:75], a[148:151], a[44:47], v[72:75]
    ds_read_b64_tr_b16 a[140:141], v249 offset:38912
    buffer_load_dwordx4 a[224:227], v243, s[48:51], s42 offen sc1
    v_mfma_f32_16x16x32_bf16 v[72:75], a[144:147], a[36:39], v[72:75]
    ds_read_b64_tr_b16 a[142:143], v249 offset:39424
    v_exp_f32 v229, v229
    v_mul_f32 v25, v9, v25
    v_mfma_f32_16x16x32_bf16 v[80:83], a[152:155], a[32:35], v[80:83]
    ds_read_b64_tr_b16 a[144:145], v249 offset:45056
    ds_read_b64_tr_b16 a[146:147], v249 offset:45568
    buffer_load_dwordx4 a[228:231], v240, s[48:51], s42 offen offset:1024 sc1
    v_mfma_f32_16x16x32_bf16 v[80:83], a[156:159], a[40:43], v[80:83]
    v_exp_f32 v230, v230
    v_mul_f32 v26, v10, v26
    v_exp_f32 v231, v231
    v_mfma_f32_16x16x32_bf16 v[88:91], a[156:159], a[44:47], v[88:91]
    ds_read_b64_tr_b16 a[148:149], v249 offset:47104
    v_mul_f32 v27, v11, v27
    v_add_f32 v228, 1.0, v228
    v_add_f32 v229, 1.0, v229
    v_add_f32 v230, 1.0, v230
    v_mfma_f32_16x16x32_bf16 v[88:91], a[152:155], a[36:39], v[88:91]
    ds_read_b64_tr_b16 a[150:151], v249 offset:47616
    v_add_f32 v231, 1.0, v231
    v_rcp_f32 v228, v228
    s_waitcnt lgkmcnt(8)
    v_mfma_f32_16x16x32_bf16 v[68:71], a[160:163], a[32:35], v[68:71]
    buffer_load_dwordx4 a[232:235], v243, s[48:51], s42 offen offset:2048 sc1
    v_mfma_f32_16x16x32_bf16 v[68:71], a[164:167], a[40:43], v[68:71]
    ds_read_b64_tr_b16 a[152:153], v247 offset:36864
    ds_read_b64_tr_b16 a[154:155], v247 offset:37376
    v_rcp_f32 v229, v229
    v_mfma_f32_16x16x32_bf16 v[76:79], a[164:167], a[44:47], v[76:79]
    ds_read_b64_tr_b16 a[156:157], v247 offset:38912
    v_rcp_f32 v230, v230
    v_rcp_f32 v231, v231
    v_mfma_f32_16x16x32_bf16 v[76:79], a[160:163], a[36:39], v[76:79]
    ds_read_b64_tr_b16 a[158:159], v247 offset:39424
    v_mul_f32 v24, v24, v228
    v_mul_f32 v25, v25, v229
    v_mul_f32 v26, v26, v230
    v_mul_f32 v27, v27, v231
    v_mfma_f32_16x16x32_bf16 v[84:87], a[128:131], a[32:35], v[84:87]
    ds_read_b64_tr_b16 a[160:161], v247 offset:45056
    buffer_load_dwordx4 a[236:239], v240, s[48:51], s42 offen offset:3072 sc1
    v_mfma_f32_16x16x32_bf16 v[84:87], a[132:135], a[40:43], v[84:87]
    ds_read_b64_tr_b16 a[162:163], v247 offset:45568
    v_cvt_pk_bf16_f32 v4, v24, v25
    v_cvt_pk_bf16_f32 v5, v26, v27
    v_mul_f32 v228, s17, v12
    v_mfma_f32_16x16x32_bf16 v[92:95], a[132:135], a[44:47], v[92:95]
    ds_read_b64_tr_b16 a[164:165], v247 offset:47104
    v_mul_f32 v229, s17, v13
    v_mul_f32 v230, s17, v14
    v_mfma_f32_16x16x32_bf16 v[92:95], a[128:131], a[36:39], v[92:95]
    ds_read_b64_tr_b16 a[166:167], v247 offset:47616
    v_mul_f32 v231, s17, v15
    s_waitcnt vmcnt(21)
    s_barrier
    s_waitcnt lgkmcnt(8)
    v_mfma_f32_16x16x32_bf16 v[64:67], a[136:139], a[48:51], v[64:67]
    ds_read_b64_tr_b16 a[128:129], v249 offset:49152
    s_add_u32 m0, s62, 0
    v_add_u32 v238, 229376, v238
    v_exp_f32 v228, v228
    v_mfma_f32_16x16x32_bf16 v[64:67], a[140:143], a[56:59], v[64:67]
    ds_read_b64_tr_b16 a[130:131], v249 offset:49664
    v_mul_f32 v28, v12, v28
    v_exp_f32 v229, v229
    v_mfma_f32_16x16x32_bf16 v[72:75], a[140:143], a[60:63], v[72:75]
    ds_read_b64_tr_b16 a[132:133], v249 offset:51200
    buffer_load_dwordx4 v238, s[32:35], 0 offen lds
    v_mfma_f32_16x16x32_bf16 v[72:75], a[136:139], a[52:55], v[72:75]
    ds_read_b64_tr_b16 a[134:135], v249 offset:51712
    v_mul_f32 v29, v13, v29
    v_exp_f32 v230, v230
    v_mul_f32 v30, v14, v30
    v_mfma_f32_16x16x32_bf16 v[80:83], a[144:147], a[48:51], v[80:83]
    ds_read_b64_tr_b16 a[136:137], v249 offset:57344
    v_exp_f32 v231, v231
    v_mul_f32 v31, v15, v31
    v_add_f32 v228, 1.0, v228
    v_mfma_f32_16x16x32_bf16 v[80:83], a[148:151], a[56:59], v[80:83]
    ds_read_b64_tr_b16 a[138:139], v249 offset:57856
    v_add_f32 v229, 1.0, v229
    v_add_f32 v230, 1.0, v230
    v_add_f32 v231, 1.0, v231
    v_mfma_f32_16x16x32_bf16 v[88:91], a[148:151], a[60:63], v[88:91]
    ds_read_b64_tr_b16 a[140:141], v249 offset:59392
    buffer_load_dwordx4 v238, s[32:35], s11 offen offset:1024 lds
    v_mfma_f32_16x16x32_bf16 v[88:91], a[144:147], a[52:55], v[88:91]
    ds_read_b64_tr_b16 a[142:143], v249 offset:59904
    v_rcp_f32 v228, v228
    v_rcp_f32 v229, v229
    s_waitcnt lgkmcnt(8)
    v_mfma_f32_16x16x32_bf16 v[68:71], a[152:155], a[48:51], v[68:71]
    v_rcp_f32 v230, v230
    v_rcp_f32 v231, v231
    v_mfma_f32_16x16x32_bf16 v[68:71], a[156:159], a[56:59], v[68:71]
    ds_read_b64_tr_b16 a[144:145], v247 offset:49152
    ds_read_b64_tr_b16 a[146:147], v247 offset:49664
    v_mul_f32 v28, v28, v228
    v_mul_f32 v29, v29, v229
    v_mfma_f32_16x16x32_bf16 v[76:79], a[156:159], a[60:63], v[76:79]
    ds_read_b64_tr_b16 a[148:149], v247 offset:51200
    buffer_load_dwordx4 v238, s[32:35], s12 offen offset:2048 lds
    v_mfma_f32_16x16x32_bf16 v[76:79], a[152:155], a[52:55], v[76:79]
    ds_read_b64_tr_b16 a[150:151], v247 offset:51712
    v_mul_f32 v30, v30, v230
    v_mul_f32 v31, v31, v231
    v_cvt_pk_bf16_f32 v6, v28, v29
    v_mfma_f32_16x16x32_bf16 v[84:87], a[160:163], a[48:51], v[84:87]
    buffer_load_dwordx4 v238, s[32:35], s13 offen offset:3072 lds
    v_mfma_f32_16x16x32_bf16 v[84:87], a[164:167], a[56:59], v[84:87]
    ds_read_b64_tr_b16 a[152:153], v247 offset:57344
    ds_read_b64_tr_b16 a[154:155], v247 offset:57856
    v_cvt_pk_bf16_f32 v7, v30, v31
    v_mfma_f32_16x16x32_bf16 v[92:95], a[164:167], a[60:63], v[92:95]
    s_add_u32 s42, s40, 49152
    buffer_store_dwordx4 v[4:7], v251, s[48:51], s4 offen offset:1024 sc1
    v_mfma_f32_16x16x32_bf16 v[92:95], a[160:163], a[52:55], v[92:95]
    ds_read_b64_tr_b16 a[156:157], v247 offset:59392
    ds_read_b64_tr_b16 a[158:159], v247 offset:59904
    v_mul_f32 v228, s17, v32
    s_waitcnt lgkmcnt(8)
    v_mfma_f32_16x16x32_bf16 v[64:67], a[128:131], a[64:67], v[64:67]
    v_mul_f32 v229, s17, v33
    v_mul_f32 v230, s17, v34
    v_mul_f32 v231, s17, v35
    v_exp_f32 v228, v228
    v_mfma_f32_16x16x32_bf16 v[64:67], a[132:135], a[72:75], v[64:67]
    ds_read_b64_tr_b16 a[160:161], v249 offset:53248
    ds_read_b64_tr_b16 a[162:163], v249 offset:53760
    v_mul_f32 v48, v32, v48
    v_exp_f32 v229, v229
    v_mfma_f32_16x16x32_bf16 v[72:75], a[132:135], a[76:79], v[72:75]
    ds_read_b64_tr_b16 a[164:165], v249 offset:55296
    buffer_load_dwordx4 a[240:243], v243, s[48:51], s42 offen sc1
    v_mfma_f32_16x16x32_bf16 v[72:75], a[128:131], a[68:71], v[72:75]
    ds_read_b64_tr_b16 a[166:167], v249 offset:55808
    v_mul_f32 v49, v33, v49
    v_exp_f32 v230, v230
    v_mfma_f32_16x16x32_bf16 v[80:83], a[136:139], a[64:67], v[80:83]
    ds_read_b64_tr_b16 a[128:129], v249 offset:61440
    buffer_load_dwordx4 a[244:247], v240, s[48:51], s42 offen offset:1024 sc1
    v_mfma_f32_16x16x32_bf16 v[80:83], a[140:143], a[72:75], v[80:83]
    ds_read_b64_tr_b16 a[130:131], v249 offset:61952
    v_mul_f32 v50, v34, v50
    v_exp_f32 v231, v231
    v_mfma_f32_16x16x32_bf16 v[88:91], a[140:143], a[76:79], v[88:91]
    ds_read_b64_tr_b16 a[132:133], v249 offset:63488
    v_mul_f32 v51, v35, v51
    v_add_f32 v228, 1.0, v228
    v_add_f32 v229, 1.0, v229
    v_add_f32 v230, 1.0, v230
    v_mfma_f32_16x16x32_bf16 v[88:91], a[136:139], a[68:71], v[88:91]
    ds_read_b64_tr_b16 a[134:135], v249 offset:64000
    v_add_f32 v231, 1.0, v231
    v_rcp_f32 v228, v228
    s_waitcnt lgkmcnt(8)
    v_mfma_f32_16x16x32_bf16 v[68:71], a[144:147], a[64:67], v[68:71]
    ds_read_b64_tr_b16 a[136:137], v247 offset:53248
    buffer_load_dwordx4 a[248:251], v243, s[48:51], s42 offen offset:2048 sc1
    v_mfma_f32_16x16x32_bf16 v[68:71], a[148:151], a[72:75], v[68:71]
    ds_read_b64_tr_b16 a[138:139], v247 offset:53760
    v_rcp_f32 v229, v229
    v_rcp_f32 v230, v230
    v_mfma_f32_16x16x32_bf16 v[76:79], a[148:151], a[76:79], v[76:79]
    ds_read_b64_tr_b16 a[140:141], v247 offset:55296
    v_rcp_f32 v231, v231
    v_mul_f32 v48, v48, v228
    v_mfma_f32_16x16x32_bf16 v[76:79], a[144:147], a[68:71], v[76:79]
    ds_read_b64_tr_b16 a[142:143], v247 offset:55808
    v_mul_f32 v49, v49, v229
    v_mul_f32 v50, v50, v230
    v_mul_f32 v51, v51, v231
    v_mfma_f32_16x16x32_bf16 v[84:87], a[152:155], a[64:67], v[84:87]
    ds_read_b64_tr_b16 a[144:145], v247 offset:61440
    buffer_load_dwordx4 a[252:255], v240, s[48:51], s42 offen offset:3072 sc1
    v_mfma_f32_16x16x32_bf16 v[84:87], a[156:159], a[72:75], v[84:87]
    ds_read_b64_tr_b16 a[146:147], v247 offset:61952
    v_cvt_pk_bf16_f32 v32, v48, v49
    v_cvt_pk_bf16_f32 v33, v50, v51
    v_mul_f32 v228, s17, v36
    v_mul_f32 v229, s17, v37
    v_mfma_f32_16x16x32_bf16 v[92:95], a[156:159], a[76:79], v[92:95]
    ds_read_b64_tr_b16 a[148:149], v247 offset:63488
    v_mul_f32 v230, s17, v38
    v_mul_f32 v231, s17, v39
    v_exp_f32 v228, v228
    v_mfma_f32_16x16x32_bf16 v[92:95], a[152:155], a[68:71], v[92:95]
    ds_read_b64_tr_b16 a[150:151], v247 offset:64000
    v_mul_f32 v52, v36, v52
    v_exp_f32 v229, v229
    s_waitcnt lgkmcnt(8)
    v_mfma_f32_16x16x32_bf16 v[64:67], a[160:163], a[80:83], v[64:67]
    v_add_u32 v249, 65536, v249
    ds_read_b64_tr_b16 a[152:153], v249
    s_add_u32 m0, s62, 16384
    v_add_u32 v238, 229376, v238
    v_mul_f32 v53, v37, v53
    v_mfma_f32_16x16x32_bf16 v[64:67], a[164:167], a[88:91], v[64:67]
    ds_read_b64_tr_b16 a[154:155], v249 offset:512
    v_exp_f32 v230, v230
    v_mul_f32 v54, v38, v54
    v_mfma_f32_16x16x32_bf16 v[72:75], a[164:167], a[92:95], v[72:75]
    ds_read_b64_tr_b16 a[156:157], v249 offset:2048
    buffer_load_dwordx4 v238, s[32:35], 0 offen lds
    v_mfma_f32_16x16x32_bf16 v[72:75], a[160:163], a[84:87], v[72:75]
    ds_read_b64_tr_b16 a[158:159], v249 offset:2560
    v_exp_f32 v231, v231
    v_mul_f32 v55, v39, v55
    v_add_f32 v228, 1.0, v228
    v_mfma_f32_16x16x32_bf16 v[80:83], a[128:131], a[80:83], v[80:83]
    ds_read_b64_tr_b16 a[160:161], v249 offset:8192
    v_add_f32 v229, 1.0, v229
    v_add_f32 v230, 1.0, v230
    v_add_f32 v231, 1.0, v231
    v_mfma_f32_16x16x32_bf16 v[80:83], a[132:135], a[88:91], v[80:83]
    ds_read_b64_tr_b16 a[162:163], v249 offset:8704
    v_rcp_f32 v228, v228
    v_rcp_f32 v229, v229
    v_mfma_f32_16x16x32_bf16 v[88:91], a[132:135], a[92:95], v[88:91]
    ds_read_b64_tr_b16 a[164:165], v249 offset:10240
    buffer_load_dwordx4 v238, s[32:35], s11 offen offset:1024 lds
    v_mfma_f32_16x16x32_bf16 v[88:91], a[128:131], a[84:87], v[88:91]
    ds_read_b64_tr_b16 a[166:167], v249 offset:10752
    v_rcp_f32 v230, v230
    v_rcp_f32 v231, v231
    s_waitcnt lgkmcnt(8)
    v_mfma_f32_16x16x32_bf16 v[68:71], a[136:139], a[80:83], v[68:71]
    v_add_u32 v247, 65536, v247
    ds_read_b64_tr_b16 a[128:129], v247
    v_mul_f32 v52, v52, v228
    v_mul_f32 v53, v53, v229
    v_mul_f32 v54, v54, v230
    v_mfma_f32_16x16x32_bf16 v[68:71], a[140:143], a[88:91], v[68:71]
    ds_read_b64_tr_b16 a[130:131], v247 offset:512
    v_mul_f32 v55, v55, v231
    v_cvt_pk_bf16_f32 v34, v52, v53
    v_cvt_pk_bf16_f32 v35, v54, v55
    v_mfma_f32_16x16x32_bf16 v[76:79], a[140:143], a[92:95], v[76:79]
    buffer_load_dwordx4 v238, s[32:35], s12 offen offset:2048 lds
    v_mfma_f32_16x16x32_bf16 v[76:79], a[136:139], a[84:87], v[76:79]
    ds_read_b64_tr_b16 a[132:133], v247 offset:2048
    ds_read_b64_tr_b16 a[134:135], v247 offset:2560
    v_mfma_f32_16x16x32_bf16 v[84:87], a[144:147], a[80:83], v[84:87]
    ds_read_b64_tr_b16 a[136:137], v247 offset:8192
    ds_read_b64_tr_b16 a[138:139], v247 offset:8704
    buffer_load_dwordx4 v238, s[32:35], s13 offen offset:3072 lds
    v_mfma_f32_16x16x32_bf16 v[84:87], a[148:151], a[88:91], v[84:87]
    buffer_store_dwordx4 v[32:35], v251, s[48:51], s4 offen offset:256 sc1
    v_mfma_f32_16x16x32_bf16 v[92:95], a[148:151], a[92:95], v[92:95]
    ds_read_b64_tr_b16 a[140:141], v247 offset:10240
    s_add_u32 s42, s40, 53248
    v_mul_f32 v228, s17, v40
    v_mul_f32 v229, s17, v41
    v_mul_f32 v230, s17, v42
    v_mfma_f32_16x16x32_bf16 v[92:95], a[144:147], a[84:87], v[92:95]
    ds_read_b64_tr_b16 a[142:143], v247 offset:10752
    v_mul_f32 v231, s17, v43
    v_exp_f32 v228, v228
    s_waitcnt lgkmcnt(8)
    v_mfma_f32_16x16x32_bf16 v[64:67], a[152:155], a[96:99], v[64:67]
    ds_read_b64_tr_b16 a[144:145], v249 offset:4096
    v_mul_f32 v56, v40, v56
    v_exp_f32 v229, v229
    v_mfma_f32_16x16x32_bf16 v[64:67], a[156:159], a[104:107], v[64:67]
    ds_read_b64_tr_b16 a[146:147], v249 offset:4608
    v_mul_f32 v57, v41, v57
    v_exp_f32 v230, v230
    v_mfma_f32_16x16x32_bf16 v[72:75], a[156:159], a[108:111], v[72:75]
    ds_read_b64_tr_b16 a[148:149], v249 offset:6144
    buffer_load_dwordx4 v[96:99], v243, s[48:51], s42 offen sc1
    v_mfma_f32_16x16x32_bf16 v[72:75], a[152:155], a[100:103], v[72:75]
    ds_read_b64_tr_b16 a[150:151], v249 offset:6656
    v_mul_f32 v58, v42, v58
    v_exp_f32 v231, v231
    v_mul_f32 v59, v43, v59
    v_mfma_f32_16x16x32_bf16 v[80:83], a[160:163], a[96:99], v[80:83]
    ds_read_b64_tr_b16 a[152:153], v249 offset:12288
    buffer_load_dwordx4 v[100:103], v240, s[48:51], s42 offen offset:1024 sc1
    v_mfma_f32_16x16x32_bf16 v[80:83], a[164:167], a[104:107], v[80:83]
    ds_read_b64_tr_b16 a[154:155], v249 offset:12800
    v_add_f32 v228, 1.0, v228
    v_add_f32 v229, 1.0, v229
    v_add_f32 v230, 1.0, v230
    v_mfma_f32_16x16x32_bf16 v[88:91], a[164:167], a[108:111], v[88:91]
    ds_read_b64_tr_b16 a[156:157], v249 offset:14336
    v_add_f32 v231, 1.0, v231
    v_rcp_f32 v228, v228
    v_mfma_f32_16x16x32_bf16 v[88:91], a[160:163], a[100:103], v[88:91]
    ds_read_b64_tr_b16 a[158:159], v249 offset:14848
    v_rcp_f32 v229, v229
    v_rcp_f32 v230, v230
    s_waitcnt lgkmcnt(8)
    v_mfma_f32_16x16x32_bf16 v[68:71], a[128:131], a[96:99], v[68:71]
    ds_read_b64_tr_b16 a[160:161], v247 offset:4096
    buffer_load_dwordx4 v[104:107], v243, s[48:51], s42 offen offset:2048 sc1
    v_mfma_f32_16x16x32_bf16 v[68:71], a[132:135], a[104:107], v[68:71]
    ds_read_b64_tr_b16 a[162:163], v247 offset:4608
    v_rcp_f32 v231, v231
    v_mul_f32 v56, v56, v228
    v_mfma_f32_16x16x32_bf16 v[76:79], a[132:135], a[108:111], v[76:79]
    ds_read_b64_tr_b16 a[164:165], v247 offset:6144
    v_mul_f32 v57, v57, v229
    v_mul_f32 v58, v58, v230
    v_mul_f32 v59, v59, v231
    v_cvt_pk_bf16_f32 v36, v56, v57
    v_mfma_f32_16x16x32_bf16 v[76:79], a[128:131], a[100:103], v[76:79]
    ds_read_b64_tr_b16 a[166:167], v247 offset:6656
    v_cvt_pk_bf16_f32 v37, v58, v59
    v_mul_f32 v228, s17, v44
    v_mul_f32 v229, s17, v45
    v_mfma_f32_16x16x32_bf16 v[84:87], a[136:139], a[96:99], v[84:87]
    ds_read_b64_tr_b16 a[128:129], v247 offset:12288
    buffer_load_dwordx4 v[108:111], v240, s[48:51], s42 offen offset:3072 sc1
    v_mfma_f32_16x16x32_bf16 v[84:87], a[140:143], a[104:107], v[84:87]
    ds_read_b64_tr_b16 a[130:131], v247 offset:12800
    v_mul_f32 v230, s17, v46
    v_mul_f32 v231, s17, v47
    v_exp_f32 v228, v228
    v_mfma_f32_16x16x32_bf16 v[92:95], a[140:143], a[108:111], v[92:95]
    ds_read_b64_tr_b16 a[132:133], v247 offset:14336
    v_mul_f32 v60, v44, v60
    v_mfma_f32_16x16x32_bf16 v[92:95], a[136:139], a[100:103], v[92:95]
    ds_read_b64_tr_b16 a[134:135], v247 offset:14848
    v_exp_f32 v229, v229
    s_waitcnt vmcnt(23)
    s_barrier
    s_waitcnt lgkmcnt(8)
    v_mfma_f32_16x16x32_bf16 v[64:67], a[144:147], a[112:115], v[64:67]
    v_add_u32 v254, 81920, v254
    ds_read_b64_tr_b16 a[136:137], v254
    s_add_u32 m0, s62, 32768
    v_add_u32 v238, 229376, v238
    v_mul_f32 v61, v45, v61
    v_exp_f32 v230, v230
    v_mfma_f32_16x16x32_bf16 v[64:67], a[148:151], a[120:123], v[64:67]
    ds_read_b64_tr_b16 a[138:139], v254 offset:1024
    v_mul_f32 v62, v46, v62
    v_exp_f32 v231, v231
    v_mfma_f32_16x16x32_bf16 v[72:75], a[148:151], a[124:127], v[72:75]
    buffer_load_dwordx4 v238, s[32:35], 0 offen lds
    v_mfma_f32_16x16x32_bf16 v[72:75], a[144:147], a[116:119], v[72:75]
    ds_read_b64_tr_b16 a[140:141], v254 offset:4096
    ds_read_b64_tr_b16 a[142:143], v254 offset:5120
    v_mul_f32 v63, v47, v63
    v_add_f32 v228, 1.0, v228
    v_mfma_f32_16x16x32_bf16 v[80:83], a[152:155], a[112:115], v[80:83]
    ds_read_b64_tr_b16 a[144:145], v254 offset:8192
    v_add_f32 v229, 1.0, v229
    v_add_f32 v230, 1.0, v230
    v_add_f32 v231, 1.0, v231
    v_mfma_f32_16x16x32_bf16 v[80:83], a[156:159], a[120:123], v[80:83]
    ds_read_b64_tr_b16 a[146:147], v254 offset:9216
    v_rcp_f32 v228, v228
    v_rcp_f32 v229, v229
    v_mfma_f32_16x16x32_bf16 v[88:91], a[156:159], a[124:127], v[88:91]
    ds_read_b64_tr_b16 a[148:149], v254 offset:12288
    buffer_load_dwordx4 v238, s[32:35], s11 offen offset:1024 lds
    v_mfma_f32_16x16x32_bf16 v[88:91], a[152:155], a[116:119], v[88:91]
    ds_read_b64_tr_b16 a[150:151], v254 offset:13312
    v_rcp_f32 v230, v230
    v_rcp_f32 v231, v231
    s_waitcnt lgkmcnt(8)
    v_mfma_f32_16x16x32_bf16 v[68:71], a[160:163], a[112:115], v[68:71]
    v_add_u32 v253, 81920, v253
    ds_read_b64_tr_b16 a[152:153], v253
    v_mul_f32 v60, v60, v228
    v_mul_f32 v61, v61, v229
    v_mul_f32 v62, v62, v230
    v_mfma_f32_16x16x32_bf16 v[68:71], a[164:167], a[120:123], v[68:71]
    ds_read_b64_tr_b16 a[154:155], v253 offset:1024
    v_mul_f32 v63, v63, v231
    v_cvt_pk_bf16_f32 v38, v60, v61
    v_cvt_pk_bf16_f32 v39, v62, v63
    v_mfma_f32_16x16x32_bf16 v[76:79], a[164:167], a[124:127], v[76:79]
    ds_read_b64_tr_b16 a[156:157], v253 offset:4096
    ds_read_b64_tr_b16 a[158:159], v253 offset:5120
    buffer_load_dwordx4 v238, s[32:35], s12 offen offset:2048 lds
    v_mfma_f32_16x16x32_bf16 v[76:79], a[160:163], a[116:119], v[76:79]
    buffer_store_dwordx4 v[36:39], v251, s[48:51], s4 offen offset:1280 sc1
    v_mfma_f32_16x16x32_bf16 v[84:87], a[128:131], a[112:115], v[84:87]
    buffer_load_dwordx4 v238, s[32:35], s13 offen offset:3072 lds
    v_mfma_f32_16x16x32_bf16 v[84:87], a[132:135], a[120:123], v[84:87]
    ds_read_b64_tr_b16 a[160:161], v253 offset:8192
    ds_read_b64_tr_b16 a[162:163], v253 offset:9216
    v_mfma_f32_16x16x32_bf16 v[92:95], a[132:135], a[124:127], v[92:95]
    ds_read_b64_tr_b16 a[164:165], v253 offset:12288
    s_add_u32 s42, s41, 0
    v_mfma_f32_16x16x32_bf16 v[92:95], a[128:131], a[116:119], v[92:95]
    ds_read_b64_tr_b16 a[166:167], v253 offset:13312
    s_waitcnt lgkmcnt(8)
    v_mfma_f32_16x16x32_bf16 v[0:3], a[136:139], a[0:3], 0
    v_add_u32 v233, 81920, v233
    ds_read_b64_tr_b16 a[128:129], v233
    v_mfma_f32_16x16x32_bf16 v[0:3], a[140:143], a[8:11], v[0:3]
    ds_read_b64_tr_b16 a[130:131], v233 offset:1024
    v_mfma_f32_16x16x32_bf16 v[32:35], a[140:143], a[12:15], 0
    buffer_load_dwordx4 v[112:115], v243, s[48:51], s42 offen sc1
    v_mfma_f32_16x16x32_bf16 v[32:35], a[136:139], a[4:7], v[32:35]
    ds_read_b64_tr_b16 a[132:133], v233 offset:4096
    ds_read_b64_tr_b16 a[134:135], v233 offset:5120
    v_mfma_f32_16x16x32_bf16 v[16:19], a[144:147], a[0:3], 0
    buffer_load_dwordx4 v[116:119], v240, s[48:51], s42 offen offset:1024 sc1
    v_mfma_f32_16x16x32_bf16 v[16:19], a[148:151], a[8:11], v[16:19]
    ds_read_b64_tr_b16 a[136:137], v233 offset:8192
    ds_read_b64_tr_b16 a[138:139], v233 offset:9216
    v_mul_f32 v228, s17, v64
    v_mul_f32 v229, s17, v65
    v_mfma_f32_16x16x32_bf16 v[48:51], a[148:151], a[12:15], 0
    ds_read_b64_tr_b16 a[140:141], v233 offset:12288
    v_mul_f32 v230, s17, v66
    v_mul_f32 v231, s17, v67
    v_mfma_f32_16x16x32_bf16 v[48:51], a[144:147], a[4:7], v[48:51]
    ds_read_b64_tr_b16 a[142:143], v233 offset:13312
    v_exp_f32 v228, v228
    v_mul_f32 v80, v64, v80
    s_waitcnt lgkmcnt(8)
    v_mfma_f32_16x16x32_bf16 v[4:7], a[152:155], a[0:3], 0
    v_add_u32 v246, 81920, v246
    ds_read_b64_tr_b16 a[144:145], v246
    buffer_load_dwordx4 v[120:123], v243, s[48:51], s42 offen offset:2048 sc1
    v_mfma_f32_16x16x32_bf16 v[4:7], a[156:159], a[8:11], v[4:7]
    ds_read_b64_tr_b16 a[146:147], v246 offset:1024
    v_exp_f32 v229, v229
    v_mfma_f32_16x16x32_bf16 v[36:39], a[156:159], a[12:15], 0
    ds_read_b64_tr_b16 a[148:149], v246 offset:4096
    v_mul_f32 v81, v65, v81
    v_exp_f32 v230, v230
    v_mfma_f32_16x16x32_bf16 v[36:39], a[152:155], a[4:7], v[36:39]
    ds_read_b64_tr_b16 a[150:151], v246 offset:5120
    v_mul_f32 v82, v66, v82
    v_exp_f32 v231, v231
    v_mfma_f32_16x16x32_bf16 v[20:23], a[160:163], a[0:3], 0
    buffer_load_dwordx4 v[124:127], v240, s[48:51], s42 offen offset:3072 sc1
    v_mfma_f32_16x16x32_bf16 v[20:23], a[164:167], a[8:11], v[20:23]
    ds_read_b64_tr_b16 a[152:153], v246 offset:8192
    ds_read_b64_tr_b16 a[154:155], v246 offset:9216
    v_mul_f32 v83, v67, v83
    v_mfma_f32_16x16x32_bf16 v[52:55], a[164:167], a[12:15], 0
    ds_read_b64_tr_b16 a[156:157], v246 offset:12288
    v_add_f32 v228, 1.0, v228
    v_add_f32 v229, 1.0, v229
    v_add_f32 v230, 1.0, v230
    v_mfma_f32_16x16x32_bf16 v[52:55], a[160:163], a[4:7], v[52:55]
    ds_read_b64_tr_b16 a[158:159], v246 offset:13312
    v_add_f32 v231, 1.0, v231
    v_rcp_f32 v228, v228
    s_waitcnt lgkmcnt(8)
    v_mfma_f32_16x16x32_bf16 v[8:11], a[128:131], a[0:3], 0
    ds_read_b64_tr_b16 a[160:161], v254 offset:16384
    s_add_u32 m0, s62, 49152
    v_add_u32 v238, 229376, v238
    v_mfma_f32_16x16x32_bf16 v[8:11], a[132:135], a[8:11], v[8:11]
    ds_read_b64_tr_b16 a[162:163], v254 offset:17408
    v_rcp_f32 v229, v229
    v_mfma_f32_16x16x32_bf16 v[40:43], a[132:135], a[12:15], 0
    buffer_load_dwordx4 v238, s[32:35], 0 offen lds
    v_mfma_f32_16x16x32_bf16 v[40:43], a[128:131], a[4:7], v[40:43]
    ds_read_b64_tr_b16 a[164:165], v254 offset:20480
    ds_read_b64_tr_b16 a[166:167], v254 offset:21504
    v_rcp_f32 v230, v230
    v_mfma_f32_16x16x32_bf16 v[24:27], a[136:139], a[0:3], 0
    ds_read_b64_tr_b16 a[128:129], v254 offset:24576
    v_rcp_f32 v231, v231
    v_mul_f32 v80, v80, v228
    v_mfma_f32_16x16x32_bf16 v[24:27], a[140:143], a[8:11], v[24:27]
    ds_read_b64_tr_b16 a[130:131], v254 offset:25600
    v_mul_f32 v81, v81, v229
    v_mul_f32 v82, v82, v230
    v_mul_f32 v83, v83, v231
    v_mfma_f32_16x16x32_bf16 v[56:59], a[140:143], a[12:15], 0
    buffer_load_dwordx4 v238, s[32:35], s11 offen offset:1024 lds
    v_mfma_f32_16x16x32_bf16 v[56:59], a[136:139], a[4:7], v[56:59]
    ds_read_b64_tr_b16 a[132:133], v254 offset:28672
    ds_read_b64_tr_b16 a[134:135], v254 offset:29696
    v_cvt_pk_bf16_f32 v64, v80, v81
    v_cvt_pk_bf16_f32 v65, v82, v83
    s_waitcnt lgkmcnt(8)
    v_mfma_f32_16x16x32_bf16 v[12:15], a[144:147], a[0:3], 0
    ds_read_b64_tr_b16 a[136:137], v253 offset:16384
    v_mul_f32 v228, s17, v68
    v_mul_f32 v229, s17, v69
    v_mul_f32 v230, s17, v70
    v_mfma_f32_16x16x32_bf16 v[12:15], a[148:151], a[8:11], v[12:15]
    ds_read_b64_tr_b16 a[138:139], v253 offset:17408
    v_mul_f32 v231, s17, v71
    v_exp_f32 v228, v228
    v_mfma_f32_16x16x32_bf16 v[44:47], a[148:151], a[12:15], 0
    buffer_load_dwordx4 v238, s[32:35], s12 offen offset:2048 lds
    v_mfma_f32_16x16x32_bf16 v[44:47], a[144:147], a[4:7], v[44:47]
    ds_read_b64_tr_b16 a[140:141], v253 offset:20480
    ds_read_b64_tr_b16 a[142:143], v253 offset:21504
    v_mul_f32 v84, v68, v84
    v_mfma_f32_16x16x32_bf16 v[28:31], a[152:155], a[0:3], 0
    buffer_load_dwordx4 v238, s[32:35], s13 offen offset:3072 lds
    v_mfma_f32_16x16x32_bf16 v[28:31], a[156:159], a[8:11], v[28:31]
    ds_read_b64_tr_b16 a[144:145], v253 offset:24576
    ds_read_b64_tr_b16 a[146:147], v253 offset:25600
    v_exp_f32 v229, v229
    v_mfma_f32_16x16x32_bf16 v[60:63], a[156:159], a[12:15], 0
    ds_read_b64_tr_b16 a[148:149], v253 offset:28672
    s_add_u32 s42, s41, 4096
    v_mul_f32 v85, v69, v85
    v_mfma_f32_16x16x32_bf16 v[60:63], a[152:155], a[4:7], v[60:63]
    ds_read_b64_tr_b16 a[150:151], v253 offset:29696
    v_exp_f32 v230, v230
    v_mul_f32 v86, v70, v86
    s_waitcnt lgkmcnt(8)
    v_mfma_f32_16x16x32_bf16 v[0:3], a[160:163], a[16:19], v[0:3]
    ds_read_b64_tr_b16 a[152:153], v233 offset:16384
    v_exp_f32 v231, v231
    v_mul_f32 v87, v71, v87
    v_mfma_f32_16x16x32_bf16 v[0:3], a[164:167], a[24:27], v[0:3]
    ds_read_b64_tr_b16 a[154:155], v233 offset:17408
    v_add_f32 v228, 1.0, v228
    v_add_f32 v229, 1.0, v229
    v_add_f32 v230, 1.0, v230
    v_mfma_f32_16x16x32_bf16 v[32:35], a[164:167], a[28:31], v[32:35]
    buffer_load_dwordx4 v[128:131], v243, s[48:51], s42 offen sc1
    v_mfma_f32_16x16x32_bf16 v[32:35], a[160:163], a[20:23], v[32:35]
    ds_read_b64_tr_b16 a[156:157], v233 offset:20480
    ds_read_b64_tr_b16 a[158:159], v233 offset:21504
    v_add_f32 v231, 1.0, v231
    v_mfma_f32_16x16x32_bf16 v[16:19], a[128:131], a[16:19], v[16:19]
    ds_read_b64_tr_b16 a[160:161], v233 offset:24576
    ds_read_b64_tr_b16 a[162:163], v233 offset:25600
    buffer_load_dwordx4 v[132:135], v240, s[48:51], s42 offen offset:1024 sc1
    s_waitcnt vmcnt(11)
    v_mfma_f32_16x16x32_bf16 v[16:19], a[132:135], a[24:27], v[16:19]
    buffer_store_dword v241, v248, s[48:51], 0 offen offset:128 sc1
    v_mfma_f32_16x16x32_bf16 v[48:51], a[132:135], a[28:31], v[48:51]
    v_rcp_f32 v228, v228
    v_rcp_f32 v229, v229
    v_mfma_f32_16x16x32_bf16 v[48:51], a[128:131], a[20:23], v[48:51]
    ds_read_b64_tr_b16 a[164:165], v233 offset:28672
    ds_read_b64_tr_b16 a[166:167], v233 offset:29696
    v_rcp_f32 v230, v230
    s_waitcnt lgkmcnt(8)
    v_mfma_f32_16x16x32_bf16 v[4:7], a[136:139], a[16:19], v[4:7]
    buffer_load_dwordx4 v[136:139], v243, s[48:51], s42 offen offset:2048 sc1
    v_mfma_f32_16x16x32_bf16 v[4:7], a[140:143], a[24:27], v[4:7]
    ds_read_b64_tr_b16 a[128:129], v246 offset:16384
    ds_read_b64_tr_b16 a[130:131], v246 offset:17408
    v_rcp_f32 v231, v231
    v_mfma_f32_16x16x32_bf16 v[36:39], a[140:143], a[28:31], v[36:39]
    ds_read_b64_tr_b16 a[132:133], v246 offset:20480
    v_mul_f32 v84, v84, v228
    v_mul_f32 v85, v85, v229
    v_mul_f32 v86, v86, v230
    v_mfma_f32_16x16x32_bf16 v[36:39], a[136:139], a[20:23], v[36:39]
    ds_read_b64_tr_b16 a[134:135], v246 offset:21504
    v_mul_f32 v87, v87, v231
    v_cvt_pk_bf16_f32 v66, v84, v85
    v_mfma_f32_16x16x32_bf16 v[20:23], a[144:147], a[16:19], v[20:23]
    buffer_load_dwordx4 v[140:143], v240, s[48:51], s42 offen offset:3072 sc1
    v_mfma_f32_16x16x32_bf16 v[20:23], a[148:151], a[24:27], v[20:23]
    ds_read_b64_tr_b16 a[136:137], v246 offset:24576
    ds_read_b64_tr_b16 a[138:139], v246 offset:25600
    v_cvt_pk_bf16_f32 v67, v86, v87
    v_mfma_f32_16x16x32_bf16 v[52:55], a[148:151], a[28:31], v[52:55]
    ds_read_b64_tr_b16 a[140:141], v246 offset:28672
    v_mfma_f32_16x16x32_bf16 v[52:55], a[144:147], a[20:23], v[52:55]
    ds_read_b64_tr_b16 a[142:143], v246 offset:29696
    s_barrier
    s_waitcnt lgkmcnt(8)
    v_mfma_f32_16x16x32_bf16 v[8:11], a[152:155], a[16:19], v[8:11]
    v_subrev_u32 v254, 81920, v254
    ds_read_b64_tr_b16 a[144:145], v254
    ds_read_b64_tr_b16 a[146:147], v254 offset:1024
    s_add_u32 m0, s62, 65536
    v_add_u32 v238, 229376, v238
    v_mfma_f32_16x16x32_bf16 v[8:11], a[156:159], a[24:27], v[8:11]
    buffer_store_dwordx4 v[64:67], v250, s[48:51], s5 offen sc1
    v_mfma_f32_16x16x32_bf16 v[40:43], a[156:159], a[28:31], v[40:43]
    buffer_load_dwordx4 v238, s[32:35], 0 offen lds
    v_mfma_f32_16x16x32_bf16 v[40:43], a[152:155], a[20:23], v[40:43]
    ds_read_b64_tr_b16 a[148:149], v254 offset:4096
    ds_read_b64_tr_b16 a[150:151], v254 offset:5120
    v_mfma_f32_16x16x32_bf16 v[24:27], a[160:163], a[16:19], v[24:27]
    ds_read_b64_tr_b16 a[152:153], v254 offset:8192
    v_mul_f32 v228, s17, v72
    v_mul_f32 v229, s17, v73
    v_mul_f32 v230, s17, v74
    v_mfma_f32_16x16x32_bf16 v[24:27], a[164:167], a[24:27], v[24:27]
    ds_read_b64_tr_b16 a[154:155], v254 offset:9216
    v_mul_f32 v231, s17, v75
    v_exp_f32 v228, v228
    v_mfma_f32_16x16x32_bf16 v[56:59], a[164:167], a[28:31], v[56:59]
    buffer_load_dwordx4 v238, s[32:35], s11 offen offset:1024 lds
    v_mfma_f32_16x16x32_bf16 v[56:59], a[160:163], a[20:23], v[56:59]
    ds_read_b64_tr_b16 a[156:157], v254 offset:12288
    ds_read_b64_tr_b16 a[158:159], v254 offset:13312
    v_mul_f32 v88, v72, v88
    s_waitcnt lgkmcnt(8)
    v_mfma_f32_16x16x32_bf16 v[12:15], a[128:131], a[16:19], v[12:15]
    v_subrev_u32 v253, 81920, v253
    ds_read_b64_tr_b16 a[160:161], v253
    v_exp_f32 v229, v229
    v_mul_f32 v89, v73, v89
    v_mfma_f32_16x16x32_bf16 v[12:15], a[132:135], a[24:27], v[12:15]
    ds_read_b64_tr_b16 a[162:163], v253 offset:1024
    v_exp_f32 v230, v230
    v_mul_f32 v90, v74, v90
    v_mfma_f32_16x16x32_bf16 v[44:47], a[132:135], a[28:31], v[44:47]
    buffer_load_dwordx4 v238, s[32:35], s12 offen offset:2048 lds
    v_mfma_f32_16x16x32_bf16 v[44:47], a[128:131], a[20:23], v[44:47]
    ds_read_b64_tr_b16 a[164:165], v253 offset:4096
    ds_read_b64_tr_b16 a[166:167], v253 offset:5120
    v_exp_f32 v231, v231
    v_mfma_f32_16x16x32_bf16 v[28:31], a[136:139], a[16:19], v[28:31]
    buffer_load_dwordx4 v238, s[32:35], s13 offen offset:3072 lds
    v_mfma_f32_16x16x32_bf16 v[28:31], a[140:143], a[24:27], v[28:31]
    ds_read_b64_tr_b16 a[128:129], v253 offset:8192
    ds_read_b64_tr_b16 a[130:131], v253 offset:9216
    v_mul_f32 v91, v75, v91
    v_add_f32 v228, 1.0, v228
    v_mfma_f32_16x16x32_bf16 v[60:63], a[140:143], a[28:31], v[60:63]
    ds_read_b64_tr_b16 a[132:133], v253 offset:12288
    s_add_u32 s42, s41, 8192
    v_add_f32 v229, 1.0, v229
    v_mfma_f32_16x16x32_bf16 v[60:63], a[136:139], a[20:23], v[60:63]
    ds_read_b64_tr_b16 a[134:135], v253 offset:13312
    v_add_f32 v230, 1.0, v230
    v_add_f32 v231, 1.0, v231
    s_waitcnt lgkmcnt(8)
    v_mfma_f32_16x16x32_bf16 v[0:3], a[144:147], a[32:35], v[0:3]
    v_subrev_u32 v233, 81920, v233
    ds_read_b64_tr_b16 a[136:137], v233
    v_rcp_f32 v228, v228
    v_rcp_f32 v229, v229
    v_mfma_f32_16x16x32_bf16 v[0:3], a[148:151], a[40:43], v[0:3]
    ds_read_b64_tr_b16 a[138:139], v233 offset:1024
    v_rcp_f32 v230, v230
    v_mfma_f32_16x16x32_bf16 v[32:35], a[148:151], a[44:47], v[32:35]
    buffer_load_dwordx4 v[144:147], v243, s[48:51], s42 offen sc1
    v_mfma_f32_16x16x32_bf16 v[32:35], a[144:147], a[36:39], v[32:35]
    ds_read_b64_tr_b16 a[140:141], v233 offset:4096
    ds_read_b64_tr_b16 a[142:143], v233 offset:5120
    v_rcp_f32 v231, v231
    v_mfma_f32_16x16x32_bf16 v[16:19], a[152:155], a[32:35], v[16:19]
    buffer_load_dwordx4 v[148:151], v240, s[48:51], s42 offen offset:1024 sc1
    v_mfma_f32_16x16x32_bf16 v[16:19], a[156:159], a[40:43], v[16:19]
    ds_read_b64_tr_b16 a[144:145], v233 offset:8192
    ds_read_b64_tr_b16 a[146:147], v233 offset:9216
    v_mul_f32 v88, v88, v228
    v_mul_f32 v89, v89, v229
    v_mfma_f32_16x16x32_bf16 v[48:51], a[156:159], a[44:47], v[48:51]
    ds_read_b64_tr_b16 a[148:149], v233 offset:12288
    v_mul_f32 v90, v90, v230
    v_mul_f32 v91, v91, v231
    v_cvt_pk_bf16_f32 v68, v88, v89
    v_mfma_f32_16x16x32_bf16 v[48:51], a[152:155], a[36:39], v[48:51]
    ds_read_b64_tr_b16 a[150:151], v233 offset:13312
    v_cvt_pk_bf16_f32 v69, v90, v91
    v_mul_f32 v228, s17, v76
    s_waitcnt lgkmcnt(8)
    v_mfma_f32_16x16x32_bf16 v[4:7], a[160:163], a[32:35], v[4:7]
    v_subrev_u32 v246, 81920, v246
    ds_read_b64_tr_b16 a[152:153], v246
    buffer_load_dwordx4 v[152:155], v243, s[48:51], s42 offen offset:2048 sc1
    v_mfma_f32_16x16x32_bf16 v[4:7], a[164:167], a[40:43], v[4:7]
    ds_read_b64_tr_b16 a[154:155], v246 offset:1024
    v_mul_f32 v229, s17, v77
    v_mul_f32 v230, s17, v78
    v_mfma_f32_16x16x32_bf16 v[36:39], a[164:167], a[44:47], v[36:39]
    ds_read_b64_tr_b16 a[156:157], v246 offset:4096
    v_mul_f32 v231, s17, v79
    v_exp_f32 v228, v228
    v_mfma_f32_16x16x32_bf16 v[36:39], a[160:163], a[36:39], v[36:39]
    ds_read_b64_tr_b16 a[158:159], v246 offset:5120
    v_mul_f32 v92, v76, v92
    v_exp_f32 v229, v229
    v_mfma_f32_16x16x32_bf16 v[20:23], a[128:131], a[32:35], v[20:23]
    buffer_load_dwordx4 v[156:159], v240, s[48:51], s42 offen offset:3072 sc1
    v_mfma_f32_16x16x32_bf16 v[20:23], a[132:135], a[40:43], v[20:23]
    ds_read_b64_tr_b16 a[160:161], v246 offset:8192
    ds_read_b64_tr_b16 a[162:163], v246 offset:9216
    v_mul_f32 v93, v77, v93
    v_mfma_f32_16x16x32_bf16 v[52:55], a[132:135], a[44:47], v[52:55]
    ds_read_b64_tr_b16 a[164:165], v246 offset:12288
    v_exp_f32 v230, v230
    v_mul_f32 v94, v78, v94
    v_mfma_f32_16x16x32_bf16 v[52:55], a[128:131], a[36:39], v[52:55]
    ds_read_b64_tr_b16 a[166:167], v246 offset:13312
    v_exp_f32 v231, v231
    v_mul_f32 v95, v79, v95
    s_waitcnt lgkmcnt(8)
    v_mfma_f32_16x16x32_bf16 v[8:11], a[136:139], a[32:35], v[8:11]
    ds_read_b64_tr_b16 a[128:129], v254 offset:16384
    s_add_u32 m0, s62, 81920
    v_add_u32 v238, 229376, v238
    v_add_f32 v228, 1.0, v228
    v_mfma_f32_16x16x32_bf16 v[8:11], a[140:143], a[40:43], v[8:11]
    ds_read_b64_tr_b16 a[130:131], v254 offset:17408
    v_add_f32 v229, 1.0, v229
    v_add_f32 v230, 1.0, v230
    v_mfma_f32_16x16x32_bf16 v[40:43], a[140:143], a[44:47], v[40:43]
    buffer_load_dwordx4 v238, s[32:35], 0 offen lds
    v_mfma_f32_16x16x32_bf16 v[40:43], a[136:139], a[36:39], v[40:43]
    ds_read_b64_tr_b16 a[132:133], v254 offset:20480
    ds_read_b64_tr_b16 a[134:135], v254 offset:21504
    v_add_f32 v231, 1.0, v231
    v_mfma_f32_16x16x32_bf16 v[24:27], a[144:147], a[32:35], v[24:27]
    v_rcp_f32 v228, v228
    v_rcp_f32 v229, v229
    v_mfma_f32_16x16x32_bf16 v[24:27], a[148:151], a[40:43], v[24:27]
    ds_read_b64_tr_b16 a[136:137], v254 offset:24576
    ds_read_b64_tr_b16 a[138:139], v254 offset:25600
    v_rcp_f32 v230, v230
    v_mfma_f32_16x16x32_bf16 v[56:59], a[148:151], a[44:47], v[56:59]
    buffer_load_dwordx4 v238, s[32:35], s11 offen offset:1024 lds
    v_mfma_f32_16x16x32_bf16 v[56:59], a[144:147], a[36:39], v[56:59]
    ds_read_b64_tr_b16 a[140:141], v254 offset:28672
    ds_read_b64_tr_b16 a[142:143], v254 offset:29696
    v_rcp_f32 v231, v231
    s_waitcnt lgkmcnt(8)
    v_mfma_f32_16x16x32_bf16 v[12:15], a[152:155], a[32:35], v[12:15]
    ds_read_b64_tr_b16 a[144:145], v253 offset:16384
    v_mul_f32 v92, v92, v228
    v_mul_f32 v93, v93, v229
    v_mul_f32 v94, v94, v230
    v_mfma_f32_16x16x32_bf16 v[12:15], a[156:159], a[40:43], v[12:15]
    ds_read_b64_tr_b16 a[146:147], v253 offset:17408
    v_mul_f32 v95, v95, v231
    v_cvt_pk_bf16_f32 v70, v92, v93
    v_mfma_f32_16x16x32_bf16 v[44:47], a[156:159], a[44:47], v[44:47]
    buffer_load_dwordx4 v238, s[32:35], s12 offen offset:2048 lds
    v_mfma_f32_16x16x32_bf16 v[44:47], a[152:155], a[36:39], v[44:47]
    ds_read_b64_tr_b16 a[148:149], v253 offset:20480
    ds_read_b64_tr_b16 a[150:151], v253 offset:21504
    v_cvt_pk_bf16_f32 v71, v94, v95
    v_mfma_f32_16x16x32_bf16 v[28:31], a[160:163], a[32:35], v[28:31]
    buffer_load_dwordx4 v238, s[32:35], s13 offen offset:3072 lds
    v_mfma_f32_16x16x32_bf16 v[28:31], a[164:167], a[40:43], v[28:31]
    ds_read_b64_tr_b16 a[152:153], v253 offset:24576
    ds_read_b64_tr_b16 a[154:155], v253 offset:25600
    v_mfma_f32_16x16x32_bf16 v[60:63], a[164:167], a[44:47], v[60:63]
    ds_read_b64_tr_b16 a[156:157], v253 offset:28672
    ds_read_b64_tr_b16 a[158:159], v253 offset:29696
    s_add_u32 s42, s41, 12288
    v_mfma_f32_16x16x32_bf16 v[60:63], a[160:163], a[36:39], v[60:63]
    buffer_store_dwordx4 v[68:71], v250, s[48:51], s5 offen offset:256 sc1
    s_waitcnt lgkmcnt(8)
    v_mfma_f32_16x16x32_bf16 v[0:3], a[128:131], a[48:51], v[0:3]
    ds_read_b64_tr_b16 a[160:161], v233 offset:16384
    v_lshl_add_u32 v236, v255, 4, s20
    v_mfma_f32_16x16x32_bf16 v[0:3], a[132:135], a[56:59], v[0:3]
    ds_read_b64_tr_b16 a[162:163], v233 offset:17408
    v_mfma_f32_16x16x32_bf16 v[32:35], a[132:135], a[60:63], v[32:35]
    buffer_load_dwordx4 v[160:163], v243, s[48:51], s42 offen sc1
    v_mfma_f32_16x16x32_bf16 v[32:35], a[128:131], a[52:55], v[32:35]
    ds_read_b64_tr_b16 a[164:165], v233 offset:20480
    ds_read_b64_tr_b16 a[166:167], v233 offset:21504
    v_mfma_f32_16x16x32_bf16 v[16:19], a[136:139], a[48:51], v[16:19]
    buffer_load_dwordx4 v[164:167], v240, s[48:51], s42 offen offset:1024 sc1
    v_mfma_f32_16x16x32_bf16 v[16:19], a[140:143], a[56:59], v[16:19]
    ds_read_b64_tr_b16 a[128:129], v233 offset:24576
    ds_read_b64_tr_b16 a[130:131], v233 offset:25600
    v_mfma_f32_16x16x32_bf16 v[48:51], a[140:143], a[60:63], v[48:51]
    ds_read_b64_tr_b16 a[132:133], v233 offset:28672
    v_mfma_f32_16x16x32_bf16 v[48:51], a[136:139], a[52:55], v[48:51]
    ds_read_b64_tr_b16 a[134:135], v233 offset:29696
    s_waitcnt lgkmcnt(8)
    v_mfma_f32_16x16x32_bf16 v[4:7], a[144:147], a[48:51], v[4:7]
    buffer_load_dwordx4 v[168:171], v243, s[48:51], s42 offen offset:2048 sc1
    v_mfma_f32_16x16x32_bf16 v[4:7], a[148:151], a[56:59], v[4:7]
    ds_read_b64_tr_b16 a[136:137], v246 offset:16384
    ds_read_b64_tr_b16 a[138:139], v246 offset:17408
    v_mfma_f32_16x16x32_bf16 v[36:39], a[148:151], a[60:63], v[36:39]
    ds_read_b64_tr_b16 a[140:141], v246 offset:20480
    v_lshl_add_u32 v245, v255, 4, s23
    v_mfma_f32_16x16x32_bf16 v[36:39], a[144:147], a[52:55], v[36:39]
    ds_read_b64_tr_b16 a[142:143], v246 offset:21504
    v_mfma_f32_16x16x32_bf16 v[20:23], a[152:155], a[48:51], v[20:23]
    buffer_load_dwordx4 v[172:175], v240, s[48:51], s42 offen offset:3072 sc1
    v_mfma_f32_16x16x32_bf16 v[20:23], a[156:159], a[56:59], v[20:23]
    ds_read_b64_tr_b16 a[144:145], v246 offset:24576
    ds_read_b64_tr_b16 a[146:147], v246 offset:25600
    v_mfma_f32_16x16x32_bf16 v[52:55], a[156:159], a[60:63], v[52:55]
    ds_read_b64_tr_b16 a[148:149], v246 offset:28672
    v_mfma_f32_16x16x32_bf16 v[52:55], a[152:155], a[52:55], v[52:55]
    ds_read_b64_tr_b16 a[150:151], v246 offset:29696
    s_waitcnt vmcnt(23)
    s_barrier
    s_waitcnt lgkmcnt(8)
    v_mfma_f32_16x16x32_bf16 v[8:11], a[160:163], a[48:51], v[8:11]
    ds_read_b64_tr_b16 a[152:153], v254 offset:32768
    s_add_u32 s42, s40, 32768
    v_mfma_f32_16x16x32_bf16 v[8:11], a[164:167], a[56:59], v[8:11]
    ds_read_b64_tr_b16 a[154:155], v254 offset:33792
    v_mfma_f32_16x16x32_bf16 v[40:43], a[164:167], a[60:63], v[40:43]
    buffer_load_dwordx4 v[176:179], v243, s[48:51], s42 offen sc1
    v_mfma_f32_16x16x32_bf16 v[40:43], a[160:163], a[52:55], v[40:43]
    ds_read_b64_tr_b16 a[156:157], v254 offset:36864
    ds_read_b64_tr_b16 a[158:159], v254 offset:37888
    v_mfma_f32_16x16x32_bf16 v[24:27], a[128:131], a[48:51], v[24:27]
    ds_read_b64_tr_b16 a[160:161], v254 offset:40960
    v_and_b32 v244, 7, v255
    v_mfma_f32_16x16x32_bf16 v[24:27], a[132:135], a[56:59], v[24:27]
    ds_read_b64_tr_b16 a[162:163], v254 offset:41984
    v_mfma_f32_16x16x32_bf16 v[56:59], a[132:135], a[60:63], v[56:59]
    buffer_load_dwordx4 v[180:183], v240, s[48:51], s42 offen offset:1024 sc1
    v_mfma_f32_16x16x32_bf16 v[56:59], a[128:131], a[52:55], v[56:59]
    ds_read_b64_tr_b16 a[164:165], v254 offset:45056
    ds_read_b64_tr_b16 a[166:167], v254 offset:46080
    s_waitcnt lgkmcnt(8)
    v_mfma_f32_16x16x32_bf16 v[12:15], a[136:139], a[48:51], v[12:15]
    buffer_load_dwordx4 v[184:187], v243, s[48:51], s42 offen offset:2048 sc1
    v_mfma_f32_16x16x32_bf16 v[12:15], a[140:143], a[56:59], v[12:15]
    ds_read_b64_tr_b16 a[128:129], v253 offset:32768
    ds_read_b64_tr_b16 a[130:131], v253 offset:33792
    v_mfma_f32_16x16x32_bf16 v[44:47], a[140:143], a[60:63], v[44:47]
    ds_read_b64_tr_b16 a[132:133], v253 offset:36864
    v_mfma_f32_16x16x32_bf16 v[44:47], a[136:139], a[52:55], v[44:47]
    ds_read_b64_tr_b16 a[134:135], v253 offset:37888
    v_mfma_f32_16x16x32_bf16 v[28:31], a[144:147], a[48:51], v[28:31]
    buffer_load_dwordx4 v[188:191], v240, s[48:51], s42 offen offset:3072 sc1
    v_mfma_f32_16x16x32_bf16 v[28:31], a[148:151], a[56:59], v[28:31]
    ds_read_b64_tr_b16 a[136:137], v253 offset:40960
    ds_read_b64_tr_b16 a[138:139], v253 offset:41984
    v_mfma_f32_16x16x32_bf16 v[60:63], a[148:151], a[60:63], v[60:63]
    ds_read_b64_tr_b16 a[140:141], v253 offset:45056
    s_add_u32 s42, s40, 36864
    v_mfma_f32_16x16x32_bf16 v[60:63], a[144:147], a[52:55], v[60:63]
    ds_read_b64_tr_b16 a[142:143], v253 offset:46080
    s_waitcnt lgkmcnt(8)
    v_mfma_f32_16x16x32_bf16 v[0:3], a[152:155], a[64:67], v[0:3]
    buffer_load_dwordx4 v[192:195], v243, s[48:51], s42 offen sc1
    v_mfma_f32_16x16x32_bf16 v[0:3], a[156:159], a[72:75], v[0:3]
    ds_read_b64_tr_b16 a[144:145], v233 offset:32768
    ds_read_b64_tr_b16 a[146:147], v233 offset:33792
    v_mfma_f32_16x16x32_bf16 v[32:35], a[156:159], a[76:79], v[32:35]
    ds_read_b64_tr_b16 a[148:149], v233 offset:36864
    v_lshrrev_b32 v252, 2, v244
    v_mfma_f32_16x16x32_bf16 v[32:35], a[152:155], a[68:71], v[32:35]
    ds_read_b64_tr_b16 a[150:151], v233 offset:37888
    v_mfma_f32_16x16x32_bf16 v[16:19], a[160:163], a[64:67], v[16:19]
    buffer_load_dwordx4 v[196:199], v240, s[48:51], s42 offen offset:1024 sc1
    v_mfma_f32_16x16x32_bf16 v[16:19], a[164:167], a[72:75], v[16:19]
    ds_read_b64_tr_b16 a[152:153], v233 offset:40960
    ds_read_b64_tr_b16 a[154:155], v233 offset:41984
    v_mfma_f32_16x16x32_bf16 v[48:51], a[164:167], a[76:79], v[48:51]
    ds_read_b64_tr_b16 a[156:157], v233 offset:45056
    v_mfma_f32_16x16x32_bf16 v[48:51], a[160:163], a[68:71], v[48:51]
    ds_read_b64_tr_b16 a[158:159], v233 offset:46080
    s_waitcnt lgkmcnt(8)
    v_mfma_f32_16x16x32_bf16 v[4:7], a[128:131], a[64:67], v[4:7]
    buffer_load_dwordx4 v[200:203], v243, s[48:51], s42 offen offset:2048 sc1
    v_mfma_f32_16x16x32_bf16 v[4:7], a[132:135], a[72:75], v[4:7]
    ds_read_b64_tr_b16 a[160:161], v246 offset:32768
    ds_read_b64_tr_b16 a[162:163], v246 offset:33792
    v_mfma_f32_16x16x32_bf16 v[36:39], a[132:135], a[76:79], v[36:39]
    ds_read_b64_tr_b16 a[164:165], v246 offset:36864
    v_lshl_add_u32 v244, v244, 2, s21
    v_mfma_f32_16x16x32_bf16 v[36:39], a[128:131], a[68:71], v[36:39]
    ds_read_b64_tr_b16 a[166:167], v246 offset:37888
    v_mfma_f32_16x16x32_bf16 v[20:23], a[136:139], a[64:67], v[20:23]
    ds_read_b64_tr_b16 a[128:129], v246 offset:40960
    buffer_load_dwordx4 v[204:207], v240, s[48:51], s42 offen offset:3072 sc1
    v_mfma_f32_16x16x32_bf16 v[20:23], a[140:143], a[72:75], v[20:23]
    ds_read_b64_tr_b16 a[130:131], v246 offset:41984
    buffer_load_dword v242, v244, s[48:51], 0 offen offset:128 sc1
    v_mfma_f32_16x16x32_bf16 v[52:55], a[140:143], a[76:79], v[52:55]
    ds_read_b64_tr_b16 a[132:133], v246 offset:45056
    v_mfma_f32_16x16x32_bf16 v[52:55], a[136:139], a[68:71], v[52:55]
    ds_read_b64_tr_b16 a[134:135], v246 offset:46080
    s_waitcnt lgkmcnt(8)
    v_mfma_f32_16x16x32_bf16 v[8:11], a[144:147], a[64:67], v[8:11]
    ds_read_b64_tr_b16 a[136:137], v254 offset:49152
    ds_read_b64_tr_b16 a[138:139], v254 offset:50176
    s_add_u32 s42, s40, 40960
    s_waitcnt vmcnt(13)
    v_mfma_f32_16x16x32_bf16 v[8:11], a[148:151], a[72:75], v[8:11]
    buffer_store_dword v241, v248, s[48:51], 0 offen offset:256 sc1
    v_mfma_f32_16x16x32_bf16 v[40:43], a[148:151], a[76:79], v[40:43]
    buffer_load_dwordx4 v[208:211], v243, s[48:51], s42 offen sc1
    v_mfma_f32_16x16x32_bf16 v[40:43], a[144:147], a[68:71], v[40:43]
    ds_read_b64_tr_b16 a[140:141], v254 offset:53248
    ds_read_b64_tr_b16 a[142:143], v254 offset:54272
    v_mfma_f32_16x16x32_bf16 v[24:27], a[152:155], a[64:67], v[24:27]
    ds_read_b64_tr_b16 a[144:145], v254 offset:57344
    v_mfma_f32_16x16x32_bf16 v[24:27], a[156:159], a[72:75], v[24:27]
    ds_read_b64_tr_b16 a[146:147], v254 offset:58368
    v_mfma_f32_16x16x32_bf16 v[56:59], a[156:159], a[76:79], v[56:59]
    buffer_load_dwordx4 v[212:215], v240, s[48:51], s42 offen offset:1024 sc1
    v_mfma_f32_16x16x32_bf16 v[56:59], a[152:155], a[68:71], v[56:59]
    ds_read_b64_tr_b16 a[148:149], v254 offset:61440
    ds_read_b64_tr_b16 a[150:151], v254 offset:62464
    s_waitcnt lgkmcnt(8)
    v_mfma_f32_16x16x32_bf16 v[12:15], a[160:163], a[64:67], v[12:15]
    buffer_load_dwordx4 v[216:219], v243, s[48:51], s42 offen offset:2048 sc1
    v_mfma_f32_16x16x32_bf16 v[12:15], a[164:167], a[72:75], v[12:15]
    ds_read_b64_tr_b16 a[152:153], v253 offset:49152
    ds_read_b64_tr_b16 a[154:155], v253 offset:50176
    v_mfma_f32_16x16x32_bf16 v[44:47], a[164:167], a[76:79], v[44:47]
    ds_read_b64_tr_b16 a[156:157], v253 offset:53248
    v_mfma_f32_16x16x32_bf16 v[44:47], a[160:163], a[68:71], v[44:47]
    ds_read_b64_tr_b16 a[158:159], v253 offset:54272
    v_mfma_f32_16x16x32_bf16 v[28:31], a[128:131], a[64:67], v[28:31]
    buffer_load_dwordx4 v[220:223], v240, s[48:51], s42 offen offset:3072 sc1
    v_mfma_f32_16x16x32_bf16 v[28:31], a[132:135], a[72:75], v[28:31]
    ds_read_b64_tr_b16 a[160:161], v253 offset:57344
    ds_read_b64_tr_b16 a[162:163], v253 offset:58368
    v_mfma_f32_16x16x32_bf16 v[60:63], a[132:135], a[76:79], v[60:63]
    ds_read_b64_tr_b16 a[164:165], v253 offset:61440
    s_add_u32 s42, s40, 45056
    v_mfma_f32_16x16x32_bf16 v[60:63], a[128:131], a[68:71], v[60:63]
    ds_read_b64_tr_b16 a[166:167], v253 offset:62464
    s_waitcnt lgkmcnt(8)
    v_mfma_f32_16x16x32_bf16 v[0:3], a[136:139], a[80:83], v[0:3]
    buffer_load_dwordx4 a[0:3], v243, s[48:51], s42 offen sc1
    v_mfma_f32_16x16x32_bf16 v[0:3], a[140:143], a[88:91], v[0:3]
    ds_read_b64_tr_b16 a[128:129], v233 offset:49152
    ds_read_b64_tr_b16 a[130:131], v233 offset:50176
    v_mfma_f32_16x16x32_bf16 v[32:35], a[140:143], a[92:95], v[32:35]
    ds_read_b64_tr_b16 a[132:133], v233 offset:53248
    v_mfma_f32_16x16x32_bf16 v[32:35], a[136:139], a[84:87], v[32:35]
    ds_read_b64_tr_b16 a[134:135], v233 offset:54272
    v_mfma_f32_16x16x32_bf16 v[16:19], a[144:147], a[80:83], v[16:19]
    buffer_load_dwordx4 a[4:7], v240, s[48:51], s42 offen offset:1024 sc1
    v_mfma_f32_16x16x32_bf16 v[16:19], a[148:151], a[88:91], v[16:19]
    ds_read_b64_tr_b16 a[136:137], v233 offset:57344
    ds_read_b64_tr_b16 a[138:139], v233 offset:58368
    v_mfma_f32_16x16x32_bf16 v[48:51], a[148:151], a[92:95], v[48:51]
    ds_read_b64_tr_b16 a[140:141], v233 offset:61440
    v_mfma_f32_16x16x32_bf16 v[48:51], a[144:147], a[84:87], v[48:51]
    ds_read_b64_tr_b16 a[142:143], v233 offset:62464
    s_waitcnt lgkmcnt(8)
    v_mfma_f32_16x16x32_bf16 v[4:7], a[152:155], a[80:83], v[4:7]
    buffer_load_dwordx4 a[8:11], v243, s[48:51], s42 offen offset:2048 sc1
    v_mfma_f32_16x16x32_bf16 v[4:7], a[156:159], a[88:91], v[4:7]
    ds_read_b64_tr_b16 a[144:145], v246 offset:49152
    ds_read_b64_tr_b16 a[146:147], v246 offset:50176
    v_mfma_f32_16x16x32_bf16 v[36:39], a[156:159], a[92:95], v[36:39]
    ds_read_b64_tr_b16 a[148:149], v246 offset:53248
    v_mfma_f32_16x16x32_bf16 v[36:39], a[152:155], a[84:87], v[36:39]
    ds_read_b64_tr_b16 a[150:151], v246 offset:54272
    v_mfma_f32_16x16x32_bf16 v[20:23], a[160:163], a[80:83], v[20:23]
    ds_read_b64_tr_b16 a[152:153], v246 offset:57344
    buffer_load_dwordx4 a[12:15], v240, s[48:51], s42 offen offset:3072 sc1
    v_mfma_f32_16x16x32_bf16 v[20:23], a[164:167], a[88:91], v[20:23]
    ds_read_b64_tr_b16 a[154:155], v246 offset:58368
    s_waitcnt vmcnt(9)
    v_cmp_gt_u32 vcc, v252, v242
    s_cbranch_vccnz L_C_p5_slow
L_C_p5_ok:
    v_mfma_f32_16x16x32_bf16 v[52:55], a[164:167], a[92:95], v[52:55]
    ds_read_b64_tr_b16 a[156:157], v246 offset:61440
    v_mfma_f32_16x16x32_bf16 v[52:55], a[160:163], a[84:87], v[52:55]
    ds_read_b64_tr_b16 a[158:159], v246 offset:62464
    s_barrier
    s_waitcnt lgkmcnt(8)
    v_mfma_f32_16x16x32_bf16 v[8:11], a[128:131], a[80:83], v[8:11]
    v_add_u32 v254, 65536, v254
    ds_read_b64_tr_b16 a[160:161], v254
    s_add_u32 s3, s9, 0
    v_mfma_f32_16x16x32_bf16 v[8:11], a[132:135], a[88:91], v[8:11]
    ds_read_b64_tr_b16 a[162:163], v254 offset:1024
    v_mfma_f32_16x16x32_bf16 v[40:43], a[132:135], a[92:95], v[40:43]
    buffer_load_dwordx4 a[16:19], v236, s[48:51], s3 offen sc1
    v_mfma_f32_16x16x32_bf16 v[40:43], a[128:131], a[84:87], v[40:43]
    ds_read_b64_tr_b16 a[164:165], v254 offset:4096
    ds_read_b64_tr_b16 a[166:167], v254 offset:5120
    v_mfma_f32_16x16x32_bf16 v[24:27], a[136:139], a[80:83], v[24:27]
    ds_read_b64_tr_b16 a[128:129], v254 offset:8192
    v_mfma_f32_16x16x32_bf16 v[24:27], a[140:143], a[88:91], v[24:27]
    ds_read_b64_tr_b16 a[130:131], v254 offset:9216
    v_mfma_f32_16x16x32_bf16 v[56:59], a[140:143], a[92:95], v[56:59]
    buffer_load_dwordx4 a[20:23], v245, s[48:51], s3 offen sc1
    v_mfma_f32_16x16x32_bf16 v[56:59], a[136:139], a[84:87], v[56:59]
    ds_read_b64_tr_b16 a[132:133], v254 offset:12288
    ds_read_b64_tr_b16 a[134:135], v254 offset:13312
    s_waitcnt lgkmcnt(8)
    v_mfma_f32_16x16x32_bf16 v[12:15], a[144:147], a[80:83], v[12:15]
    v_add_u32 v253, 65536, v253
    ds_read_b64_tr_b16 a[136:137], v253
    buffer_load_dwordx4 a[24:27], v236, s[48:51], s3 offen offset:1024 sc1
    v_mfma_f32_16x16x32_bf16 v[12:15], a[148:151], a[88:91], v[12:15]
    ds_read_b64_tr_b16 a[138:139], v253 offset:1024
    v_mfma_f32_16x16x32_bf16 v[44:47], a[148:151], a[92:95], v[44:47]
    ds_read_b64_tr_b16 a[140:141], v253 offset:4096
    v_mfma_f32_16x16x32_bf16 v[44:47], a[144:147], a[84:87], v[44:47]
    ds_read_b64_tr_b16 a[142:143], v253 offset:5120
    v_mfma_f32_16x16x32_bf16 v[28:31], a[152:155], a[80:83], v[28:31]
    buffer_load_dwordx4 a[28:31], v245, s[48:51], s3 offen offset:1024 sc1
    v_mfma_f32_16x16x32_bf16 v[28:31], a[156:159], a[88:91], v[28:31]
    ds_read_b64_tr_b16 a[144:145], v253 offset:8192
    ds_read_b64_tr_b16 a[146:147], v253 offset:9216
    v_mfma_f32_16x16x32_bf16 v[60:63], a[156:159], a[92:95], v[60:63]
    ds_read_b64_tr_b16 a[148:149], v253 offset:12288
    s_add_u32 s3, s9, 2048
    v_mfma_f32_16x16x32_bf16 v[60:63], a[152:155], a[84:87], v[60:63]
    ds_read_b64_tr_b16 a[150:151], v253 offset:13312
    s_waitcnt lgkmcnt(8)
    v_mfma_f32_16x16x32_bf16 v[0:3], a[160:163], a[96:99], v[0:3]
    v_add_u32 v233, 65536, v233
    ds_read_b64_tr_b16 a[152:153], v233
    buffer_load_dwordx4 a[32:35], v236, s[48:51], s3 offen sc1
    v_mfma_f32_16x16x32_bf16 v[0:3], a[164:167], a[104:107], v[0:3]
    ds_read_b64_tr_b16 a[154:155], v233 offset:1024
    v_mfma_f32_16x16x32_bf16 v[32:35], a[164:167], a[108:111], v[32:35]
    ds_read_b64_tr_b16 a[156:157], v233 offset:4096
    v_mfma_f32_16x16x32_bf16 v[32:35], a[160:163], a[100:103], v[32:35]
    ds_read_b64_tr_b16 a[158:159], v233 offset:5120
    v_mfma_f32_16x16x32_bf16 v[16:19], a[128:131], a[96:99], v[16:19]
    buffer_load_dwordx4 a[36:39], v245, s[48:51], s3 offen sc1
    v_mfma_f32_16x16x32_bf16 v[16:19], a[132:135], a[104:107], v[16:19]
    ds_read_b64_tr_b16 a[160:161], v233 offset:8192
    ds_read_b64_tr_b16 a[162:163], v233 offset:9216
    v_mfma_f32_16x16x32_bf16 v[48:51], a[132:135], a[108:111], v[48:51]
    ds_read_b64_tr_b16 a[164:165], v233 offset:12288
    v_mfma_f32_16x16x32_bf16 v[48:51], a[128:131], a[100:103], v[48:51]
    ds_read_b64_tr_b16 a[166:167], v233 offset:13312
    s_waitcnt lgkmcnt(8)
    v_mfma_f32_16x16x32_bf16 v[4:7], a[136:139], a[96:99], v[4:7]
    v_add_u32 v246, 65536, v246
    ds_read_b64_tr_b16 a[128:129], v246
    buffer_load_dwordx4 a[40:43], v236, s[48:51], s3 offen offset:1024 sc1
    v_mfma_f32_16x16x32_bf16 v[4:7], a[140:143], a[104:107], v[4:7]
    ds_read_b64_tr_b16 a[130:131], v246 offset:1024
    v_mfma_f32_16x16x32_bf16 v[36:39], a[140:143], a[108:111], v[36:39]
    ds_read_b64_tr_b16 a[132:133], v246 offset:4096
    v_mfma_f32_16x16x32_bf16 v[36:39], a[136:139], a[100:103], v[36:39]
    ds_read_b64_tr_b16 a[134:135], v246 offset:5120
    v_mfma_f32_16x16x32_bf16 v[20:23], a[144:147], a[96:99], v[20:23]
    buffer_load_dwordx4 a[44:47], v245, s[48:51], s3 offen offset:1024 sc1
    v_mfma_f32_16x16x32_bf16 v[20:23], a[148:151], a[104:107], v[20:23]
    ds_read_b64_tr_b16 a[136:137], v246 offset:8192
    ds_read_b64_tr_b16 a[138:139], v246 offset:9216
    v_mfma_f32_16x16x32_bf16 v[52:55], a[148:151], a[108:111], v[52:55]
    ds_read_b64_tr_b16 a[140:141], v246 offset:12288
    v_mfma_f32_16x16x32_bf16 v[52:55], a[144:147], a[100:103], v[52:55]
    ds_read_b64_tr_b16 a[142:143], v246 offset:13312
    s_barrier
    s_waitcnt lgkmcnt(8)
    v_mfma_f32_16x16x32_bf16 v[8:11], a[152:155], a[96:99], v[8:11]
    ds_read_b64_tr_b16 a[144:145], v254 offset:16384
    s_add_u32 s3, s9, 4096
    v_mfma_f32_16x16x32_bf16 v[8:11], a[156:159], a[104:107], v[8:11]
    ds_read_b64_tr_b16 a[146:147], v254 offset:17408
    v_mfma_f32_16x16x32_bf16 v[40:43], a[156:159], a[108:111], v[40:43]
    buffer_load_dwordx4 a[48:51], v236, s[48:51], s3 offen sc1
    v_mfma_f32_16x16x32_bf16 v[40:43], a[152:155], a[100:103], v[40:43]
    ds_read_b64_tr_b16 a[148:149], v254 offset:20480
    ds_read_b64_tr_b16 a[150:151], v254 offset:21504
    v_mfma_f32_16x16x32_bf16 v[24:27], a[160:163], a[96:99], v[24:27]
    ds_read_b64_tr_b16 a[152:153], v254 offset:24576
    v_mfma_f32_16x16x32_bf16 v[24:27], a[164:167], a[104:107], v[24:27]
    ds_read_b64_tr_b16 a[154:155], v254 offset:25600
    v_mfma_f32_16x16x32_bf16 v[56:59], a[164:167], a[108:111], v[56:59]
    buffer_load_dwordx4 a[52:55], v245, s[48:51], s3 offen sc1
    v_mfma_f32_16x16x32_bf16 v[56:59], a[160:163], a[100:103], v[56:59]
    ds_read_b64_tr_b16 a[156:157], v254 offset:28672
    ds_read_b64_tr_b16 a[158:159], v254 offset:29696
    s_waitcnt lgkmcnt(8)
    v_mfma_f32_16x16x32_bf16 v[12:15], a[128:131], a[96:99], v[12:15]
    ds_read_b64_tr_b16 a[160:161], v253 offset:16384
    v_mfma_f32_16x16x32_bf16 v[12:15], a[132:135], a[104:107], v[12:15]
    ds_read_b64_tr_b16 a[162:163], v253 offset:17408
    v_mfma_f32_16x16x32_bf16 v[44:47], a[132:135], a[108:111], v[44:47]
    buffer_load_dwordx4 a[56:59], v236, s[48:51], s3 offen offset:1024 sc1
    v_mfma_f32_16x16x32_bf16 v[44:47], a[128:131], a[100:103], v[44:47]
    ds_read_b64_tr_b16 a[164:165], v253 offset:20480
    ds_read_b64_tr_b16 a[166:167], v253 offset:21504
    v_mfma_f32_16x16x32_bf16 v[28:31], a[136:139], a[96:99], v[28:31]
    buffer_load_dwordx4 a[60:63], v245, s[48:51], s3 offen offset:1024 sc1
    v_mfma_f32_16x16x32_bf16 v[28:31], a[140:143], a[104:107], v[28:31]
    ds_read_b64_tr_b16 a[128:129], v253 offset:24576
    ds_read_b64_tr_b16 a[130:131], v253 offset:25600
    v_mfma_f32_16x16x32_bf16 v[60:63], a[140:143], a[108:111], v[60:63]
    ds_read_b64_tr_b16 a[132:133], v253 offset:28672
    v_mfma_f32_16x16x32_bf16 v[60:63], a[136:139], a[100:103], v[60:63]
    ds_read_b64_tr_b16 a[134:135], v253 offset:29696
    s_waitcnt lgkmcnt(8)
    v_mfma_f32_16x16x32_bf16 v[0:3], a[144:147], a[112:115], v[0:3]
    ds_read_b64_tr_b16 a[136:137], v233 offset:16384
    ds_read_b64_tr_b16 a[138:139], v233 offset:17408
    s_add_u32 s3, s9, 6144
    v_mfma_f32_16x16x32_bf16 v[0:3], a[148:151], a[120:123], v[0:3]
    buffer_load_dword v242, v244, s[48:51], 0 offen offset:256 sc1
    v_mfma_f32_16x16x32_bf16 v[32:35], a[148:151], a[124:127], v[32:35]
    buffer_load_dwordx4 a[64:67], v236, s[48:51], s3 offen sc1
    v_mfma_f32_16x16x32_bf16 v[32:35], a[144:147], a[116:119], v[32:35]
    ds_read_b64_tr_b16 a[140:141], v233 offset:20480
    ds_read_b64_tr_b16 a[142:143], v233 offset:21504
    v_mfma_f32_16x16x32_bf16 v[16:19], a[152:155], a[112:115], v[16:19]
    ds_read_b64_tr_b16 a[144:145], v233 offset:24576
    v_mfma_f32_16x16x32_bf16 v[16:19], a[156:159], a[120:123], v[16:19]
    ds_read_b64_tr_b16 a[146:147], v233 offset:25600
    v_mfma_f32_16x16x32_bf16 v[48:51], a[156:159], a[124:127], v[48:51]
    buffer_load_dwordx4 a[68:71], v245, s[48:51], s3 offen sc1
    v_mfma_f32_16x16x32_bf16 v[48:51], a[152:155], a[116:119], v[48:51]
    ds_read_b64_tr_b16 a[148:149], v233 offset:28672
    ds_read_b64_tr_b16 a[150:151], v233 offset:29696
    s_waitcnt lgkmcnt(8)
    v_mfma_f32_16x16x32_bf16 v[4:7], a[160:163], a[112:115], v[4:7]
    buffer_load_dwordx4 a[72:75], v236, s[48:51], s3 offen offset:1024 sc1
    v_mfma_f32_16x16x32_bf16 v[4:7], a[164:167], a[120:123], v[4:7]
    ds_read_b64_tr_b16 a[152:153], v246 offset:16384
    ds_read_b64_tr_b16 a[154:155], v246 offset:17408
    v_mfma_f32_16x16x32_bf16 v[36:39], a[164:167], a[124:127], v[36:39]
    ds_read_b64_tr_b16 a[156:157], v246 offset:20480
    v_mfma_f32_16x16x32_bf16 v[36:39], a[160:163], a[116:119], v[36:39]
    ds_read_b64_tr_b16 a[158:159], v246 offset:21504
    v_mfma_f32_16x16x32_bf16 v[20:23], a[128:131], a[112:115], v[20:23]
    buffer_load_dwordx4 a[76:79], v245, s[48:51], s3 offen offset:1024 sc1
    v_mfma_f32_16x16x32_bf16 v[20:23], a[132:135], a[120:123], v[20:23]
    ds_read_b64_tr_b16 a[160:161], v246 offset:24576
    ds_read_b64_tr_b16 a[162:163], v246 offset:25600
    v_mfma_f32_16x16x32_bf16 v[52:55], a[132:135], a[124:127], v[52:55]
    ds_read_b64_tr_b16 a[164:165], v246 offset:28672
    s_add_u32 m0, s62, 114688
    v_mfma_f32_16x16x32_bf16 v[52:55], a[128:131], a[116:119], v[52:55]
    ds_read_b64_tr_b16 a[166:167], v246 offset:29696
    s_waitcnt lgkmcnt(8)
    v_mfma_f32_16x16x32_bf16 v[8:11], a[136:139], a[112:115], v[8:11]
    s_add_u32 s42, s40, 16384
    v_mfma_f32_16x16x32_bf16 v[8:11], a[140:143], a[120:123], v[8:11]
    v_mfma_f32_16x16x32_bf16 v[40:43], a[140:143], a[124:127], v[40:43]
    buffer_load_dwordx4 v243, s[48:51], s42 offen sc1 lds
    v_mfma_f32_16x16x32_bf16 v[40:43], a[136:139], a[116:119], v[40:43]
    v_mfma_f32_16x16x32_bf16 v[24:27], a[144:147], a[112:115], v[24:27]
    v_mov_b32 v224, 0xbfb8aa3b
    v_mfma_f32_16x16x32_bf16 v[24:27], a[148:151], a[120:123], v[24:27]
    v_mov_b32 v225, 0xbfb8aa3b
    v_mfma_f32_16x16x32_bf16 v[56:59], a[148:151], a[124:127], v[56:59]
    buffer_load_dwordx4 v240, s[48:51], s42 offen offset:1024 sc1 lds
    v_mfma_f32_16x16x32_bf16 v[56:59], a[144:147], a[116:119], v[56:59]
    s_waitcnt lgkmcnt(0)
    v_mfma_f32_16x16x32_bf16 v[12:15], a[152:155], a[112:115], v[12:15]
    v_mov_b32 v226, 1.0
    v_mfma_f32_16x16x32_bf16 v[12:15], a[156:159], a[120:123], v[12:15]
    v_mfma_f32_16x16x32_bf16 v[44:47], a[156:159], a[124:127], v[44:47]
    buffer_load_dwordx4 v243, s[48:51], s42 offen offset:2048 sc1 lds
    v_mfma_f32_16x16x32_bf16 v[44:47], a[152:155], a[116:119], v[44:47]
    v_mfma_f32_16x16x32_bf16 v[28:31], a[160:163], a[112:115], v[28:31]
    v_mov_b32 v227, 1.0
    v_mfma_f32_16x16x32_bf16 v[28:31], a[164:167], a[120:123], v[28:31]
    v_mfma_f32_16x16x32_bf16 v[60:63], a[164:167], a[124:127], v[60:63]
    buffer_load_dwordx4 v240, s[48:51], s42 offen offset:3072 sc1 lds
    v_mfma_f32_16x16x32_bf16 v[60:63], a[160:163], a[116:119], v[60:63]
    s_waitcnt vmcnt(8)
    v_cmp_gt_u32 vcc, v252, v242
    s_cbranch_vccnz L_C_p6_slow
L_C_p6_ok:
    s_add_u32 s3, s9, 24576
    buffer_load_dwordx4 a[128:131], v236, s[48:51], s3 offen sc1
    v_pk_mul_f32 v[228:229], v[0:1], v[224:225]
    v_pk_mul_f32 v[230:231], v[2:3], v[224:225]
    v_exp_f32 v228, v228
    v_exp_f32 v229, v229
    v_exp_f32 v230, v230
    v_exp_f32 v231, v231
    v_pk_mul_f32 v[16:17], v[0:1], v[16:17]
    v_pk_mul_f32 v[18:19], v[2:3], v[18:19]
    v_pk_add_f32 v[228:229], v[228:229], v[226:227]
    v_pk_add_f32 v[230:231], v[230:231], v[226:227]
    v_rcp_f32 v228, v228
    v_rcp_f32 v229, v229
    v_rcp_f32 v230, v230
    buffer_load_dwordx4 a[132:135], v245, s[48:51], s3 offen sc1
    v_rcp_f32 v231, v231
    v_pk_mul_f32 v[16:17], v[16:17], v[228:229]
    v_pk_mul_f32 v[18:19], v[18:19], v[230:231]
    v_cvt_pk_bf16_f32 v0, v16, v17
    v_cvt_pk_bf16_f32 v1, v18, v19
    v_pk_mul_f32 v[228:229], v[4:5], v[224:225]
    v_pk_mul_f32 v[230:231], v[6:7], v[224:225]
    v_exp_f32 v228, v228
    v_exp_f32 v229, v229
    v_exp_f32 v230, v230
    v_exp_f32 v231, v231
    v_pk_mul_f32 v[20:21], v[4:5], v[20:21]
    v_pk_mul_f32 v[22:23], v[6:7], v[22:23]
    buffer_load_dwordx4 a[136:139], v236, s[48:51], s3 offen offset:1024 sc1
    v_pk_add_f32 v[228:229], v[228:229], v[226:227]
    v_pk_add_f32 v[230:231], v[230:231], v[226:227]
    v_rcp_f32 v228, v228
    v_rcp_f32 v229, v229
    v_rcp_f32 v230, v230
    v_rcp_f32 v231, v231
    v_pk_mul_f32 v[20:21], v[20:21], v[228:229]
    v_pk_mul_f32 v[22:23], v[22:23], v[230:231]
    v_cvt_pk_bf16_f32 v2, v20, v21
    v_cvt_pk_bf16_f32 v3, v22, v23
    buffer_store_dwordx4 v[0:3], v251, s[48:51], s6 offen sc1
    v_pk_mul_f32 v[228:229], v[8:9], v[224:225]
    v_pk_mul_f32 v[230:231], v[10:11], v[224:225]
    buffer_load_dwordx4 a[140:143], v245, s[48:51], s3 offen offset:1024 sc1
    v_exp_f32 v228, v228
    v_exp_f32 v229, v229
    v_exp_f32 v230, v230
    v_exp_f32 v231, v231
    v_pk_mul_f32 v[24:25], v[8:9], v[24:25]
    v_pk_mul_f32 v[26:27], v[10:11], v[26:27]
    v_pk_add_f32 v[228:229], v[228:229], v[226:227]
    v_pk_add_f32 v[230:231], v[230:231], v[226:227]
    v_rcp_f32 v228, v228
    v_rcp_f32 v229, v229
    v_rcp_f32 v230, v230
    v_rcp_f32 v231, v231
    v_pk_mul_f32 v[24:25], v[24:25], v[228:229]
    s_add_u32 s3, s9, 26624
    buffer_load_dwordx4 a[144:147], v236, s[48:51], s3 offen sc1
    v_pk_mul_f32 v[26:27], v[26:27], v[230:231]
    v_cvt_pk_bf16_f32 v4, v24, v25
    v_cvt_pk_bf16_f32 v5, v26, v27
    v_pk_mul_f32 v[228:229], v[12:13], v[224:225]
    v_pk_mul_f32 v[230:231], v[14:15], v[224:225]
    v_exp_f32 v228, v228
    v_exp_f32 v229, v229
    v_exp_f32 v230, v230
    v_exp_f32 v231, v231
    v_pk_mul_f32 v[28:29], v[12:13], v[28:29]
    v_pk_mul_f32 v[30:31], v[14:15], v[30:31]
    v_pk_add_f32 v[228:229], v[228:229], v[226:227]
    v_pk_add_f32 v[230:231], v[230:231], v[226:227]
    buffer_load_dwordx4 a[148:151], v245, s[48:51], s3 offen sc1
    v_rcp_f32 v228, v228
    v_rcp_f32 v229, v229
    v_rcp_f32 v230, v230
    v_rcp_f32 v231, v231
    v_pk_mul_f32 v[28:29], v[28:29], v[228:229]
    v_pk_mul_f32 v[30:31], v[30:31], v[230:231]
    v_cvt_pk_bf16_f32 v6, v28, v29
    v_cvt_pk_bf16_f32 v7, v30, v31
    buffer_store_dwordx4 v[4:7], v251, s[48:51], s6 offen offset:1024 sc1
    v_pk_mul_f32 v[228:229], v[32:33], v[224:225]
    v_pk_mul_f32 v[230:231], v[34:35], v[224:225]
    v_exp_f32 v228, v228
    v_exp_f32 v229, v229
    buffer_load_dwordx4 a[152:155], v236, s[48:51], s3 offen offset:1024 sc1
    v_exp_f32 v230, v230
    v_exp_f32 v231, v231
    v_pk_mul_f32 v[48:49], v[32:33], v[48:49]
    v_pk_mul_f32 v[50:51], v[34:35], v[50:51]
    v_pk_add_f32 v[228:229], v[228:229], v[226:227]
    v_pk_add_f32 v[230:231], v[230:231], v[226:227]
    v_rcp_f32 v228, v228
    v_rcp_f32 v229, v229
    v_rcp_f32 v230, v230
    v_rcp_f32 v231, v231
    v_pk_mul_f32 v[48:49], v[48:49], v[228:229]
    v_pk_mul_f32 v[50:51], v[50:51], v[230:231]
    v_cvt_pk_bf16_f32 v32, v48, v49
    buffer_load_dwordx4 a[156:159], v245, s[48:51], s3 offen offset:1024 sc1
    v_cvt_pk_bf16_f32 v33, v50, v51
    v_pk_mul_f32 v[228:229], v[36:37], v[224:225]
    v_pk_mul_f32 v[230:231], v[38:39], v[224:225]
    v_exp_f32 v228, v228
    v_exp_f32 v229, v229
    v_exp_f32 v230, v230
    v_exp_f32 v231, v231
    v_pk_mul_f32 v[52:53], v[36:37], v[52:53]
    v_pk_mul_f32 v[54:55], v[38:39], v[54:55]
    v_pk_add_f32 v[228:229], v[228:229], v[226:227]
    v_pk_add_f32 v[230:231], v[230:231], v[226:227]
    v_rcp_f32 v228, v228
    v_rcp_f32 v229, v229
    v_rcp_f32 v230, v230
    v_rcp_f32 v231, v231
    v_pk_mul_f32 v[52:53], v[52:53], v[228:229]
    v_pk_mul_f32 v[54:55], v[54:55], v[230:231]
    v_cvt_pk_bf16_f32 v34, v52, v53
    v_cvt_pk_bf16_f32 v35, v54, v55
    buffer_store_dwordx4 v[32:35], v251, s[48:51], s6 offen offset:256 sc1
    v_pk_mul_f32 v[228:229], v[40:41], v[224:225]
    v_pk_mul_f32 v[230:231], v[42:43], v[224:225]
    v_exp_f32 v228, v228
    v_exp_f32 v229, v229
    v_exp_f32 v230, v230
    v_exp_f32 v231, v231
    v_pk_mul_f32 v[56:57], v[40:41], v[56:57]
    v_pk_mul_f32 v[58:59], v[42:43], v[58:59]
    v_pk_add_f32 v[228:229], v[228:229], v[226:227]
    v_pk_add_f32 v[230:231], v[230:231], v[226:227]
    v_rcp_f32 v228, v228
    v_rcp_f32 v229, v229
    v_rcp_f32 v230, v230
    v_rcp_f32 v231, v231
    v_pk_mul_f32 v[56:57], v[56:57], v[228:229]
    v_pk_mul_f32 v[58:59], v[58:59], v[230:231]
    v_cvt_pk_bf16_f32 v36, v56, v57
    v_cvt_pk_bf16_f32 v37, v58, v59
    v_pk_mul_f32 v[228:229], v[44:45], v[224:225]
    v_pk_mul_f32 v[230:231], v[46:47], v[224:225]
    v_exp_f32 v228, v228
    v_exp_f32 v229, v229
    v_exp_f32 v230, v230
    v_exp_f32 v231, v231
    v_pk_mul_f32 v[60:61], v[44:45], v[60:61]
    v_pk_mul_f32 v[62:63], v[46:47], v[62:63]
    v_pk_add_f32 v[228:229], v[228:229], v[226:227]
    v_pk_add_f32 v[230:231], v[230:231], v[226:227]
    v_rcp_f32 v228, v228
    v_rcp_f32 v229, v229
    v_rcp_f32 v230, v230
    v_rcp_f32 v231, v231
    v_pk_mul_f32 v[60:61], v[60:61], v[228:229]
    v_pk_mul_f32 v[62:63], v[62:63], v[230:231]
    v_cvt_pk_bf16_f32 v38, v60, v61
    v_cvt_pk_bf16_f32 v39, v62, v63
    buffer_store_dwordx4 v[36:39], v251, s[48:51], s6 offen offset:1280 sc1
    v_mfma_f32_32x32x16_bf16 v[64:79], a[176:179], a[16:19], 0
    s_add_u32 s64, s62, 98304
    v_lshl_add_u32 v250, v255, 4, s64
    v_xor_b32 v249, 4096, v250
    v_xor_b32 v254, 8192, v250
    v_xor_b32 v253, 12288, v250
    s_and_b32 s64, s22, 64
    v_mfma_f32_32x32x16_bf16 a[80:95], a[180:183], a[16:19], 0
    s_mul_i32 s65, s64, 511
    s_add_u32 s65, s65, s22
    v_lshrrev_b32 v238, 3, v255
    v_and_b32 v251, 7, v255
    v_lshlrev_b32 v251, 4, v251
    v_lshl_add_u32 v238, v238, 11, v251
    v_mfma_f32_32x32x16_bf16 a[96:111], a[176:179], a[20:23], 0
    v_add_u32 v238, s65, v238
    s_lshr_b32 s65, s56, 1
    s_lshl_b32 s65, s65, 13
    s_add_u32 s65, s65, s64
    s_add_u32 s65, s65, 147456
    v_and_b32 v251, 16, v255
    v_mfma_f32_32x32x16_bf16 a[112:127], a[180:183], a[20:23], 0
    v_lshlrev_b32 v251, 1, v251
    v_and_or_b32 v251, v255, 15, v251
    v_lshlrev_b32 v251, 7, v251
    v_and_or_b32 v251, v255, 32, v251
    v_add_u32 v251, s65, v251
    v_and_b32 v246, 7, v255
    v_mfma_f32_32x32x16_bf16 v[64:79], a[184:187], a[24:27], v[64:79]
    v_lshlrev_b32 v246, 4, v246
    v_xor_b32 v234, v246, v251
    v_xor_b32 v233, 16, v234
    v_lshrrev_b32 v246, 3, v255
    v_xor_b32 v246, v246, v255
    s_add_u32 s65, s62, 147456
    v_mfma_f32_32x32x16_bf16 a[80:95], a[188:191], a[24:27], a[80:95]
    v_lshl_add_u32 v246, v246, 4, s65
    v_mfma_f32_32x32x16_bf16 a[96:111], a[184:187], a[28:31], a[96:111]
    s_add_u32 m0, s62, 147456
    s_mov_b32 s63, 15360
    buffer_load_dwordx4 v238, s[24:27], 0 offen lds
    v_mfma_f32_32x32x16_bf16 a[112:127], a[188:191], a[28:31], a[112:127]
    v_mfma_f32_32x32x16_bf16 v[64:79], a[192:195], a[32:35], v[64:79]
    buffer_load_dwordx4 v238, s[24:27], s63 offen offset:1024 lds
    v_mfma_f32_32x32x16_bf16 a[80:95], a[196:199], a[32:35], a[80:95]
    v_mfma_f32_32x32x16_bf16 a[96:111], a[192:195], a[36:39], a[96:111]
    v_mfma_f32_32x32x16_bf16 a[112:127], a[196:199], a[36:39], a[112:127]
    v_mfma_f32_32x32x16_bf16 v[64:79], a[200:203], a[40:43], v[64:79]
    buffer_load_dword v242, v244, s[48:51], 0 offen offset:384 sc1
    v_mfma_f32_32x32x16_bf16 a[80:95], a[204:207], a[40:43], a[80:95]
    v_mfma_f32_32x32x16_bf16 a[96:111], a[200:203], a[44:47], a[96:111]
    v_mfma_f32_32x32x16_bf16 a[112:127], a[204:207], a[44:47], a[112:127]
    v_mfma_f32_32x32x16_bf16 v[64:79], a[208:211], a[48:51], v[64:79]
    s_add_u32 s42, s40, 20480
    buffer_load_dwordx4 a[160:163], v243, s[48:51], s42 offen sc1
    v_mfma_f32_32x32x16_bf16 a[80:95], a[212:215], a[48:51], a[80:95]
    v_mfma_f32_32x32x16_bf16 a[96:111], a[208:211], a[52:55], a[96:111]
    buffer_load_dwordx4 a[164:167], v240, s[48:51], s42 offen offset:1024 sc1
    v_mfma_f32_32x32x16_bf16 a[112:127], a[212:215], a[52:55], a[112:127]
    v_mfma_f32_32x32x16_bf16 v[64:79], a[216:219], a[56:59], v[64:79]
    buffer_load_dwordx4 a[168:171], v243, s[48:51], s42 offen offset:2048 sc1
    v_mfma_f32_32x32x16_bf16 a[80:95], a[220:223], a[56:59], a[80:95]
    v_mfma_f32_32x32x16_bf16 a[96:111], a[216:219], a[60:63], a[96:111]
    buffer_load_dwordx4 a[172:175], v240, s[48:51], s42 offen offset:3072 sc1
    v_mfma_f32_32x32x16_bf16 a[112:127], a[220:223], a[60:63], a[112:127]
    v_xor_b32 v252, 1, v252
    s_waitcnt vmcnt(26)
    v_mfma_f32_32x32x16_bf16 v[64:79], a[224:227], a[64:67], v[64:79]
    s_waitcnt vmcnt(7)
    buffer_store_dword v241, v248, s[48:51], 0 offen offset:640 sc1
    s_waitcnt vmcnt(5)
    v_cmp_gt_u32 vcc, v252, v242
    s_cbranch_vccnz L_C_p7_slow
L_C_p7_ok:
    v_mfma_f32_32x32x16_bf16 a[80:95], a[228:231], a[64:67], a[80:95]
    s_add_u32 s3, s10, 0
    buffer_load_dwordx4 a[16:19], v236, s[48:51], s3 offen sc1
    v_mfma_f32_32x32x16_bf16 a[96:111], a[224:227], a[68:71], a[96:111]
    buffer_load_dwordx4 a[20:23], v245, s[48:51], s3 offen sc1
    v_mfma_f32_32x32x16_bf16 a[112:127], a[228:231], a[68:71], a[112:127]
    v_mfma_f32_32x32x16_bf16 v[64:79], a[232:235], a[72:75], v[64:79]
    buffer_load_dwordx4 a[24:27], v236, s[48:51], s3 offen offset:1024 sc1
    v_mfma_f32_32x32x16_bf16 a[80:95], a[236:239], a[72:75], a[80:95]
    v_mfma_f32_32x32x16_bf16 a[96:111], a[232:235], a[76:79], a[96:111]
    buffer_load_dwordx4 a[28:31], v245, s[48:51], s3 offen offset:1024 sc1
    v_mfma_f32_32x32x16_bf16 a[112:127], a[236:239], a[76:79], a[112:127]
    v_mfma_f32_32x32x16_bf16 v[64:79], a[240:243], a[128:131], v[64:79]
    s_add_u32 s3, s10, 2048
    buffer_load_dwordx4 a[176:179], v236, s[48:51], s3 offen sc1
    v_mfma_f32_32x32x16_bf16 a[80:95], a[244:247], a[128:131], a[80:95]
    v_mfma_f32_32x32x16_bf16 a[96:111], a[240:243], a[132:135], a[96:111]
    buffer_load_dwordx4 a[180:183], v245, s[48:51], s3 offen sc1
    v_mfma_f32_32x32x16_bf16 a[112:127], a[244:247], a[132:135], a[112:127]
    v_mfma_f32_32x32x16_bf16 v[64:79], a[248:251], a[136:139], v[64:79]
    buffer_load_dwordx4 a[184:187], v236, s[48:51], s3 offen offset:1024 sc1
    v_mfma_f32_32x32x16_bf16 a[80:95], a[252:255], a[136:139], a[80:95]
    v_mfma_f32_32x32x16_bf16 a[96:111], a[248:251], a[140:143], a[96:111]
    buffer_load_dwordx4 a[188:191], v245, s[48:51], s3 offen offset:1024 sc1
    v_mfma_f32_32x32x16_bf16 a[112:127], a[252:255], a[140:143], a[112:127]
    v_mfma_f32_32x32x16_bf16 v[64:79], v[96:99], a[144:147], v[64:79]
    s_add_u32 s3, s10, 4096
    buffer_load_dwordx4 a[32:35], v236, s[48:51], s3 offen sc1
    v_mfma_f32_32x32x16_bf16 a[80:95], v[100:103], a[144:147], a[80:95]
    v_mfma_f32_32x32x16_bf16 a[96:111], v[96:99], a[148:151], a[96:111]
    buffer_load_dwordx4 a[36:39], v245, s[48:51], s3 offen sc1
    v_mfma_f32_32x32x16_bf16 a[112:127], v[100:103], a[148:151], a[112:127]
    v_mfma_f32_32x32x16_bf16 v[64:79], v[104:107], a[152:155], v[64:79]
    buffer_load_dwordx4 a[40:43], v236, s[48:51], s3 offen offset:1024 sc1
    v_mfma_f32_32x32x16_bf16 a[80:95], v[108:111], a[152:155], a[80:95]
    v_mfma_f32_32x32x16_bf16 a[96:111], v[104:107], a[156:159], a[96:111]
    buffer_load_dwordx4 a[44:47], v245, s[48:51], s3 offen offset:1024 sc1
    v_mfma_f32_32x32x16_bf16 a[112:127], v[108:111], a[156:159], a[112:127]
    s_waitcnt vmcnt(11)
    v_mfma_f32_32x32x16_bf16 v[80:95], v[112:115], a[16:19], 0
    s_add_u32 s3, s10, 6144
    buffer_load_dwordx4 a[192:195], v236, s[48:51], s3 offen sc1
    v_mfma_f32_32x32x16_bf16 a[224:239], v[116:119], a[16:19], 0
    s_waitcnt vmcnt(11)
    v_mfma_f32_32x32x16_bf16 a[240:255], v[112:115], a[20:23], 0
    buffer_load_dwordx4 a[196:199], v245, s[48:51], s3 offen sc1
    v_mfma_f32_32x32x16_bf16 v[96:111], v[116:119], a[20:23], 0
    s_waitcnt vmcnt(11)
    v_mfma_f32_32x32x16_bf16 v[80:95], v[120:123], a[24:27], v[80:95]
    buffer_load_dwordx4 a[200:203], v236, s[48:51], s3 offen offset:1024 sc1
    v_mfma_f32_32x32x16_bf16 a[224:239], v[124:127], a[24:27], a[224:239]
    s_waitcnt vmcnt(11)
    v_mfma_f32_32x32x16_bf16 a[240:255], v[120:123], a[28:31], a[240:255]
    buffer_load_dwordx4 a[204:207], v245, s[48:51], s3 offen offset:1024 sc1
    v_mfma_f32_32x32x16_bf16 v[96:111], v[124:127], a[28:31], v[96:111]
    s_waitcnt vmcnt(11)
    v_mfma_f32_32x32x16_bf16 v[80:95], v[128:131], a[176:179], v[80:95]
    buffer_load_dword v242, v244, s[48:51], 0 offen offset:640 sc1
    v_mfma_f32_32x32x16_bf16 a[224:239], v[132:135], a[176:179], a[224:239]
    s_add_u32 s42, s40, 24576
    buffer_load_dwordx4 a[48:51], v243, s[48:51], s42 offen sc1
    s_waitcnt vmcnt(12)
    v_mfma_f32_32x32x16_bf16 a[240:255], v[128:131], a[180:183], a[240:255]
    buffer_load_dwordx4 a[52:55], v240, s[48:51], s42 offen offset:1024 sc1
    v_mfma_f32_32x32x16_bf16 v[96:111], v[132:135], a[180:183], v[96:111]
    buffer_load_dwordx4 a[56:59], v243, s[48:51], s42 offen offset:2048 sc1
    s_waitcnt vmcnt(13)
    v_mfma_f32_32x32x16_bf16 v[80:95], v[136:139], a[184:187], v[80:95]
    buffer_load_dwordx4 a[60:63], v240, s[48:51], s42 offen offset:3072 sc1
    v_mfma_f32_32x32x16_bf16 a[224:239], v[140:143], a[184:187], a[224:239]
    s_add_u32 s42, s40, 28672
    buffer_load_dwordx4 a[208:211], v243, s[48:51], s42 offen sc1
    s_waitcnt vmcnt(14)
    v_mfma_f32_32x32x16_bf16 a[240:255], v[136:139], a[188:191], a[240:255]
    buffer_load_dwordx4 a[212:215], v240, s[48:51], s42 offen offset:1024 sc1
    v_mfma_f32_32x32x16_bf16 v[96:111], v[140:143], a[188:191], v[96:111]
    buffer_load_dwordx4 a[216:219], v243, s[48:51], s42 offen offset:2048 sc1
    s_waitcnt vmcnt(15)
    v_mfma_f32_32x32x16_bf16 v[80:95], v[144:147], a[32:35], v[80:95]
    buffer_load_dwordx4 a[220:223], v240, s[48:51], s42 offen offset:3072 sc1
    v_mfma_f32_32x32x16_bf16 a[224:239], v[148:151], a[32:35], a[224:239]
    s_waitcnt vmcnt(15)
    v_mfma_f32_32x32x16_bf16 a[240:255], v[144:147], a[36:39], a[240:255]
    v_mfma_f32_32x32x16_bf16 v[96:111], v[148:151], a[36:39], v[96:111]
    s_waitcnt vmcnt(14)
    v_mfma_f32_32x32x16_bf16 v[80:95], v[152:155], a[40:43], v[80:95]
    s_waitcnt vmcnt(8)
    v_cmp_gt_u32 vcc, 1, v242
    s_cbranch_vccnz L_C_p8_slow
L_C_p8_ok:
    s_add_u32 s3, s9, 16384
    buffer_load_dwordx4 a[64:67], v236, s[48:51], s3 offen sc1
    v_mfma_f32_32x32x16_bf16 a[224:239], v[156:159], a[40:43], a[224:239]
    buffer_load_dwordx4 a[68:71], v245, s[48:51], s3 offen sc1
    v_mfma_f32_32x32x16_bf16 a[240:255], v[152:155], a[44:47], a[240:255]
    buffer_load_dwordx4 a[72:75], v236, s[48:51], s3 offen offset:1024 sc1
    v_mfma_f32_32x32x16_bf16 v[96:111], v[156:159], a[44:47], v[96:111]
    buffer_load_dwordx4 a[76:79], v245, s[48:51], s3 offen offset:1024 sc1
    v_mfma_f32_32x32x16_bf16 v[80:95], v[160:163], a[192:195], v[80:95]
    s_add_u32 s3, s9, 18432
    buffer_load_dwordx4 a[128:131], v236, s[48:51], s3 offen sc1
    v_mfma_f32_32x32x16_bf16 a[224:239], v[164:167], a[192:195], a[224:239]
    buffer_load_dwordx4 a[132:135], v245, s[48:51], s3 offen sc1
    v_mfma_f32_32x32x16_bf16 a[240:255], v[160:163], a[196:199], a[240:255]
    buffer_load_dwordx4 a[136:139], v236, s[48:51], s3 offen offset:1024 sc1
    v_mfma_f32_32x32x16_bf16 v[96:111], v[164:167], a[196:199], v[96:111]
    buffer_load_dwordx4 a[140:143], v245, s[48:51], s3 offen offset:1024 sc1
    v_mfma_f32_32x32x16_bf16 v[80:95], v[168:171], a[200:203], v[80:95]
    s_add_u32 s3, s9, 20480
    buffer_load_dwordx4 a[148:151], v245, s[48:51], s3 offen sc1
    v_mfma_f32_32x32x16_bf16 a[224:239], v[172:175], a[200:203], a[224:239]
    buffer_load_dwordx4 a[156:159], v245, s[48:51], s3 offen offset:1024 sc1
    v_mfma_f32_32x32x16_bf16 a[240:255], v[168:171], a[204:207], a[240:255]
    s_add_u32 s3, s9, 22528
    buffer_load_dwordx4 a[20:23], v245, s[48:51], s3 offen sc1
    v_mfma_f32_32x32x16_bf16 v[96:111], v[172:175], a[204:207], v[96:111]
    buffer_load_dwordx4 a[28:31], v245, s[48:51], s3 offen offset:1024 sc1
    s_waitcnt vmcnt(11)
    v_mfma_f32_32x32x16_bf16 v[64:79], v[176:179], a[64:67], v[64:79]
    s_add_u32 s3, s9, 8192
    buffer_load_dwordx4 v[116:119], v245, s[48:51], s3 offen sc1
    v_mfma_f32_32x32x16_bf16 a[80:95], v[180:183], a[64:67], a[80:95]
    v_add_u32 v237, 114688, v237
    ds_read_b128 v[144:147], v237
    ds_read_b128 v[148:151], v237 offset:1024
    ds_read_b128 v[152:155], v237 offset:2048
    ds_read_b128 v[156:159], v237 offset:3072
    s_waitcnt lgkmcnt(0)
    ds_write_b128 v250, a[224:227]
    s_waitcnt vmcnt(11)
    v_mfma_f32_32x32x16_bf16 a[96:111], v[176:179], a[68:71], a[96:111]
    buffer_load_dwordx4 v[124:127], v245, s[48:51], s3 offen offset:1024 sc1
    v_mfma_f32_32x32x16_bf16 a[112:127], v[180:183], a[68:71], a[112:127]
    ds_write_b128 v250, a[228:231] offset:1024
    s_waitcnt vmcnt(11)
    v_mfma_f32_32x32x16_bf16 v[64:79], v[184:187], a[72:75], v[64:79]
    s_add_u32 s3, s9, 10240
    buffer_load_dwordx4 a[180:183], v245, s[48:51], s3 offen sc1
    v_mfma_f32_32x32x16_bf16 a[80:95], v[188:191], a[72:75], a[80:95]
    ds_write_b128 v250, a[232:235] offset:2048
    s_waitcnt vmcnt(11)
    v_mfma_f32_32x32x16_bf16 a[96:111], v[184:187], a[76:79], a[96:111]
    buffer_load_dwordx4 a[188:191], v245, s[48:51], s3 offen offset:1024 sc1
    v_mfma_f32_32x32x16_bf16 a[112:127], v[188:191], a[76:79], a[112:127]
    ds_write_b128 v250, a[236:239] offset:3072
    s_waitcnt vmcnt(11)
    v_mfma_f32_32x32x16_bf16 v[64:79], v[192:195], a[128:131], v[64:79]
    s_add_u32 s3, s9, 12288
    buffer_load_dwordx4 v[132:135], v245, s[48:51], s3 offen sc1
    v_mfma_f32_32x32x16_bf16 a[80:95], v[196:199], a[128:131], a[80:95]
    ds_write_b128 v250, a[240:243] offset:16384
    s_waitcnt vmcnt(11)
    v_mfma_f32_32x32x16_bf16 a[96:111], v[192:195], a[132:135], a[96:111]
    buffer_load_dwordx4 v[140:143], v245, s[48:51], s3 offen offset:1024 sc1
    v_mfma_f32_32x32x16_bf16 a[112:127], v[196:199], a[132:135], a[112:127]
    ds_write_b128 v250, a[244:247] offset:17408
    s_waitcnt vmcnt(11)
    v_mfma_f32_32x32x16_bf16 v[64:79], v[200:203], a[136:139], v[64:79]
    s_add_u32 s3, s9, 14336
    buffer_load_dwordx4 a[36:39], v245, s[48:51], s3 offen sc1
    v_mfma_f32_32x32x16_bf16 a[80:95], v[204:207], a[136:139], a[80:95]
    ds_write_b128 v250, a[248:251] offset:18432
    s_waitcnt vmcnt(11)
    v_mfma_f32_32x32x16_bf16 a[96:111], v[200:203], a[140:143], a[96:111]
    buffer_load_dwordx4 a[44:47], v245, s[48:51], s3 offen offset:1024 sc1
    v_mfma_f32_32x32x16_bf16 a[112:127], v[204:207], a[140:143], a[112:127]
    ds_write_b128 v250, a[252:255] offset:19456
    s_waitcnt vmcnt(11)
    v_mfma_f32_32x32x16_bf16 a[96:111], v[208:211], a[148:151], a[96:111]
    s_add_u32 s3, s9, 20480
    buffer_load_dwordx4 a[144:147], v236, s[48:51], s3 offen sc1
    v_mfma_f32_32x32x16_bf16 a[112:127], v[212:215], a[148:151], a[112:127]
    ds_write_b128 v250, v[96:99] offset:32768
    s_waitcnt vmcnt(11)
    v_mfma_f32_32x32x16_bf16 a[96:111], v[216:219], a[156:159], a[96:111]
    buffer_load_dwordx4 a[152:155], v236, s[48:51], s3 offen offset:1024 sc1
    v_mfma_f32_32x32x16_bf16 a[112:127], v[220:223], a[156:159], a[112:127]
    ds_write_b128 v250, v[100:103] offset:33792
    s_waitcnt vmcnt(11)
    v_mfma_f32_32x32x16_bf16 a[96:111], a[0:3], a[20:23], a[96:111]
    s_add_u32 s3, s9, 22528
    buffer_load_dwordx4 a[16:19], v236, s[48:51], s3 offen sc1
    v_mfma_f32_32x32x16_bf16 a[112:127], a[4:7], a[20:23], a[112:127]
    ds_write_b128 v250, v[104:107] offset:34816
    s_waitcnt vmcnt(11)
    v_mfma_f32_32x32x16_bf16 a[96:111], a[8:11], a[28:31], a[96:111]
    buffer_load_dwordx4 a[24:27], v236, s[48:51], s3 offen offset:1024 sc1
    v_mfma_f32_32x32x16_bf16 a[112:127], a[12:15], a[28:31], a[112:127]
    ds_write_b128 v250, v[108:111] offset:35840
    s_waitcnt vmcnt(11)
    v_mfma_f32_32x32x16_bf16 a[96:111], v[144:147], v[116:119], a[96:111]
    s_add_u32 s3, s9, 8192
    buffer_load_dwordx4 v[112:115], v236, s[48:51], s3 offen sc1
    v_mfma_f32_32x32x16_bf16 a[112:127], v[148:151], v[116:119], a[112:127]
    s_waitcnt vmcnt(11)
    v_mfma_f32_32x32x16_bf16 a[96:111], v[152:155], v[124:127], a[96:111]
    buffer_load_dwordx4 v[120:123], v236, s[48:51], s3 offen offset:1024 sc1
    s_waitcnt lgkmcnt(0)
    s_barrier
    ds_read_b128 v[52:55], v251
    v_mfma_f32_32x32x16_bf16 a[112:127], v[156:159], v[124:127], a[112:127]
    ds_read_b128 v[60:63], v251 offset:16
    ds_read_b128 v[0:3], v249
    s_waitcnt vmcnt(11)
    v_mfma_f32_32x32x16_bf16 a[96:111], a[160:163], a[180:183], a[96:111]
    s_add_u32 s3, s9, 10240
    buffer_load_dwordx4 a[176:179], v236, s[48:51], s3 offen sc1
    ds_read_b128 v[4:7], v249 offset:1024
    v_mfma_f32_32x32x16_bf16 a[112:127], a[164:167], a[180:183], a[112:127]
    ds_read_b128 v[8:11], v249 offset:2048
    ds_read_b128 v[12:15], v249 offset:3072
    s_waitcnt vmcnt(11)
    v_mfma_f32_32x32x16_bf16 a[96:111], a[168:171], a[188:191], a[96:111]
    buffer_load_dwordx4 a[184:187], v236, s[48:51], s3 offen offset:1024 sc1
    ds_read_b128 v[16:19], v254 offset:16384
    v_mfma_f32_32x32x16_bf16 a[112:127], a[172:175], a[188:191], a[112:127]
    ds_read_b128 v[20:23], v254 offset:17408
    ds_read_b128 v[24:27], v254 offset:18432
    s_waitcnt vmcnt(11)
    v_mfma_f32_32x32x16_bf16 a[96:111], a[48:51], v[132:135], a[96:111]
    s_add_u32 s3, s9, 12288
    buffer_load_dwordx4 v[128:131], v236, s[48:51], s3 offen sc1
    ds_read_b128 v[28:31], v254 offset:19456
    v_mfma_f32_32x32x16_bf16 a[112:127], a[52:55], v[132:135], a[112:127]
    ds_read_b128 v[32:35], v253 offset:32768
    ds_read_b128 v[36:39], v253 offset:33792
    s_waitcnt vmcnt(11)
    v_mfma_f32_32x32x16_bf16 a[96:111], a[56:59], v[140:143], a[96:111]
    buffer_load_dwordx4 v[136:139], v236, s[48:51], s3 offen offset:1024 sc1
    ds_read_b128 v[40:43], v253 offset:34816
    v_mfma_f32_32x32x16_bf16 a[112:127], a[60:63], v[140:143], a[112:127]
    ds_read_b128 v[44:47], v253 offset:35840
    v_subrev_u32 v250, 98304, v250
    v_subrev_u32 v249, 98304, v249
    v_subrev_u32 v254, 98304, v254
    s_waitcnt vmcnt(11)
    v_mfma_f32_32x32x16_bf16 a[96:111], a[208:211], a[36:39], a[96:111]
    s_add_u32 s3, s9, 14336
    buffer_load_dwordx4 a[32:35], v236, s[48:51], s3 offen sc1
    v_subrev_u32 v253, 98304, v253
    s_waitcnt lgkmcnt(13)
    v_lshlrev_b32 v48, 16, v52
    v_mfma_f32_32x32x16_bf16 a[112:127], a[212:215], a[36:39], a[112:127]
    v_and_b32 v49, 0xffff0000, v52
    v_lshlrev_b32 v50, 16, v53
    v_and_b32 v51, 0xffff0000, v53
    v_lshlrev_b32 v52, 16, v54
    v_and_b32 v53, 0xffff0000, v54
    v_lshlrev_b32 v54, 16, v55
    s_waitcnt vmcnt(11)
    v_mfma_f32_32x32x16_bf16 a[96:111], a[216:219], a[44:47], a[96:111]
    buffer_load_dwordx4 a[40:43], v236, s[48:51], s3 offen offset:1024 sc1
    v_and_b32 v55, 0xffff0000, v55
    s_waitcnt lgkmcnt(12)
    v_lshlrev_b32 v56, 16, v60
    v_mfma_f32_32x32x16_bf16 a[112:127], a[220:223], a[44:47], a[112:127]
    v_and_b32 v57, 0xffff0000, v60
    v_lshlrev_b32 v58, 16, v61
    v_and_b32 v59, 0xffff0000, v61
    v_lshlrev_b32 v60, 16, v62
    v_and_b32 v61, 0xffff0000, v62
    v_lshlrev_b32 v62, 16, v63
    s_waitcnt vmcnt(11)
    v_mfma_f32_32x32x16_bf16 a[80:95], v[212:215], a[144:147], a[80:95]
    ds_write_b128 v250, a[96:99] offset:16384
    v_mfma_f32_32x32x16_bf16 v[64:79], v[208:211], a[144:147], v[64:79]
    v_and_b32 v63, 0xffff0000, v63
    s_waitcnt lgkmcnt(12)
    v_add_f32 v80, v80, v0
    v_add_f32 v81, v81, v1
    v_add_f32 v82, v82, v2
    v_add_f32 v83, v83, v3
    s_waitcnt lgkmcnt(11)
    v_add_f32 v84, v84, v4
    s_waitcnt vmcnt(10)
    v_mfma_f32_32x32x16_bf16 a[80:95], v[220:223], a[152:155], a[80:95]
    ds_write_b128 v250, a[100:103] offset:17408
    v_mfma_f32_32x32x16_bf16 v[64:79], v[216:219], a[152:155], v[64:79]
    v_add_f32 v85, v85, v5
    v_add_f32 v86, v86, v6
    v_add_f32 v87, v87, v7
    s_waitcnt lgkmcnt(11)
    v_add_f32 v88, v88, v8
    v_add_f32 v89, v89, v9
    v_add_f32 v90, v90, v10
    s_waitcnt vmcnt(9)
    v_mfma_f32_32x32x16_bf16 a[80:95], a[4:7], a[16:19], a[80:95]
    ds_write_b128 v250, a[104:107] offset:18432
    v_mfma_f32_32x32x16_bf16 v[64:79], a[0:3], a[16:19], v[64:79]
    v_add_f32 v91, v91, v11
    s_waitcnt lgkmcnt(11)
    v_add_f32 v92, v92, v12
    v_add_f32 v93, v93, v13
    v_add_f32 v94, v94, v14
    v_add_f32 v95, v95, v15
    s_waitcnt lgkmcnt(6)
    v_add_f32 v16, v16, v32
    s_waitcnt vmcnt(8)
    v_mfma_f32_32x32x16_bf16 a[80:95], a[12:15], a[24:27], a[80:95]
    ds_write_b128 v250, a[108:111] offset:19456
    v_mfma_f32_32x32x16_bf16 v[64:79], a[8:11], a[24:27], v[64:79]
    v_add_f32 v17, v17, v33
    v_add_f32 v18, v18, v34
    v_add_f32 v19, v19, v35
    s_waitcnt lgkmcnt(6)
    v_add_f32 v20, v20, v36
    v_add_f32 v21, v21, v37
    v_add_f32 v22, v22, v38
    s_waitcnt vmcnt(7)
    v_mfma_f32_32x32x16_bf16 a[80:95], v[148:151], v[112:115], a[80:95]
    ds_write_b128 v250, a[112:115] offset:32768
    s_waitcnt vmcnt(6)
    v_mfma_f32_32x32x16_bf16 a[80:95], v[156:159], v[120:123], a[80:95]
    v_add_f32 v23, v23, v39
    s_waitcnt lgkmcnt(6)
    v_add_f32 v24, v24, v40
    v_add_f32 v25, v25, v41
    v_add_f32 v26, v26, v42
    v_add_f32 v27, v27, v43
    s_waitcnt lgkmcnt(5)
    v_add_f32 v28, v28, v44
    s_waitcnt vmcnt(5)
    v_mfma_f32_32x32x16_bf16 a[80:95], a[164:167], a[176:179], a[80:95]
    ds_write_b128 v250, a[116:119] offset:33792
    s_waitcnt vmcnt(4)
    v_mfma_f32_32x32x16_bf16 a[80:95], a[172:175], a[184:187], a[80:95]
    v_add_f32 v29, v29, v45
    v_add_f32 v30, v30, v46
    v_add_f32 v31, v31, v47
    v_add_f32 v80, v80, v16
    v_add_f32 v81, v81, v17
    v_add_f32 v82, v82, v18
    s_waitcnt vmcnt(3)
    v_mfma_f32_32x32x16_bf16 a[80:95], a[52:55], v[128:131], a[80:95]
    ds_write_b128 v250, a[120:123] offset:34816
    s_waitcnt vmcnt(2)
    v_mfma_f32_32x32x16_bf16 a[80:95], a[60:63], v[136:139], a[80:95]
    v_add_f32 v83, v83, v19
    v_add_f32 v84, v84, v20
    v_add_f32 v85, v85, v21
    v_add_f32 v86, v86, v22
    v_add_f32 v87, v87, v23
    v_add_f32 v88, v88, v24
    s_waitcnt vmcnt(1)
    v_mfma_f32_32x32x16_bf16 a[80:95], a[212:215], a[32:35], a[80:95]
    ds_write_b128 v250, a[124:127] offset:35840
    s_waitcnt vmcnt(0)
    v_mfma_f32_32x32x16_bf16 a[80:95], a[220:223], a[40:43], a[80:95]
    v_add_f32 v89, v89, v25
    v_add_f32 v90, v90, v26
    v_add_f32 v91, v91, v27
    v_add_f32 v92, v92, v28
    v_add_f32 v93, v93, v29
    v_add_f32 v94, v94, v30
    v_mfma_f32_32x32x16_bf16 v[64:79], v[144:147], v[112:115], v[64:79]
    v_add_f32 v95, v95, v31
    v_mfma_f32_32x32x16_bf16 v[64:79], v[152:155], v[120:123], v[64:79]
    s_nop 2
    ds_write_b128 v250, a[80:83]
    v_mfma_f32_32x32x16_bf16 v[64:79], a[160:163], a[176:179], v[64:79]
    ds_write_b128 v250, a[84:87] offset:1024
    v_mfma_f32_32x32x16_bf16 v[64:79], a[168:171], a[184:187], v[64:79]
    ds_write_b128 v250, a[88:91] offset:2048
    v_mfma_f32_32x32x16_bf16 v[64:79], a[48:51], v[128:131], v[64:79]
    ds_write_b128 v250, a[92:95] offset:3072
    v_mfma_f32_32x32x16_bf16 v[64:79], a[56:59], v[136:139], v[64:79]
    v_mfma_f32_32x32x16_bf16 v[64:79], a[208:211], a[32:35], v[64:79]
    v_mfma_f32_32x32x16_bf16 v[64:79], a[216:219], a[40:43], v[64:79]
    s_waitcnt lgkmcnt(0)
    s_barrier
    ds_read_b128 v[0:3], v249
    ds_read_b128 v[16:19], v254 offset:16384
    ds_read_b128 v[32:35], v253 offset:32768
    ds_read_b128 v[4:7], v249 offset:1024
    ds_read_b128 v[20:23], v254 offset:17408
    ds_read_b128 v[36:39], v253 offset:33792
    ds_read_b128 v[8:11], v249 offset:2048
    ds_read_b128 v[24:27], v254 offset:18432
    ds_read_b128 v[40:43], v253 offset:34816
    ds_read_b128 v[12:15], v249 offset:3072
    ds_read_b128 v[28:31], v254 offset:19456
    ds_read_b128 v[44:47], v253 offset:35840
    s_waitcnt lgkmcnt(9)
    v_pk_add_f32 v[16:17], v[16:17], v[32:33]
    v_pk_add_f32 v[18:19], v[18:19], v[34:35]
    s_waitcnt lgkmcnt(6)
    v_pk_add_f32 v[20:21], v[20:21], v[36:37]
    v_pk_add_f32 v[22:23], v[22:23], v[38:39]
    v_pk_add_f32 v[64:65], v[64:65], v[0:1]
    v_pk_add_f32 v[66:67], v[66:67], v[2:3]
    v_pk_add_f32 v[68:69], v[68:69], v[4:5]
    v_pk_add_f32 v[70:71], v[70:71], v[6:7]
    v_pk_add_f32 v[64:65], v[64:65], v[16:17]
    v_pk_add_f32 v[66:67], v[66:67], v[18:19]
    v_pk_add_f32 v[68:69], v[68:69], v[20:21]
    v_pk_add_f32 v[70:71], v[70:71], v[22:23]
    v_pk_mul_f32 v[0:1], v[64:65], v[224:225]
    v_pk_mul_f32 v[2:3], v[66:67], v[224:225]
    v_pk_mul_f32 v[4:5], v[68:69], v[224:225]
    v_pk_mul_f32 v[6:7], v[70:71], v[224:225]
    v_exp_f32 v0, v0
    v_exp_f32 v1, v1
    v_exp_f32 v2, v2
    v_exp_f32 v3, v3
    v_exp_f32 v4, v4
    v_exp_f32 v5, v5
    v_exp_f32 v6, v6
    v_exp_f32 v7, v7
    v_pk_mul_f32 v[80:81], v[80:81], v[64:65]
    v_pk_mul_f32 v[82:83], v[82:83], v[66:67]
    v_pk_mul_f32 v[84:85], v[84:85], v[68:69]
    v_pk_mul_f32 v[86:87], v[86:87], v[70:71]
    v_pk_add_f32 v[0:1], v[0:1], v[226:227]
    v_pk_add_f32 v[2:3], v[2:3], v[226:227]
    v_pk_add_f32 v[4:5], v[4:5], v[226:227]
    v_pk_add_f32 v[6:7], v[6:7], v[226:227]
    v_rcp_f32 v0, v0
    v_rcp_f32 v1, v1
    v_rcp_f32 v2, v2
    v_rcp_f32 v3, v3
    v_rcp_f32 v4, v4
    v_rcp_f32 v5, v5
    v_rcp_f32 v6, v6
    v_rcp_f32 v7, v7
    v_pk_fma_f32 v[48:49], v[80:81], v[0:1], v[48:49]
    v_pk_fma_f32 v[50:51], v[82:83], v[2:3], v[50:51]
    v_pk_fma_f32 v[52:53], v[84:85], v[4:5], v[52:53]
    v_pk_fma_f32 v[54:55], v[86:87], v[6:7], v[54:55]
    v_cvt_pk_bf16_f32 v0, v48, v49
    v_cvt_pk_bf16_f32 v1, v50, v51
    v_cvt_pk_bf16_f32 v2, v52, v53
    v_cvt_pk_bf16_f32 v3, v54, v55
    ds_write_b128 v234, v[0:3]
    s_waitcnt lgkmcnt(4)
    v_pk_add_f32 v[24:25], v[24:25], v[40:41]
    v_pk_add_f32 v[26:27], v[26:27], v[42:43]
    s_waitcnt lgkmcnt(1)
    v_pk_add_f32 v[28:29], v[28:29], v[44:45]
    v_pk_add_f32 v[30:31], v[30:31], v[46:47]
    v_pk_add_f32 v[72:73], v[72:73], v[8:9]
    v_pk_add_f32 v[74:75], v[74:75], v[10:11]
    v_pk_add_f32 v[76:77], v[76:77], v[12:13]
    v_pk_add_f32 v[78:79], v[78:79], v[14:15]
    v_pk_add_f32 v[72:73], v[72:73], v[24:25]
    v_pk_add_f32 v[74:75], v[74:75], v[26:27]
    v_pk_add_f32 v[76:77], v[76:77], v[28:29]
    v_pk_add_f32 v[78:79], v[78:79], v[30:31]
    v_pk_mul_f32 v[8:9], v[72:73], v[224:225]
    v_pk_mul_f32 v[10:11], v[74:75], v[224:225]
    v_pk_mul_f32 v[12:13], v[76:77], v[224:225]
    v_pk_mul_f32 v[14:15], v[78:79], v[224:225]
    v_exp_f32 v8, v8
    v_exp_f32 v9, v9
    v_exp_f32 v10, v10
    v_exp_f32 v11, v11
    v_exp_f32 v12, v12
    v_exp_f32 v13, v13
    v_exp_f32 v14, v14
    v_exp_f32 v15, v15
    v_pk_mul_f32 v[88:89], v[88:89], v[72:73]
    v_pk_mul_f32 v[90:91], v[90:91], v[74:75]
    v_pk_mul_f32 v[92:93], v[92:93], v[76:77]
    v_pk_mul_f32 v[94:95], v[94:95], v[78:79]
    v_pk_add_f32 v[8:9], v[8:9], v[226:227]
    v_pk_add_f32 v[10:11], v[10:11], v[226:227]
    v_pk_add_f32 v[12:13], v[12:13], v[226:227]
    v_pk_add_f32 v[14:15], v[14:15], v[226:227]
    v_rcp_f32 v8, v8
    v_rcp_f32 v9, v9
    v_rcp_f32 v10, v10
    v_rcp_f32 v11, v11
    v_rcp_f32 v12, v12
    v_rcp_f32 v13, v13
    v_rcp_f32 v14, v14
    v_rcp_f32 v15, v15
    v_pk_fma_f32 v[56:57], v[88:89], v[8:9], v[56:57]
    v_pk_fma_f32 v[58:59], v[90:91], v[10:11], v[58:59]
    v_pk_fma_f32 v[60:61], v[92:93], v[12:13], v[60:61]
    v_pk_fma_f32 v[62:63], v[94:95], v[14:15], v[62:63]
    v_cvt_pk_bf16_f32 v8, v56, v57
    v_cvt_pk_bf16_f32 v9, v58, v59
    v_cvt_pk_bf16_f32 v10, v60, v61
    v_cvt_pk_bf16_f32 v11, v62, v63
    ds_write_b128 v233, v[8:11]
    s_movk_i32 s63, 16384
    s_waitcnt lgkmcnt(0)
    s_barrier
    ds_read_b128 v[48:51], v246
    ds_read_b128 v[52:55], v246 offset:1024
    s_waitcnt lgkmcnt(1)
    buffer_store_dwordx4 v[48:51], v238, s[44:47], 0 offen sc1
    s_waitcnt lgkmcnt(0)
    buffer_store_dwordx4 v[52:55], v238, s[44:47], s63 offen sc1
    s_endpgm
L_C_p1_slow:
    s_mov_b32 s79, 0
L_C_p1_spin:
    buffer_load_dword v242, v106, s[52:55], 0 offen sc1
    s_add_u32 s79, s79, 1
    s_waitcnt vmcnt(0)
    v_cmp_gt_u32 vcc, v107, v242
    s_cmp_ge_u32 s79, 1000000
    s_cbranch_scc1 L_C_p1_ok
    s_cbranch_vccnz L_C_p1_spin
    s_branch L_C_p1_ok
L_C_p2_slow:
    s_mov_b32 s79, 0
L_C_p2_spin:
    v_mov_b32 v242, 15
    s_bfm_b64 exec, 2, 0
    v_mov_b32 v242, 0
    buffer_atomic_add v242, v105, s[48:51], 0 offen offset:0 sc0 sc1
    s_mov_b64 exec, -1
    s_add_u32 s79, s79, 1
    s_waitcnt vmcnt(0)
    v_cmp_gt_u32 vcc, 1, v242
    s_cmp_ge_u32 s79, 1000000
    s_cbranch_scc1 L_C_p2_ok
    s_cbranch_vccnz L_C_p2_spin
    s_branch L_C_p2_ok
L_C_p3_slow:
    s_mov_b32 s79, 0
L_C_p3_spin:
    buffer_load_dword v242, v235, s[48:51], 0 offen sc1
    s_add_u32 s79, s79, 1
    s_waitcnt vmcnt(0)
    v_cmp_gt_u32 vcc, s43, v242
    s_cmp_ge_u32 s79, 1000000
    s_cbranch_scc1 L_C_p3_ok
    s_cbranch_vccnz L_C_p3_spin
    s_branch L_C_p3_ok
L_C_p4_slow:
    s_mov_b32 s79, 0
L_C_p4_spin:
    buffer_load_dword v242, v234, s[48:51], 0 offen sc1
    s_add_u32 s79, s79, 1
    s_waitcnt vmcnt(0)
    v_cmp_gt_u32 vcc, s43, v242
    s_cmp_ge_u32 s79, 1000000
    s_cbranch_scc1 L_C_p4_ok
    s_cbranch_vccnz L_C_p4_spin
    s_branch L_C_p4_ok
L_C_p5_slow:
    s_mov_b32 s79, 0
L_C_p5_spin:
    buffer_load_dword v242, v244, s[48:51], 0 offen offset:128 sc1
    s_add_u32 s79, s79, 1
    s_waitcnt vmcnt(0)
    v_cmp_gt_u32 vcc, v252, v242
    s_cmp_ge_u32 s79, 1000000
    s_cbranch_scc1 L_C_p5_ok
    s_cbranch_vccnz L_C_p5_spin
    s_branch L_C_p5_ok
L_C_p6_slow:
    s_mov_b32 s79, 0
L_C_p6_spin:
    buffer_load_dword v242, v244, s[48:51], 0 offen offset:256 sc1
    s_add_u32 s79, s79, 1
    s_waitcnt vmcnt(0)
    v_cmp_gt_u32 vcc, v252, v242
    s_cmp_ge_u32 s79, 1000000
    s_cbranch_scc1 L_C_p6_ok
    s_cbranch_vccnz L_C_p6_spin
    s_branch L_C_p6_ok
L_C_p7_slow:
    s_mov_b32 s79, 0
L_C_p7_spin:
    buffer_load_dword v242, v244, s[48:51], 0 offen offset:384 sc1
    s_add_u32 s79, s79, 1
    s_waitcnt vmcnt(0)
    v_cmp_gt_u32 vcc, v252, v242
    s_cmp_ge_u32 s79, 1000000
    s_cbranch_scc1 L_C_p7_ok
    s_cbranch_vccnz L_C_p7_spin
    s_branch L_C_p7_ok
L_C_p8_slow:
    s_mov_b32 s79, 0
L_C_p8_spin:
    buffer_load_dword v242, v244, s[48:51], 0 offen offset:640 sc1
    s_add_u32 s79, s79, 1
    s_waitcnt vmcnt(0)
    v_cmp_gt_u32 vcc, 1, v242
    s_cmp_ge_u32 s79, 1000000
    s_cbranch_scc1 L_C_p8_ok
    s_cbranch_vccnz L_C_p8_spin
    s_branch L_C_p8_ok
L_end:
.section .rodata,"a"
.p2align 6
.amdhsa_kernel recurrent_scan__sliding_local_dilated__swiglu_ffn__prompt_kernel
  .amdhsa_next_free_vgpr 512
  .amdhsa_next_free_sgpr 102
  .amdhsa_accum_offset 256
  .amdhsa_group_segment_fixed_size 0
  .amdhsa_kernarg_size 80
  .amdhsa_user_sgpr_count 2
  .amdhsa_user_sgpr_kernarg_segment_ptr 1
  .amdhsa_system_sgpr_workgroup_id_x 1
.end_amdhsa_kernel
```
